```python
import torch

def _softmax(x, axis=-1):
    return torch.softmax(x, dim=axis)
def _gelu(x):
    return torch.nn.functional.gelu(x, approximate="tanh")
def _silu(x):
    return torch.nn.functional.silu(x)
def _sigmoid(x):
    return torch.sigmoid(x)
def _layernorm(x, axis=-1, eps=1e-5):
    m = x.mean(dim=axis, keepdim=True)
    v = x.var(dim=axis, keepdim=True, unbiased=False)
    return (x - m) / torch.sqrt(v + eps)
def _scatter_add(tgt, idx, src, axis=0):
    return tgt.clone().index_add_(axis, idx, src)
def _segment_sum(src, seg, n):
    out = torch.zeros((n,) + src.shape[1:], dtype=src.dtype)
    return out.index_add_(0, seg, src)
def _pad(x, pw):
    flat = tuple(v for pair in reversed(pw) for v in pair)
    return torch.nn.functional.pad(x, flat)

kernel_name = 'concat_heads__mha_block_cached__gqa_block_cached__near_ridge'

def setup_inputs():

    _w = (lambda a: (lambda t: t.to(torch.bfloat16) if t.is_floating_point() else t)(torch.as_tensor(a)))
    def _A_setup():
        B, Sq, D = 8, 128, 1024
        H, Sk, Dh = 32, 512, 128
        return {
            "x": _w((lambda *s: torch.randn(*s, dtype=torch.bfloat16) * 0.8)(B, Sq, D)),
            "k_cache": _w((lambda *s: torch.randn(*s, dtype=torch.bfloat16) * 0.8)(B, H, Sk, Dh)),
            "v_cache": _w((lambda *s: torch.randn(*s, dtype=torch.bfloat16) * 0.05)(B, H, Sk, Dh)),
            "wq": _w((lambda *s: torch.randn(*s, dtype=torch.bfloat16) * 0.8)(D, H * Dh) * (D ** -0.5)),
            "wo": _w((lambda *s: torch.randn(*s, dtype=torch.bfloat16) * 0.05)(H * Dh, D) * ((H * Dh) ** -0.5)),
        }
    _A_in = _A_setup()

    def _B_setup():
        B, Sq, D = 8, 128, 1024
        Hq, Hkv, Sk, Dh = 32, 32, 512, 128
        assert Hq % Hkv == 0, (Hq, Hkv)
        return {
            "x": _w((lambda *s: torch.randn(*s, dtype=torch.bfloat16) * 0.8)(B, Sq, D)),
            "k_cache": _w((lambda *s: torch.randn(*s, dtype=torch.bfloat16) * 0.8)(B, Hkv, Sk, Dh)),
            "v_cache": _w((lambda *s: torch.randn(*s, dtype=torch.bfloat16) * 0.05)(B, Hkv, Sk, Dh)),
            "wq": _w((lambda *s: torch.randn(*s, dtype=torch.bfloat16) * 0.8)(D, Hq * Dh) * (D ** -0.5)),
            "wo": _w((lambda *s: torch.randn(*s, dtype=torch.bfloat16) * 0.05)(Hq * Dh, D) * ((Hq * Dh) ** -0.5)),
        }
    _B_in = _B_setup()

    return {
        "A_x": _A_in["x"],
        "A_k_cache": _A_in["k_cache"],
        "A_v_cache": _A_in["v_cache"],
        "A_wq": _A_in["wq"],
        "A_wo": _A_in["wo"],
        "B_x": _B_in["x"],
        "B_k_cache": _B_in["k_cache"],
        "B_v_cache": _B_in["v_cache"],
        "B_wq": _B_in["wq"],
        "B_wo": _B_in["wo"],
    }

def reference(A_x, A_k_cache, A_v_cache, A_wq, A_wo, B_x, B_k_cache, B_v_cache, B_wq, B_wo):
    def _A_ref(x, k_cache, v_cache, wq, wo):
        B, Sq, D = x.shape
        H, Dh = 32, 128
        q = (lambda x, *d: x.permute(*d))((x @ wq).reshape(B, Sq, H, Dh), 0, 2, 1, 3)
        scores = torch.einsum("bhqd,bhkd->bhqk", q, k_cache) * (Dh ** -0.5)
        p = _softmax(scores, axis=-1)
        o = torch.einsum("bhqk,bhkd->bhqd", p, v_cache)
        return (lambda x, *d: x.permute(*d))(o, 0, 2, 1, 3).reshape(B, Sq, H * Dh) @ wo

    def _B_ref(x, k_cache, v_cache, wq, wo):
        B, Sq, D = x.shape
        Hq, Dh = 32, 128
        Hkv = k_cache.shape[1]
        rep = Hq // Hkv
        q = (lambda x, *d: x.permute(*d))((x @ wq).reshape(B, Sq, Hq, Dh), 0, 2, 1, 3)
        k = (lambda x, n, axis: torch.repeat_interleave(x, n, dim=axis))(k_cache, rep, axis=1)
        v = (lambda x, n, axis: torch.repeat_interleave(x, n, dim=axis))(v_cache, rep, axis=1)
        scores = torch.einsum("bhqd,bhkd->bhqk", q, k) * (Dh ** -0.5)
        p = _softmax(scores, axis=-1)
        o = torch.einsum("bhqk,bhkd->bhqd", p, v)
        return (lambda x, *d: x.permute(*d))(o, 0, 2, 1, 3).reshape(B, Sq, Hq * Dh) @ wo

    a = _A_ref(A_x, A_k_cache, A_v_cache, A_wq, A_wo)
    b = _B_ref(B_x, B_k_cache, B_v_cache, B_wq, B_wo)
    return torch.concatenate([a, b], axis=-1)
```

```asm
; @launch grid=(256,1,1) block=(512,1,1) lds=163840
.amdgcn_target "amdgcn-amd-amdhsa--gfx950"
.text
.globl concat_heads__mha_block_cached__gqa_block_cached__near_ridge_kernel
.p2align 8
.type concat_heads__mha_block_cached__gqa_block_cached__near_ridge_kernel,@function
concat_heads__mha_block_cached__gqa_block_cached__near_ridge_kernel:
    s_cmp_ge_u32 s2, 256
    s_cbranch_scc1 L_end
    s_bfe_u32 s3, s2, 0x10002
    s_mul_i32 s27, s3, 40
    s_load_dwordx8 s[8:15], s[0:1], s27
    s_load_dwordx2 s[48:49], s[0:1], s27 offset:32
    s_load_dwordx4 s[52:55], s[0:1], 80
    s_load_dwordx2 s[20:21], s[0:1], 96
    v_lshrrev_b32 v1, 6, v0
    s_getpc_b64 s[58:59]
    v_mul_u32_u24 v246, 52, v0
    v_readfirstlane_b32 s24, v1
    global_load_dword v246, v246, s[58:59]
    v_and_b32 v0, 63, v0
    s_lshr_b32 s66, s2, 3
    s_and_b32 s67, s66, 7
    s_lshr_b32 s66, s66, 3
    s_and_b32 s92, s2, 3
    s_lshr_b32 s30, s24, 2
    s_cbranch_scc0 L_np
    s_setprio 1
L_np:
    s_and_b32 s31, s24, 3
    v_lshrrev_b32 v248, 4, v0
    v_and_b32 v249, 15, v0
    v_and_b32 v250, 3, v0
    v_bfe_u32 v251, v0, 2, 2
    s_and_b32 s27, s31, 1
    s_lshl_b32 s27, s27, 2
    v_or_b32 v252, s27, v248
    v_and_b32 v253, 7, v0
    v_xor_b32 v252, v252, v253
    v_lshrrev_b32 v253, 3, v0
    s_lshl_b32 s27, s31, 3
    v_add_u32 v253, s27, v253
    v_lshlrev_b32 v253, 11, v253
    v_lshl_add_u32 v2, v252, 4, v253
    v_add_u32 v3, 0x10000, v2
    s_and_b32 s27, s31, 1
    s_lshl_b32 s27, s27, 1
    s_lshr_b32 s28, s31, 1
    s_lshl_b32 s28, s28, 3
    s_add_u32 s27, s27, s28
    v_and_b32 v252, 1, v248
    v_lshlrev_b32 v252, 2, v252
    v_lshrrev_b32 v253, 1, v248
    v_lshl_add_u32 v254, v253, 4, v252
    v_add_u32 v254, s27, v254
    v_lshlrev_b32 v254, 13, v254
    v_lshl_add_u32 v4, v249, 4, v254
    v_add_u32 v5, 0x2000, v4
    s_mul_i32 s27, s30, 33792
    s_mul_i32 s28, s31, 2112
    s_add_u32 s64, s28, 67584
    s_add_u32 s69, s27, s28
    s_lshl_b32 s28, s31, 10
    s_add_u32 s65, s28, 118272
    s_lshl_b32 s93, s67, 18
    s_lshl_b32 s28, s92, 2
    s_add_u32 s28, s28, s66
    s_lshl_b32 s94, s28, 9
    s_mov_b32 s6, 0x40000
    s_mov_b32 s7, 0x20000
    s_waitcnt lgkmcnt(0)
    s_mov_b64 s[60:61], s[8:9]
    s_add_u32 s4, s8, s93
    s_addc_u32 s5, s9, 0
    s_add_u32 s8, s14, s94
    s_addc_u32 s9, s15, 0
    s_mov_b64 s[16:17], s[12:13]
    s_mov_b64 s[12:13], s[10:11]
    s_sub_u32 s10, 0x800000, s94
    s_mov_b32 s11, 0x20000
    s_cmp_eq_u32 s30, 0
    s_cbranch_scc1 L_nold
    s_add_u32 m0, s64, 0
    s_mov_b32 s26, 0
    buffer_load_dwordx4 v4, s[8:11], s26 offen offset:0 lds
    s_add_u32 m0, s64, 1056
    s_nop 0
    buffer_load_dwordx4 v5, s[8:11], s26 offen offset:0 lds
    s_add_u32 m0, s64, 8192
    s_nop 0
    buffer_load_dwordx4 v4, s[8:11], s26 offen offset:256 lds
    s_add_u32 m0, s64, 9248
    s_nop 0
    buffer_load_dwordx4 v5, s[8:11], s26 offen offset:256 lds
    s_add_u32 m0, s65, 0
    s_mov_b32 s25, 0
    buffer_load_dwordx4 v2, s[4:7], s25 offen lds
    s_add_u32 m0, s65, 4096
    s_nop 0
    buffer_load_dwordx4 v3, s[4:7], s25 offen lds
    s_add_u32 m0, s65, 8192
    s_mov_b32 s25, 131072
    buffer_load_dwordx4 v2, s[4:7], s25 offen lds
    s_add_u32 m0, s65, 12288
    s_nop 0
    buffer_load_dwordx4 v3, s[4:7], s25 offen lds
L_nold:
    s_lshl_b32 s28, s31, 11
    v_lshl_add_u32 v9, v0, 4, s28
    v_add_u32 v254, v251, v252
    v_mul_u32_u24 v254, 1056, v254
    v_lshl_add_u32 v254, v250, 3, v254
    s_mul_i32 s28, s30, 8448
    s_add_u32 s28, s28, 67584
    v_lshl_add_u32 v255, v253, 9, v254
    v_add_u32 v8, s28, v255
    v_add_u32 v254, s27, v254
    v_lshl_add_u32 v12, v253, 8, v254
    v_lshl_add_u32 v254, v253, 7, v254
    s_lshl_b32 s28, s30, 6
    v_add_u32 v106, s28, v254
    s_xor_b32 s28, s28, 64
    v_add_u32 v107, s28, v254
    v_add_u32 v108, 67584, v106
    v_add_u32 v109, 67584, v107
    v_and_b32 v254, 7, v249
    v_mul_u32_u24 v254, 1056, v254
    v_lshrrev_b32 v255, 3, v249
    v_lshl_add_u32 v254, v255, 8, v254
    v_lshl_add_u32 v254, v248, 4, v254
    v_add_u32 v10, s27, v254
    v_add_u32 v11, 67584, v10
    v_xor_b32 v11, v11, v10
    v_add_u32 v13, 67584, v12
    v_xor_b32 v13, v13, v12
    v_lshrrev_b32 v254, 1, v249
    v_xor_b32 v254, v254, v248
    v_lshlrev_b32 v254, 4, v254
    v_lshl_add_u32 v254, v249, 7, v254
    s_lshl_b32 s27, s31, 12
    s_add_u32 s27, s27, 118272
    v_xor_b32 v255, 64, v254
    v_add_u32 v6, s27, v254
    v_add_u32 v7, s27, v255
    s_lshl_b32 s27, s31, 13
    v_lshl_add_u32 v14, v0, 4, s27
    v_lshrrev_b32 v254, 3, v0
    s_lshl_b32 s27, s31, 1
    v_lshl_add_u32 v254, v254, 3, s27
    v_lshlrev_b32 v254, 11, v254
    v_and_b32 v255, 7, v0
    v_lshl_add_u32 v104, v255, 4, v254
    v_add_u32 v105, 0x800, v104
    s_lshl_b32 s27, s31, 5
    v_add_u32 v234, s27, v0
    v_lshlrev_b32 v232, 11, v234
    v_lshlrev_b32 v235, 7, v234
    v_lshrrev_b32 v234, 2, v234
    v_lshlrev_b32 v234, 13, v234
    v_lshl_add_u32 v234, v250, 7, v234
    s_and_b32 s27, s67, 1
    s_lshl_b32 s28, s66, 1
    s_add_u32 s27, s27, s28
    s_lshl_b32 s27, s27, 18
    s_add_u32 s28, s67, 2
    s_lshl_b32 s101, s28, 18
    s_lshr_b32 s28, s28, 1
    s_lshl_b32 s28, s28, 7
    s_add_u32 s29, s27, s28
    s_add_u32 s27, s67, s66
    s_and_b32 s47, s27, 1
    s_and_b32 s27, s2, 63
    s_lshl_b32 s28, s27, 7
    s_add_u32 s28, s28, 50495488
    v_lshl_add_u32 v15, v250, 3, s28
    s_lshl_b32 s27, s27, 3
    s_add_u32 s27, s27, s24
    s_lshl_b32 s27, s27, 7
    s_add_u32 s27, s27, 50331648
    v_lshl_add_u32 v110, v250, 3, s27
    s_lshl_b32 s100, 1, s66
    s_xor_b32 s100, s100, 15
    v_mov_b32 v16, 0x3f803f80
    v_mov_b32 v17, 0x3f803f80
    v_mov_b32 v18, 0x3f803f80
    v_mov_b32 v19, 0x3f803f80
    v_mov_b32 v36, 0xff800000
    v_mov_b32 v37, 0xff800000
    s_lshr_b32 s27, s94, 8
    s_add_u32 s27, s27, s30
    s_lshl_b32 s28, s67, 5
    s_add_u32 s27, s27, s28
    s_lshl_b32 s95, s27, 17
    s_lshl_b32 s27, s92, 3
    s_add_u32 s27, s27, s30
    s_lshl_b32 s96, s27, 18
    s_add_u32 s27, s27, s28
    s_lshl_b32 s28, s3, 8
    s_add_u32 s27, s27, s28
    s_lshl_b32 s58, s27, 15
    s_lshl_b32 s28, s66, 9
    s_add_u32 s96, s96, s28
    s_lshl_b32 s27, s67, 19
    s_add_u32 s28, s28, s27
    s_lshl_b32 s27, s3, 11
    s_add_u32 s28, s28, s27
    s_lshl_b32 s27, s92, 7
    s_add_u32 s28, s28, s27
    s_lshl_b32 s27, s30, 6
    s_add_u32 s97, s28, s27
    s_sub_u32 s68, 0x400000, s97
    s_and_b32 s59, s2, 0xfc
    s_lshl_b32 s93, s30, 11
    s_lshl_b32 s27, s31, 12
    s_sub_u32 s93, s93, s27
    s_add_u32 s27, s66, 0
    s_and_b32 s27, s27, 3
    s_lshl_b32 s32, s27, 19
    s_lshl_b32 s27, s27, 16
    s_add_u32 s40, s58, s27
    s_add_u32 s27, s92, 1
    s_and_b32 s27, s27, 3
    s_lshl_b32 s36, s27, 7
    s_or_b32 s27, s27, s59
    s_mul_i32 s27, s27, 49152
    s_add_u32 s27, s27, s93
    s_add_u32 s44, s27, 16777216
    s_add_u32 s27, s66, 1
    s_and_b32 s27, s27, 3
    s_lshl_b32 s33, s27, 19
    s_lshl_b32 s27, s27, 16
    s_add_u32 s41, s58, s27
    s_add_u32 s27, s92, 2
    s_and_b32 s27, s27, 3
    s_lshl_b32 s37, s27, 7
    s_or_b32 s27, s27, s59
    s_mul_i32 s27, s27, 49152
    s_add_u32 s27, s27, s93
    s_add_u32 s45, s27, 16793600
    s_add_u32 s27, s66, 2
    s_and_b32 s27, s27, 3
    s_lshl_b32 s34, s27, 19
    s_lshl_b32 s27, s27, 16
    s_add_u32 s42, s58, s27
    s_add_u32 s27, s92, 3
    s_and_b32 s27, s27, 3
    s_lshl_b32 s38, s27, 7
    s_or_b32 s27, s27, s59
    s_mul_i32 s27, s27, 49152
    s_add_u32 s27, s27, s93
    s_add_u32 s46, s27, 16809984
    s_add_u32 s27, s66, 3
    s_and_b32 s27, s27, 3
    s_lshl_b32 s35, s27, 19
    s_lshl_b32 s27, s27, 16
    s_add_u32 s43, s58, s27
    s_add_u32 s27, s92, 4
    s_and_b32 s27, s27, 3
    s_lshl_b32 s39, s27, 7
    s_mov_b32 s58, 16384
    s_mov_b32 s59, 16384
    s_lshr_b32 s18, 0x40000, s30
    s_mov_b32 s19, 0x20000
    s_mov_b32 s22, 0x4000000
    s_mov_b32 s23, 0x20000
    s_sub_u32 s50, 0x800000, s96
    s_mov_b32 s51, 0x20000
    s_mov_b32 s62, 0x200000
    s_mov_b32 s63, 0x20000
    s_add_u32 s16, s16, s95
    s_addc_u32 s17, s17, 0
    s_add_u32 s12, s12, s95
    s_addc_u32 s13, s13, 0
    s_mov_b32 s14, s18
    s_mov_b32 s15, 0x20000
    s_add_u32 s48, s48, s96
    s_addc_u32 s49, s49, 0
    s_add_u32 s56, s52, s97
    s_addc_u32 s57, s53, 0
    s_mov_b64 s[52:53], s[54:55]
    s_mov_b32 s54, 256
    s_mov_b32 s55, 0x20000
    s_cmp_eq_u32 s30, 0
    s_cbranch_scc1 L_qa
    s_add_u32 m0, s64, 16896
    s_mov_b32 s26, 262144
    buffer_load_dwordx4 v4, s[8:11], s26 offen offset:0 lds
    s_add_u32 m0, s64, 17952
    s_nop 0
    buffer_load_dwordx4 v5, s[8:11], s26 offen offset:0 lds
    s_add_u32 m0, s64, 25088
    s_nop 0
    buffer_load_dwordx4 v4, s[8:11], s26 offen offset:256 lds
    s_add_u32 m0, s64, 26144
    s_nop 0
    buffer_load_dwordx4 v5, s[8:11], s26 offen offset:256 lds
    s_add_u32 m0, s65, 16384
    s_mov_b32 s25, 128
    buffer_load_dwordx4 v2, s[4:7], s25 offen lds
    s_add_u32 m0, s65, 20480
    s_nop 0
    buffer_load_dwordx4 v3, s[4:7], s25 offen lds
    s_waitcnt vmcnt(6) lgkmcnt(0)
    s_barrier
    ds_read_b128 v[200:203], v6 offset:0
    ds_read_b128 v[204:207], v6 offset:2048
    ds_read_b128 v[208:211], v7 offset:0
    ds_read_b128 v[212:215], v7 offset:2048
    ds_read_b64_tr_b16 v[136:137], v8 offset:0
    ds_read_b64_tr_b16 v[138:139], v8 offset:256
    ds_read_b64_tr_b16 v[140:141], v8 offset:32
    ds_read_b64_tr_b16 v[142:143], v8 offset:288
    ds_read_b64_tr_b16 v[144:145], v8 offset:64
    ds_read_b64_tr_b16 v[146:147], v8 offset:320
    ds_read_b64_tr_b16 v[148:149], v8 offset:96
    ds_read_b64_tr_b16 v[150:151], v8 offset:352
    ds_read_b64_tr_b16 v[152:153], v8 offset:128
    ds_read_b64_tr_b16 v[154:155], v8 offset:384
    ds_read_b64_tr_b16 v[156:157], v8 offset:160
    ds_read_b64_tr_b16 v[158:159], v8 offset:416
    ds_read_b64_tr_b16 v[160:161], v8 offset:192
    ds_read_b64_tr_b16 v[162:163], v8 offset:448
    ds_read_b64_tr_b16 v[164:165], v8 offset:224
    ds_read_b64_tr_b16 v[166:167], v8 offset:480
    s_add_u32 m0, s64, 33792
    s_mov_b32 s26, 524288
    buffer_load_dwordx4 v4, s[8:11], s26 offen offset:0 lds
    s_add_u32 m0, s64, 34848
    s_nop 0
    buffer_load_dwordx4 v5, s[8:11], s26 offen offset:0 lds
    s_add_u32 m0, s64, 41984
    s_nop 0
    buffer_load_dwordx4 v4, s[8:11], s26 offen offset:256 lds
    s_add_u32 m0, s64, 43040
    s_nop 0
    buffer_load_dwordx4 v5, s[8:11], s26 offen offset:256 lds
    s_add_u32 m0, s65, 24576
    s_mov_b32 s25, 131200
    buffer_load_dwordx4 v2, s[4:7], s25 offen lds
    s_add_u32 m0, s65, 28672
    s_nop 0
    buffer_load_dwordx4 v3, s[4:7], s25 offen lds
    s_waitcnt vmcnt(8) lgkmcnt(0)
    s_barrier
    s_add_u32 m0, s64, 0
    s_mov_b32 s26, 786432
    buffer_load_dwordx4 v4, s[8:11], s26 offen offset:0 lds
    s_add_u32 m0, s64, 1056
    s_nop 0
    buffer_load_dwordx4 v5, s[8:11], s26 offen offset:0 lds
    s_add_u32 m0, s64, 8192
    s_nop 0
    buffer_load_dwordx4 v4, s[8:11], s26 offen offset:256 lds
    s_add_u32 m0, s64, 9248
    s_nop 0
    buffer_load_dwordx4 v5, s[8:11], s26 offen offset:256 lds
    s_add_u32 m0, s65, 0
    s_mov_b32 s25, 256
    buffer_load_dwordx4 v2, s[4:7], s25 offen lds
    s_add_u32 m0, s65, 4096
    s_nop 0
    buffer_load_dwordx4 v3, s[4:7], s25 offen lds
    ds_read_b64_tr_b16 v[168:169], v8 offset:16896
    ds_read_b64_tr_b16 v[170:171], v8 offset:17152
    ds_read_b64_tr_b16 v[172:173], v8 offset:16928
    ds_read_b64_tr_b16 v[174:175], v8 offset:17184
    v_mfma_f32_16x16x32_bf16 v[40:43], v[136:139], v[200:203], 0
    ds_read_b64_tr_b16 v[176:177], v8 offset:16960
    v_mfma_f32_16x16x32_bf16 v[44:47], v[136:139], v[204:207], 0
    ds_read_b64_tr_b16 v[178:179], v8 offset:17216
    v_mfma_f32_16x16x32_bf16 v[48:51], v[140:143], v[200:203], 0
    ds_read_b64_tr_b16 v[180:181], v8 offset:16992
    v_mfma_f32_16x16x32_bf16 v[52:55], v[140:143], v[204:207], 0
    ds_read_b64_tr_b16 v[182:183], v8 offset:17248
    v_mfma_f32_16x16x32_bf16 v[56:59], v[144:147], v[200:203], 0
    ds_read_b64_tr_b16 v[184:185], v8 offset:17024
    v_mfma_f32_16x16x32_bf16 v[60:63], v[144:147], v[204:207], 0
    ds_read_b64_tr_b16 v[186:187], v8 offset:17280
    v_mfma_f32_16x16x32_bf16 v[64:67], v[148:151], v[200:203], 0
    ds_read_b64_tr_b16 v[188:189], v8 offset:17056
    v_mfma_f32_16x16x32_bf16 v[68:71], v[148:151], v[204:207], 0
    ds_read_b64_tr_b16 v[190:191], v8 offset:17312
    v_mfma_f32_16x16x32_bf16 v[72:75], v[152:155], v[200:203], 0
    ds_read_b64_tr_b16 v[192:193], v8 offset:17088
    v_mfma_f32_16x16x32_bf16 v[76:79], v[152:155], v[204:207], 0
    ds_read_b64_tr_b16 v[194:195], v8 offset:17344
    v_mfma_f32_16x16x32_bf16 v[80:83], v[156:159], v[200:203], 0
    ds_read_b64_tr_b16 v[196:197], v8 offset:17120
    v_mfma_f32_16x16x32_bf16 v[84:87], v[156:159], v[204:207], 0
    ds_read_b64_tr_b16 v[198:199], v8 offset:17376
    v_mfma_f32_16x16x32_bf16 v[88:91], v[160:163], v[200:203], 0
    v_mfma_f32_16x16x32_bf16 v[92:95], v[160:163], v[204:207], 0
    v_mfma_f32_16x16x32_bf16 v[96:99], v[164:167], v[200:203], 0
    v_mfma_f32_16x16x32_bf16 v[100:103], v[164:167], v[204:207], 0
    s_waitcnt vmcnt(6) lgkmcnt(0)
    s_barrier
    s_add_u32 m0, s64, 16896
    s_mov_b32 s26, 1048576
    buffer_load_dwordx4 v4, s[8:11], s26 offen offset:0 lds
    s_add_u32 m0, s64, 17952
    s_nop 0
    buffer_load_dwordx4 v5, s[8:11], s26 offen offset:0 lds
    s_add_u32 m0, s64, 25088
    s_nop 0
    buffer_load_dwordx4 v4, s[8:11], s26 offen offset:256 lds
    s_add_u32 m0, s64, 26144
    s_nop 0
    buffer_load_dwordx4 v5, s[8:11], s26 offen offset:256 lds
    s_add_u32 m0, s65, 8192
    s_mov_b32 s25, 131328
    buffer_load_dwordx4 v2, s[4:7], s25 offen lds
    s_add_u32 m0, s65, 12288
    s_nop 0
    buffer_load_dwordx4 v3, s[4:7], s25 offen lds
    ds_read_b128 v[216:219], v6 offset:16384
    ds_read_b128 v[220:223], v6 offset:18432
    ds_read_b128 v[224:227], v7 offset:16384
    ds_read_b128 v[228:231], v7 offset:18432
    ds_read_b64_tr_b16 v[136:137], v8 offset:33792
    ds_read_b64_tr_b16 v[138:139], v8 offset:34048
    ds_read_b64_tr_b16 v[140:141], v8 offset:33824
    ds_read_b64_tr_b16 v[142:143], v8 offset:34080
    v_mfma_f32_16x16x32_bf16 v[40:43], v[168:171], v[208:211], v[40:43]
    ds_read_b64_tr_b16 v[144:145], v8 offset:33856
    v_mfma_f32_16x16x32_bf16 v[44:47], v[168:171], v[212:215], v[44:47]
    ds_read_b64_tr_b16 v[146:147], v8 offset:34112
    v_mfma_f32_16x16x32_bf16 v[48:51], v[172:175], v[208:211], v[48:51]
    ds_read_b64_tr_b16 v[148:149], v8 offset:33888
    v_mfma_f32_16x16x32_bf16 v[52:55], v[172:175], v[212:215], v[52:55]
    ds_read_b64_tr_b16 v[150:151], v8 offset:34144
    v_mfma_f32_16x16x32_bf16 v[56:59], v[176:179], v[208:211], v[56:59]
    ds_read_b64_tr_b16 v[152:153], v8 offset:33920
    v_mfma_f32_16x16x32_bf16 v[60:63], v[176:179], v[212:215], v[60:63]
    ds_read_b64_tr_b16 v[154:155], v8 offset:34176
    v_mfma_f32_16x16x32_bf16 v[64:67], v[180:183], v[208:211], v[64:67]
    ds_read_b64_tr_b16 v[156:157], v8 offset:33952
    v_mfma_f32_16x16x32_bf16 v[68:71], v[180:183], v[212:215], v[68:71]
    ds_read_b64_tr_b16 v[158:159], v8 offset:34208
    v_mfma_f32_16x16x32_bf16 v[72:75], v[184:187], v[208:211], v[72:75]
    ds_read_b64_tr_b16 v[160:161], v8 offset:33984
    v_mfma_f32_16x16x32_bf16 v[76:79], v[184:187], v[212:215], v[76:79]
    ds_read_b64_tr_b16 v[162:163], v8 offset:34240
    v_mfma_f32_16x16x32_bf16 v[80:83], v[188:191], v[208:211], v[80:83]
    ds_read_b64_tr_b16 v[164:165], v8 offset:34016
    v_mfma_f32_16x16x32_bf16 v[84:87], v[188:191], v[212:215], v[84:87]
    ds_read_b64_tr_b16 v[166:167], v8 offset:34272
    v_mfma_f32_16x16x32_bf16 v[88:91], v[192:195], v[208:211], v[88:91]
    v_mfma_f32_16x16x32_bf16 v[92:95], v[192:195], v[212:215], v[92:95]
    v_mfma_f32_16x16x32_bf16 v[96:99], v[196:199], v[208:211], v[96:99]
    v_mfma_f32_16x16x32_bf16 v[100:103], v[196:199], v[212:215], v[100:103]
    s_waitcnt vmcnt(8) lgkmcnt(0)
    s_barrier
    s_add_u32 m0, s64, 33792
    s_mov_b32 s26, 1310720
    buffer_load_dwordx4 v4, s[8:11], s26 offen offset:0 lds
    s_add_u32 m0, s64, 34848
    s_nop 0
    buffer_load_dwordx4 v5, s[8:11], s26 offen offset:0 lds
    s_add_u32 m0, s64, 41984
    s_nop 0
    buffer_load_dwordx4 v4, s[8:11], s26 offen offset:256 lds
    s_add_u32 m0, s64, 43040
    s_nop 0
    buffer_load_dwordx4 v5, s[8:11], s26 offen offset:256 lds
    s_add_u32 m0, s65, 16384
    s_mov_b32 s25, 384
    buffer_load_dwordx4 v2, s[4:7], s25 offen lds
    s_add_u32 m0, s65, 20480
    s_nop 0
    buffer_load_dwordx4 v3, s[4:7], s25 offen lds
    ds_read_b64_tr_b16 v[168:169], v8 offset:0
    ds_read_b64_tr_b16 v[170:171], v8 offset:256
    ds_read_b64_tr_b16 v[172:173], v8 offset:32
    ds_read_b64_tr_b16 v[174:175], v8 offset:288
    v_mfma_f32_16x16x32_bf16 v[40:43], v[136:139], v[216:219], v[40:43]
    ds_read_b64_tr_b16 v[176:177], v8 offset:64
    v_mfma_f32_16x16x32_bf16 v[44:47], v[136:139], v[220:223], v[44:47]
    ds_read_b64_tr_b16 v[178:179], v8 offset:320
    v_mfma_f32_16x16x32_bf16 v[48:51], v[140:143], v[216:219], v[48:51]
    ds_read_b64_tr_b16 v[180:181], v8 offset:96
    v_mfma_f32_16x16x32_bf16 v[52:55], v[140:143], v[220:223], v[52:55]
    ds_read_b64_tr_b16 v[182:183], v8 offset:352
    v_mfma_f32_16x16x32_bf16 v[56:59], v[144:147], v[216:219], v[56:59]
    ds_read_b64_tr_b16 v[184:185], v8 offset:128
    v_mfma_f32_16x16x32_bf16 v[60:63], v[144:147], v[220:223], v[60:63]
    ds_read_b64_tr_b16 v[186:187], v8 offset:384
    v_mfma_f32_16x16x32_bf16 v[64:67], v[148:151], v[216:219], v[64:67]
    ds_read_b64_tr_b16 v[188:189], v8 offset:160
    v_mfma_f32_16x16x32_bf16 v[68:71], v[148:151], v[220:223], v[68:71]
    ds_read_b64_tr_b16 v[190:191], v8 offset:416
    v_mfma_f32_16x16x32_bf16 v[72:75], v[152:155], v[216:219], v[72:75]
    ds_read_b64_tr_b16 v[192:193], v8 offset:192
    v_mfma_f32_16x16x32_bf16 v[76:79], v[152:155], v[220:223], v[76:79]
    ds_read_b64_tr_b16 v[194:195], v8 offset:448
    v_mfma_f32_16x16x32_bf16 v[80:83], v[156:159], v[216:219], v[80:83]
    ds_read_b64_tr_b16 v[196:197], v8 offset:224
    v_mfma_f32_16x16x32_bf16 v[84:87], v[156:159], v[220:223], v[84:87]
    ds_read_b64_tr_b16 v[198:199], v8 offset:480
    v_mfma_f32_16x16x32_bf16 v[88:91], v[160:163], v[216:219], v[88:91]
    v_mfma_f32_16x16x32_bf16 v[92:95], v[160:163], v[220:223], v[92:95]
    v_mfma_f32_16x16x32_bf16 v[96:99], v[164:167], v[216:219], v[96:99]
    v_mfma_f32_16x16x32_bf16 v[100:103], v[164:167], v[220:223], v[100:103]
    s_waitcnt vmcnt(6) lgkmcnt(0)
    s_barrier
    s_add_u32 m0, s64, 0
    s_mov_b32 s26, 1572864
    buffer_load_dwordx4 v4, s[8:11], s26 offen offset:0 lds
    s_add_u32 m0, s64, 1056
    s_nop 0
    buffer_load_dwordx4 v5, s[8:11], s26 offen offset:0 lds
    s_add_u32 m0, s64, 8192
    s_nop 0
    buffer_load_dwordx4 v4, s[8:11], s26 offen offset:256 lds
    s_add_u32 m0, s64, 9248
    s_nop 0
    buffer_load_dwordx4 v5, s[8:11], s26 offen offset:256 lds
    s_add_u32 m0, s65, 24576
    s_mov_b32 s25, 131456
    buffer_load_dwordx4 v2, s[4:7], s25 offen lds
    s_add_u32 m0, s65, 28672
    s_nop 0
    buffer_load_dwordx4 v3, s[4:7], s25 offen lds
    ds_read_b128 v[200:203], v6 offset:0
    ds_read_b128 v[204:207], v6 offset:2048
    ds_read_b128 v[208:211], v7 offset:0
    ds_read_b128 v[212:215], v7 offset:2048
    ds_read_b64_tr_b16 v[136:137], v8 offset:16896
    ds_read_b64_tr_b16 v[138:139], v8 offset:17152
    ds_read_b64_tr_b16 v[140:141], v8 offset:16928
    ds_read_b64_tr_b16 v[142:143], v8 offset:17184
    v_mfma_f32_16x16x32_bf16 v[40:43], v[168:171], v[224:227], v[40:43]
    ds_read_b64_tr_b16 v[144:145], v8 offset:16960
    v_mfma_f32_16x16x32_bf16 v[44:47], v[168:171], v[228:231], v[44:47]
    ds_read_b64_tr_b16 v[146:147], v8 offset:17216
    v_mfma_f32_16x16x32_bf16 v[48:51], v[172:175], v[224:227], v[48:51]
    ds_read_b64_tr_b16 v[148:149], v8 offset:16992
    v_mfma_f32_16x16x32_bf16 v[52:55], v[172:175], v[228:231], v[52:55]
    ds_read_b64_tr_b16 v[150:151], v8 offset:17248
    v_mfma_f32_16x16x32_bf16 v[56:59], v[176:179], v[224:227], v[56:59]
    ds_read_b64_tr_b16 v[152:153], v8 offset:17024
    v_mfma_f32_16x16x32_bf16 v[60:63], v[176:179], v[228:231], v[60:63]
    ds_read_b64_tr_b16 v[154:155], v8 offset:17280
    v_mfma_f32_16x16x32_bf16 v[64:67], v[180:183], v[224:227], v[64:67]
    ds_read_b64_tr_b16 v[156:157], v8 offset:17056
    v_mfma_f32_16x16x32_bf16 v[68:71], v[180:183], v[228:231], v[68:71]
    ds_read_b64_tr_b16 v[158:159], v8 offset:17312
    v_mfma_f32_16x16x32_bf16 v[72:75], v[184:187], v[224:227], v[72:75]
    ds_read_b64_tr_b16 v[160:161], v8 offset:17088
    v_mfma_f32_16x16x32_bf16 v[76:79], v[184:187], v[228:231], v[76:79]
    ds_read_b64_tr_b16 v[162:163], v8 offset:17344
    v_mfma_f32_16x16x32_bf16 v[80:83], v[188:191], v[224:227], v[80:83]
    ds_read_b64_tr_b16 v[164:165], v8 offset:17120
    v_mfma_f32_16x16x32_bf16 v[84:87], v[188:191], v[228:231], v[84:87]
    ds_read_b64_tr_b16 v[166:167], v8 offset:17376
    v_mfma_f32_16x16x32_bf16 v[88:91], v[192:195], v[224:227], v[88:91]
    v_mfma_f32_16x16x32_bf16 v[92:95], v[192:195], v[228:231], v[92:95]
    v_mfma_f32_16x16x32_bf16 v[96:99], v[196:199], v[224:227], v[96:99]
    v_mfma_f32_16x16x32_bf16 v[100:103], v[196:199], v[228:231], v[100:103]
    s_waitcnt vmcnt(8) lgkmcnt(0)
    s_barrier
    s_add_u32 m0, s64, 16896
    s_mov_b32 s26, 1835008
    buffer_load_dwordx4 v4, s[8:11], s26 offen offset:0 lds
    s_add_u32 m0, s64, 17952
    s_nop 0
    buffer_load_dwordx4 v5, s[8:11], s26 offen offset:0 lds
    s_add_u32 m0, s64, 25088
    s_nop 0
    buffer_load_dwordx4 v4, s[8:11], s26 offen offset:256 lds
    s_add_u32 m0, s64, 26144
    s_nop 0
    buffer_load_dwordx4 v5, s[8:11], s26 offen offset:256 lds
    s_add_u32 m0, s65, 0
    s_mov_b32 s25, 512
    buffer_load_dwordx4 v2, s[4:7], s25 offen lds
    s_add_u32 m0, s65, 4096
    s_nop 0
    buffer_load_dwordx4 v3, s[4:7], s25 offen lds
    ds_read_b64_tr_b16 v[168:169], v8 offset:33792
    ds_read_b64_tr_b16 v[170:171], v8 offset:34048
    ds_read_b64_tr_b16 v[172:173], v8 offset:33824
    ds_read_b64_tr_b16 v[174:175], v8 offset:34080
    v_mfma_f32_16x16x32_bf16 v[40:43], v[136:139], v[200:203], v[40:43]
    ds_read_b64_tr_b16 v[176:177], v8 offset:33856
    v_mfma_f32_16x16x32_bf16 v[44:47], v[136:139], v[204:207], v[44:47]
    ds_read_b64_tr_b16 v[178:179], v8 offset:34112
    v_mfma_f32_16x16x32_bf16 v[48:51], v[140:143], v[200:203], v[48:51]
    ds_read_b64_tr_b16 v[180:181], v8 offset:33888
    v_mfma_f32_16x16x32_bf16 v[52:55], v[140:143], v[204:207], v[52:55]
    ds_read_b64_tr_b16 v[182:183], v8 offset:34144
    v_mfma_f32_16x16x32_bf16 v[56:59], v[144:147], v[200:203], v[56:59]
    ds_read_b64_tr_b16 v[184:185], v8 offset:33920
    v_mfma_f32_16x16x32_bf16 v[60:63], v[144:147], v[204:207], v[60:63]
    ds_read_b64_tr_b16 v[186:187], v8 offset:34176
    v_mfma_f32_16x16x32_bf16 v[64:67], v[148:151], v[200:203], v[64:67]
    ds_read_b64_tr_b16 v[188:189], v8 offset:33952
    v_mfma_f32_16x16x32_bf16 v[68:71], v[148:151], v[204:207], v[68:71]
    ds_read_b64_tr_b16 v[190:191], v8 offset:34208
    v_mfma_f32_16x16x32_bf16 v[72:75], v[152:155], v[200:203], v[72:75]
    ds_read_b64_tr_b16 v[192:193], v8 offset:33984
    v_mfma_f32_16x16x32_bf16 v[76:79], v[152:155], v[204:207], v[76:79]
    ds_read_b64_tr_b16 v[194:195], v8 offset:34240
    v_mfma_f32_16x16x32_bf16 v[80:83], v[156:159], v[200:203], v[80:83]
    ds_read_b64_tr_b16 v[196:197], v8 offset:34016
    v_mfma_f32_16x16x32_bf16 v[84:87], v[156:159], v[204:207], v[84:87]
    ds_read_b64_tr_b16 v[198:199], v8 offset:34272
    v_mfma_f32_16x16x32_bf16 v[88:91], v[160:163], v[200:203], v[88:91]
    v_mfma_f32_16x16x32_bf16 v[92:95], v[160:163], v[204:207], v[92:95]
    v_mfma_f32_16x16x32_bf16 v[96:99], v[164:167], v[200:203], v[96:99]
    v_mfma_f32_16x16x32_bf16 v[100:103], v[164:167], v[204:207], v[100:103]
    s_waitcnt vmcnt(6) lgkmcnt(0)
    s_barrier
    s_add_u32 m0, s64, 33792
    s_mov_b32 s26, 2097152
    buffer_load_dwordx4 v4, s[8:11], s26 offen offset:0 lds
    s_add_u32 m0, s64, 34848
    s_nop 0
    buffer_load_dwordx4 v5, s[8:11], s26 offen offset:0 lds
    s_add_u32 m0, s64, 41984
    s_nop 0
    buffer_load_dwordx4 v4, s[8:11], s26 offen offset:256 lds
    s_add_u32 m0, s64, 43040
    s_nop 0
    buffer_load_dwordx4 v5, s[8:11], s26 offen offset:256 lds
    s_add_u32 m0, s65, 8192
    s_mov_b32 s25, 131584
    buffer_load_dwordx4 v2, s[4:7], s25 offen lds
    s_add_u32 m0, s65, 12288
    s_nop 0
    buffer_load_dwordx4 v3, s[4:7], s25 offen lds
    ds_read_b128 v[216:219], v6 offset:16384
    ds_read_b128 v[220:223], v6 offset:18432
    ds_read_b128 v[224:227], v7 offset:16384
    ds_read_b128 v[228:231], v7 offset:18432
    ds_read_b64_tr_b16 v[136:137], v8 offset:0
    ds_read_b64_tr_b16 v[138:139], v8 offset:256
    ds_read_b64_tr_b16 v[140:141], v8 offset:32
    ds_read_b64_tr_b16 v[142:143], v8 offset:288
    v_mfma_f32_16x16x32_bf16 v[40:43], v[168:171], v[208:211], v[40:43]
    ds_read_b64_tr_b16 v[144:145], v8 offset:64
    v_mfma_f32_16x16x32_bf16 v[44:47], v[168:171], v[212:215], v[44:47]
    ds_read_b64_tr_b16 v[146:147], v8 offset:320
    v_mfma_f32_16x16x32_bf16 v[48:51], v[172:175], v[208:211], v[48:51]
    ds_read_b64_tr_b16 v[148:149], v8 offset:96
    v_mfma_f32_16x16x32_bf16 v[52:55], v[172:175], v[212:215], v[52:55]
    ds_read_b64_tr_b16 v[150:151], v8 offset:352
    v_mfma_f32_16x16x32_bf16 v[56:59], v[176:179], v[208:211], v[56:59]
    ds_read_b64_tr_b16 v[152:153], v8 offset:128
    v_mfma_f32_16x16x32_bf16 v[60:63], v[176:179], v[212:215], v[60:63]
    ds_read_b64_tr_b16 v[154:155], v8 offset:384
    v_mfma_f32_16x16x32_bf16 v[64:67], v[180:183], v[208:211], v[64:67]
    ds_read_b64_tr_b16 v[156:157], v8 offset:160
    v_mfma_f32_16x16x32_bf16 v[68:71], v[180:183], v[212:215], v[68:71]
    ds_read_b64_tr_b16 v[158:159], v8 offset:416
    v_mfma_f32_16x16x32_bf16 v[72:75], v[184:187], v[208:211], v[72:75]
    ds_read_b64_tr_b16 v[160:161], v8 offset:192
    v_mfma_f32_16x16x32_bf16 v[76:79], v[184:187], v[212:215], v[76:79]
    ds_read_b64_tr_b16 v[162:163], v8 offset:448
    v_mfma_f32_16x16x32_bf16 v[80:83], v[188:191], v[208:211], v[80:83]
    ds_read_b64_tr_b16 v[164:165], v8 offset:224
    v_mfma_f32_16x16x32_bf16 v[84:87], v[188:191], v[212:215], v[84:87]
    ds_read_b64_tr_b16 v[166:167], v8 offset:480
    v_mfma_f32_16x16x32_bf16 v[88:91], v[192:195], v[208:211], v[88:91]
    v_mfma_f32_16x16x32_bf16 v[92:95], v[192:195], v[212:215], v[92:95]
    v_mfma_f32_16x16x32_bf16 v[96:99], v[196:199], v[208:211], v[96:99]
    v_mfma_f32_16x16x32_bf16 v[100:103], v[196:199], v[212:215], v[100:103]
    s_waitcnt vmcnt(8) lgkmcnt(0)
    s_barrier
    s_add_u32 m0, s64, 0
    s_mov_b32 s26, 2359296
    buffer_load_dwordx4 v4, s[8:11], s26 offen offset:0 lds
    s_add_u32 m0, s64, 1056
    s_nop 0
    buffer_load_dwordx4 v5, s[8:11], s26 offen offset:0 lds
    s_add_u32 m0, s64, 8192
    s_nop 0
    buffer_load_dwordx4 v4, s[8:11], s26 offen offset:256 lds
    s_add_u32 m0, s64, 9248
    s_nop 0
    buffer_load_dwordx4 v5, s[8:11], s26 offen offset:256 lds
    s_add_u32 m0, s65, 16384
    s_mov_b32 s25, 640
    buffer_load_dwordx4 v2, s[4:7], s25 offen lds
    s_add_u32 m0, s65, 20480
    s_nop 0
    buffer_load_dwordx4 v3, s[4:7], s25 offen lds
    ds_read_b64_tr_b16 v[168:169], v8 offset:16896
    ds_read_b64_tr_b16 v[170:171], v8 offset:17152
    ds_read_b64_tr_b16 v[172:173], v8 offset:16928
    ds_read_b64_tr_b16 v[174:175], v8 offset:17184
    v_mfma_f32_16x16x32_bf16 v[40:43], v[136:139], v[216:219], v[40:43]
    ds_read_b64_tr_b16 v[176:177], v8 offset:16960
    v_mfma_f32_16x16x32_bf16 v[44:47], v[136:139], v[220:223], v[44:47]
    ds_read_b64_tr_b16 v[178:179], v8 offset:17216
    v_mfma_f32_16x16x32_bf16 v[48:51], v[140:143], v[216:219], v[48:51]
    ds_read_b64_tr_b16 v[180:181], v8 offset:16992
    v_mfma_f32_16x16x32_bf16 v[52:55], v[140:143], v[220:223], v[52:55]
    ds_read_b64_tr_b16 v[182:183], v8 offset:17248
    v_mfma_f32_16x16x32_bf16 v[56:59], v[144:147], v[216:219], v[56:59]
    ds_read_b64_tr_b16 v[184:185], v8 offset:17024
    v_mfma_f32_16x16x32_bf16 v[60:63], v[144:147], v[220:223], v[60:63]
    ds_read_b64_tr_b16 v[186:187], v8 offset:17280
    v_mfma_f32_16x16x32_bf16 v[64:67], v[148:151], v[216:219], v[64:67]
    ds_read_b64_tr_b16 v[188:189], v8 offset:17056
    v_mfma_f32_16x16x32_bf16 v[68:71], v[148:151], v[220:223], v[68:71]
    ds_read_b64_tr_b16 v[190:191], v8 offset:17312
    v_mfma_f32_16x16x32_bf16 v[72:75], v[152:155], v[216:219], v[72:75]
    ds_read_b64_tr_b16 v[192:193], v8 offset:17088
    v_mfma_f32_16x16x32_bf16 v[76:79], v[152:155], v[220:223], v[76:79]
    ds_read_b64_tr_b16 v[194:195], v8 offset:17344
    v_mfma_f32_16x16x32_bf16 v[80:83], v[156:159], v[216:219], v[80:83]
    ds_read_b64_tr_b16 v[196:197], v8 offset:17120
    v_mfma_f32_16x16x32_bf16 v[84:87], v[156:159], v[220:223], v[84:87]
    ds_read_b64_tr_b16 v[198:199], v8 offset:17376
    v_mfma_f32_16x16x32_bf16 v[88:91], v[160:163], v[216:219], v[88:91]
    v_mfma_f32_16x16x32_bf16 v[92:95], v[160:163], v[220:223], v[92:95]
    v_mfma_f32_16x16x32_bf16 v[96:99], v[164:167], v[216:219], v[96:99]
    v_mfma_f32_16x16x32_bf16 v[100:103], v[164:167], v[220:223], v[100:103]
    s_waitcnt vmcnt(6) lgkmcnt(0)
    s_barrier
    s_add_u32 m0, s64, 16896
    s_mov_b32 s26, 2621440
    buffer_load_dwordx4 v4, s[8:11], s26 offen offset:0 lds
    s_add_u32 m0, s64, 17952
    s_nop 0
    buffer_load_dwordx4 v5, s[8:11], s26 offen offset:0 lds
    s_add_u32 m0, s64, 25088
    s_nop 0
    buffer_load_dwordx4 v4, s[8:11], s26 offen offset:256 lds
    s_add_u32 m0, s64, 26144
    s_nop 0
    buffer_load_dwordx4 v5, s[8:11], s26 offen offset:256 lds
    s_add_u32 m0, s65, 24576
    s_mov_b32 s25, 131712
    buffer_load_dwordx4 v2, s[4:7], s25 offen lds
    s_add_u32 m0, s65, 28672
    s_nop 0
    buffer_load_dwordx4 v3, s[4:7], s25 offen lds
    ds_read_b128 v[200:203], v6 offset:0
    ds_read_b128 v[204:207], v6 offset:2048
    ds_read_b128 v[208:211], v7 offset:0
    ds_read_b128 v[212:215], v7 offset:2048
    ds_read_b64_tr_b16 v[136:137], v8 offset:33792
    ds_read_b64_tr_b16 v[138:139], v8 offset:34048
    ds_read_b64_tr_b16 v[140:141], v8 offset:33824
    ds_read_b64_tr_b16 v[142:143], v8 offset:34080
    v_mfma_f32_16x16x32_bf16 v[40:43], v[168:171], v[224:227], v[40:43]
    ds_read_b64_tr_b16 v[144:145], v8 offset:33856
    v_mfma_f32_16x16x32_bf16 v[44:47], v[168:171], v[228:231], v[44:47]
    ds_read_b64_tr_b16 v[146:147], v8 offset:34112
    v_mfma_f32_16x16x32_bf16 v[48:51], v[172:175], v[224:227], v[48:51]
    ds_read_b64_tr_b16 v[148:149], v8 offset:33888
    v_mfma_f32_16x16x32_bf16 v[52:55], v[172:175], v[228:231], v[52:55]
    ds_read_b64_tr_b16 v[150:151], v8 offset:34144
    v_mfma_f32_16x16x32_bf16 v[56:59], v[176:179], v[224:227], v[56:59]
    ds_read_b64_tr_b16 v[152:153], v8 offset:33920
    v_mfma_f32_16x16x32_bf16 v[60:63], v[176:179], v[228:231], v[60:63]
    ds_read_b64_tr_b16 v[154:155], v8 offset:34176
    v_mfma_f32_16x16x32_bf16 v[64:67], v[180:183], v[224:227], v[64:67]
    ds_read_b64_tr_b16 v[156:157], v8 offset:33952
    v_mfma_f32_16x16x32_bf16 v[68:71], v[180:183], v[228:231], v[68:71]
    ds_read_b64_tr_b16 v[158:159], v8 offset:34208
    v_mfma_f32_16x16x32_bf16 v[72:75], v[184:187], v[224:227], v[72:75]
    ds_read_b64_tr_b16 v[160:161], v8 offset:33984
    v_mfma_f32_16x16x32_bf16 v[76:79], v[184:187], v[228:231], v[76:79]
    ds_read_b64_tr_b16 v[162:163], v8 offset:34240
    v_mfma_f32_16x16x32_bf16 v[80:83], v[188:191], v[224:227], v[80:83]
    ds_read_b64_tr_b16 v[164:165], v8 offset:34016
    v_mfma_f32_16x16x32_bf16 v[84:87], v[188:191], v[228:231], v[84:87]
    ds_read_b64_tr_b16 v[166:167], v8 offset:34272
    v_mfma_f32_16x16x32_bf16 v[88:91], v[192:195], v[224:227], v[88:91]
    v_mfma_f32_16x16x32_bf16 v[92:95], v[192:195], v[228:231], v[92:95]
    v_mfma_f32_16x16x32_bf16 v[96:99], v[196:199], v[224:227], v[96:99]
    v_mfma_f32_16x16x32_bf16 v[100:103], v[196:199], v[228:231], v[100:103]
    s_waitcnt vmcnt(8) lgkmcnt(0)
    s_barrier
    s_add_u32 m0, s64, 33792
    s_mov_b32 s26, 2883584
    buffer_load_dwordx4 v4, s[8:11], s26 offen offset:0 lds
    s_add_u32 m0, s64, 34848
    s_nop 0
    buffer_load_dwordx4 v5, s[8:11], s26 offen offset:0 lds
    s_add_u32 m0, s64, 41984
    s_nop 0
    buffer_load_dwordx4 v4, s[8:11], s26 offen offset:256 lds
    s_add_u32 m0, s64, 43040
    s_nop 0
    buffer_load_dwordx4 v5, s[8:11], s26 offen offset:256 lds
    s_add_u32 m0, s65, 0
    s_mov_b32 s25, 768
    buffer_load_dwordx4 v2, s[4:7], s25 offen lds
    s_add_u32 m0, s65, 4096
    s_nop 0
    buffer_load_dwordx4 v3, s[4:7], s25 offen lds
    ds_read_b64_tr_b16 v[168:169], v8 offset:0
    ds_read_b64_tr_b16 v[170:171], v8 offset:256
    ds_read_b64_tr_b16 v[172:173], v8 offset:32
    ds_read_b64_tr_b16 v[174:175], v8 offset:288
    v_mfma_f32_16x16x32_bf16 v[40:43], v[136:139], v[200:203], v[40:43]
    ds_read_b64_tr_b16 v[176:177], v8 offset:64
    v_mfma_f32_16x16x32_bf16 v[44:47], v[136:139], v[204:207], v[44:47]
    ds_read_b64_tr_b16 v[178:179], v8 offset:320
    v_mfma_f32_16x16x32_bf16 v[48:51], v[140:143], v[200:203], v[48:51]
    ds_read_b64_tr_b16 v[180:181], v8 offset:96
    v_mfma_f32_16x16x32_bf16 v[52:55], v[140:143], v[204:207], v[52:55]
    ds_read_b64_tr_b16 v[182:183], v8 offset:352
    v_mfma_f32_16x16x32_bf16 v[56:59], v[144:147], v[200:203], v[56:59]
    ds_read_b64_tr_b16 v[184:185], v8 offset:128
    v_mfma_f32_16x16x32_bf16 v[60:63], v[144:147], v[204:207], v[60:63]
    ds_read_b64_tr_b16 v[186:187], v8 offset:384
    v_mfma_f32_16x16x32_bf16 v[64:67], v[148:151], v[200:203], v[64:67]
    ds_read_b64_tr_b16 v[188:189], v8 offset:160
    v_mfma_f32_16x16x32_bf16 v[68:71], v[148:151], v[204:207], v[68:71]
    ds_read_b64_tr_b16 v[190:191], v8 offset:416
    v_mfma_f32_16x16x32_bf16 v[72:75], v[152:155], v[200:203], v[72:75]
    ds_read_b64_tr_b16 v[192:193], v8 offset:192
    v_mfma_f32_16x16x32_bf16 v[76:79], v[152:155], v[204:207], v[76:79]
    ds_read_b64_tr_b16 v[194:195], v8 offset:448
    v_mfma_f32_16x16x32_bf16 v[80:83], v[156:159], v[200:203], v[80:83]
    ds_read_b64_tr_b16 v[196:197], v8 offset:224
    v_mfma_f32_16x16x32_bf16 v[84:87], v[156:159], v[204:207], v[84:87]
    ds_read_b64_tr_b16 v[198:199], v8 offset:480
    v_mfma_f32_16x16x32_bf16 v[88:91], v[160:163], v[200:203], v[88:91]
    v_mfma_f32_16x16x32_bf16 v[92:95], v[160:163], v[204:207], v[92:95]
    v_mfma_f32_16x16x32_bf16 v[96:99], v[164:167], v[200:203], v[96:99]
    v_mfma_f32_16x16x32_bf16 v[100:103], v[164:167], v[204:207], v[100:103]
    s_waitcnt vmcnt(6) lgkmcnt(0)
    s_barrier
    s_add_u32 m0, s64, 0
    s_mov_b32 s26, 3145728
    buffer_load_dwordx4 v4, s[8:11], s26 offen offset:0 lds
    s_add_u32 m0, s64, 1056
    s_nop 0
    buffer_load_dwordx4 v5, s[8:11], s26 offen offset:0 lds
    s_add_u32 m0, s64, 8192
    s_nop 0
    buffer_load_dwordx4 v4, s[8:11], s26 offen offset:256 lds
    s_add_u32 m0, s64, 9248
    s_nop 0
    buffer_load_dwordx4 v5, s[8:11], s26 offen offset:256 lds
    s_add_u32 m0, s65, 8192
    s_mov_b32 s25, 131840
    buffer_load_dwordx4 v2, s[4:7], s25 offen lds
    s_add_u32 m0, s65, 12288
    s_nop 0
    buffer_load_dwordx4 v3, s[4:7], s25 offen lds
    ds_read_b128 v[216:219], v6 offset:16384
    ds_read_b128 v[220:223], v6 offset:18432
    ds_read_b128 v[224:227], v7 offset:16384
    ds_read_b128 v[228:231], v7 offset:18432
    ds_read_b64_tr_b16 v[136:137], v8 offset:16896
    ds_read_b64_tr_b16 v[138:139], v8 offset:17152
    ds_read_b64_tr_b16 v[140:141], v8 offset:16928
    ds_read_b64_tr_b16 v[142:143], v8 offset:17184
    v_mfma_f32_16x16x32_bf16 v[40:43], v[168:171], v[208:211], v[40:43]
    ds_read_b64_tr_b16 v[144:145], v8 offset:16960
    v_mfma_f32_16x16x32_bf16 v[44:47], v[168:171], v[212:215], v[44:47]
    ds_read_b64_tr_b16 v[146:147], v8 offset:17216
    v_mfma_f32_16x16x32_bf16 v[48:51], v[172:175], v[208:211], v[48:51]
    ds_read_b64_tr_b16 v[148:149], v8 offset:16992
    v_mfma_f32_16x16x32_bf16 v[52:55], v[172:175], v[212:215], v[52:55]
    ds_read_b64_tr_b16 v[150:151], v8 offset:17248
    v_mfma_f32_16x16x32_bf16 v[56:59], v[176:179], v[208:211], v[56:59]
    ds_read_b64_tr_b16 v[152:153], v8 offset:17024
    v_mfma_f32_16x16x32_bf16 v[60:63], v[176:179], v[212:215], v[60:63]
    ds_read_b64_tr_b16 v[154:155], v8 offset:17280
    v_mfma_f32_16x16x32_bf16 v[64:67], v[180:183], v[208:211], v[64:67]
    ds_read_b64_tr_b16 v[156:157], v8 offset:17056
    v_mfma_f32_16x16x32_bf16 v[68:71], v[180:183], v[212:215], v[68:71]
    ds_read_b64_tr_b16 v[158:159], v8 offset:17312
    v_mfma_f32_16x16x32_bf16 v[72:75], v[184:187], v[208:211], v[72:75]
    ds_read_b64_tr_b16 v[160:161], v8 offset:17088
    v_mfma_f32_16x16x32_bf16 v[76:79], v[184:187], v[212:215], v[76:79]
    ds_read_b64_tr_b16 v[162:163], v8 offset:17344
    v_mfma_f32_16x16x32_bf16 v[80:83], v[188:191], v[208:211], v[80:83]
    ds_read_b64_tr_b16 v[164:165], v8 offset:17120
    v_mfma_f32_16x16x32_bf16 v[84:87], v[188:191], v[212:215], v[84:87]
    ds_read_b64_tr_b16 v[166:167], v8 offset:17376
    v_mfma_f32_16x16x32_bf16 v[88:91], v[192:195], v[208:211], v[88:91]
    v_mfma_f32_16x16x32_bf16 v[92:95], v[192:195], v[212:215], v[92:95]
    v_mfma_f32_16x16x32_bf16 v[96:99], v[196:199], v[208:211], v[96:99]
    v_mfma_f32_16x16x32_bf16 v[100:103], v[196:199], v[212:215], v[100:103]
    s_waitcnt vmcnt(8) lgkmcnt(0)
    s_barrier
    s_add_u32 m0, s64, 16896
    s_mov_b32 s26, 3407872
    buffer_load_dwordx4 v4, s[8:11], s26 offen offset:0 lds
    s_add_u32 m0, s64, 17952
    s_nop 0
    buffer_load_dwordx4 v5, s[8:11], s26 offen offset:0 lds
    s_add_u32 m0, s64, 25088
    s_nop 0
    buffer_load_dwordx4 v4, s[8:11], s26 offen offset:256 lds
    s_add_u32 m0, s64, 26144
    s_nop 0
    buffer_load_dwordx4 v5, s[8:11], s26 offen offset:256 lds
    s_add_u32 m0, s65, 16384
    s_mov_b32 s25, 896
    buffer_load_dwordx4 v2, s[4:7], s25 offen lds
    s_add_u32 m0, s65, 20480
    s_nop 0
    buffer_load_dwordx4 v3, s[4:7], s25 offen lds
    ds_read_b64_tr_b16 v[168:169], v8 offset:33792
    ds_read_b64_tr_b16 v[170:171], v8 offset:34048
    ds_read_b64_tr_b16 v[172:173], v8 offset:33824
    ds_read_b64_tr_b16 v[174:175], v8 offset:34080
    v_mfma_f32_16x16x32_bf16 v[40:43], v[136:139], v[216:219], v[40:43]
    ds_read_b64_tr_b16 v[176:177], v8 offset:33856
    v_mfma_f32_16x16x32_bf16 v[44:47], v[136:139], v[220:223], v[44:47]
    ds_read_b64_tr_b16 v[178:179], v8 offset:34112
    v_mfma_f32_16x16x32_bf16 v[48:51], v[140:143], v[216:219], v[48:51]
    ds_read_b64_tr_b16 v[180:181], v8 offset:33888
    v_mfma_f32_16x16x32_bf16 v[52:55], v[140:143], v[220:223], v[52:55]
    ds_read_b64_tr_b16 v[182:183], v8 offset:34144
    v_mfma_f32_16x16x32_bf16 v[56:59], v[144:147], v[216:219], v[56:59]
    ds_read_b64_tr_b16 v[184:185], v8 offset:33920
    v_mfma_f32_16x16x32_bf16 v[60:63], v[144:147], v[220:223], v[60:63]
    ds_read_b64_tr_b16 v[186:187], v8 offset:34176
    v_mfma_f32_16x16x32_bf16 v[64:67], v[148:151], v[216:219], v[64:67]
    ds_read_b64_tr_b16 v[188:189], v8 offset:33952
    v_mfma_f32_16x16x32_bf16 v[68:71], v[148:151], v[220:223], v[68:71]
    ds_read_b64_tr_b16 v[190:191], v8 offset:34208
    v_mfma_f32_16x16x32_bf16 v[72:75], v[152:155], v[216:219], v[72:75]
    ds_read_b64_tr_b16 v[192:193], v8 offset:33984
    v_mfma_f32_16x16x32_bf16 v[76:79], v[152:155], v[220:223], v[76:79]
    ds_read_b64_tr_b16 v[194:195], v8 offset:34240
    v_mfma_f32_16x16x32_bf16 v[80:83], v[156:159], v[216:219], v[80:83]
    ds_read_b64_tr_b16 v[196:197], v8 offset:34016
    v_mfma_f32_16x16x32_bf16 v[84:87], v[156:159], v[220:223], v[84:87]
    ds_read_b64_tr_b16 v[198:199], v8 offset:34272
    v_mfma_f32_16x16x32_bf16 v[88:91], v[160:163], v[216:219], v[88:91]
    v_mfma_f32_16x16x32_bf16 v[92:95], v[160:163], v[220:223], v[92:95]
    v_mfma_f32_16x16x32_bf16 v[96:99], v[164:167], v[216:219], v[96:99]
    v_mfma_f32_16x16x32_bf16 v[100:103], v[164:167], v[220:223], v[100:103]
    s_waitcnt vmcnt(6) lgkmcnt(0)
    s_barrier
    s_add_u32 m0, s64, 33792
    s_mov_b32 s26, 3670016
    buffer_load_dwordx4 v4, s[8:11], s26 offen offset:0 lds
    s_add_u32 m0, s64, 34848
    s_nop 0
    buffer_load_dwordx4 v5, s[8:11], s26 offen offset:0 lds
    s_add_u32 m0, s64, 41984
    s_nop 0
    buffer_load_dwordx4 v4, s[8:11], s26 offen offset:256 lds
    s_add_u32 m0, s64, 43040
    s_nop 0
    buffer_load_dwordx4 v5, s[8:11], s26 offen offset:256 lds
    s_add_u32 m0, s65, 24576
    s_mov_b32 s25, 131968
    buffer_load_dwordx4 v2, s[4:7], s25 offen lds
    s_add_u32 m0, s65, 28672
    s_nop 0
    buffer_load_dwordx4 v3, s[4:7], s25 offen lds
    ds_read_b128 v[200:203], v6 offset:0
    ds_read_b128 v[204:207], v6 offset:2048
    ds_read_b128 v[208:211], v7 offset:0
    ds_read_b128 v[212:215], v7 offset:2048
    ds_read_b64_tr_b16 v[136:137], v8 offset:0
    ds_read_b64_tr_b16 v[138:139], v8 offset:256
    ds_read_b64_tr_b16 v[140:141], v8 offset:32
    ds_read_b64_tr_b16 v[142:143], v8 offset:288
    v_mfma_f32_16x16x32_bf16 v[40:43], v[168:171], v[224:227], v[40:43]
    ds_read_b64_tr_b16 v[144:145], v8 offset:64
    v_mfma_f32_16x16x32_bf16 v[44:47], v[168:171], v[228:231], v[44:47]
    ds_read_b64_tr_b16 v[146:147], v8 offset:320
    v_mfma_f32_16x16x32_bf16 v[48:51], v[172:175], v[224:227], v[48:51]
    ds_read_b64_tr_b16 v[148:149], v8 offset:96
    v_mfma_f32_16x16x32_bf16 v[52:55], v[172:175], v[228:231], v[52:55]
    ds_read_b64_tr_b16 v[150:151], v8 offset:352
    v_mfma_f32_16x16x32_bf16 v[56:59], v[176:179], v[224:227], v[56:59]
    ds_read_b64_tr_b16 v[152:153], v8 offset:128
    v_mfma_f32_16x16x32_bf16 v[60:63], v[176:179], v[228:231], v[60:63]
    ds_read_b64_tr_b16 v[154:155], v8 offset:384
    v_mfma_f32_16x16x32_bf16 v[64:67], v[180:183], v[224:227], v[64:67]
    ds_read_b64_tr_b16 v[156:157], v8 offset:160
    v_mfma_f32_16x16x32_bf16 v[68:71], v[180:183], v[228:231], v[68:71]
    ds_read_b64_tr_b16 v[158:159], v8 offset:416
    v_mfma_f32_16x16x32_bf16 v[72:75], v[184:187], v[224:227], v[72:75]
    ds_read_b64_tr_b16 v[160:161], v8 offset:192
    v_mfma_f32_16x16x32_bf16 v[76:79], v[184:187], v[228:231], v[76:79]
    ds_read_b64_tr_b16 v[162:163], v8 offset:448
    v_mfma_f32_16x16x32_bf16 v[80:83], v[188:191], v[224:227], v[80:83]
    ds_read_b64_tr_b16 v[164:165], v8 offset:224
    v_mfma_f32_16x16x32_bf16 v[84:87], v[188:191], v[228:231], v[84:87]
    ds_read_b64_tr_b16 v[166:167], v8 offset:480
    v_mfma_f32_16x16x32_bf16 v[88:91], v[192:195], v[224:227], v[88:91]
    v_mfma_f32_16x16x32_bf16 v[92:95], v[192:195], v[228:231], v[92:95]
    v_mfma_f32_16x16x32_bf16 v[96:99], v[196:199], v[224:227], v[96:99]
    v_mfma_f32_16x16x32_bf16 v[100:103], v[196:199], v[228:231], v[100:103]
    s_waitcnt vmcnt(8) lgkmcnt(0)
    s_barrier
    s_add_u32 m0, s64, 0
    s_mov_b32 s26, 3932160
    buffer_load_dwordx4 v4, s[8:11], s26 offen offset:0 lds
    s_add_u32 m0, s64, 1056
    s_nop 0
    buffer_load_dwordx4 v5, s[8:11], s26 offen offset:0 lds
    s_add_u32 m0, s64, 8192
    s_nop 0
    buffer_load_dwordx4 v4, s[8:11], s26 offen offset:256 lds
    s_add_u32 m0, s64, 9248
    s_nop 0
    buffer_load_dwordx4 v5, s[8:11], s26 offen offset:256 lds
    s_add_u32 m0, s65, 0
    s_mov_b32 s25, 1024
    buffer_load_dwordx4 v2, s[4:7], s25 offen lds
    s_add_u32 m0, s65, 4096
    s_nop 0
    buffer_load_dwordx4 v3, s[4:7], s25 offen lds
    ds_read_b64_tr_b16 v[168:169], v8 offset:16896
    ds_read_b64_tr_b16 v[170:171], v8 offset:17152
    ds_read_b64_tr_b16 v[172:173], v8 offset:16928
    ds_read_b64_tr_b16 v[174:175], v8 offset:17184
    v_mfma_f32_16x16x32_bf16 v[40:43], v[136:139], v[200:203], v[40:43]
    ds_read_b64_tr_b16 v[176:177], v8 offset:16960
    v_mfma_f32_16x16x32_bf16 v[44:47], v[136:139], v[204:207], v[44:47]
    ds_read_b64_tr_b16 v[178:179], v8 offset:17216
    v_mfma_f32_16x16x32_bf16 v[48:51], v[140:143], v[200:203], v[48:51]
    ds_read_b64_tr_b16 v[180:181], v8 offset:16992
    v_mfma_f32_16x16x32_bf16 v[52:55], v[140:143], v[204:207], v[52:55]
    ds_read_b64_tr_b16 v[182:183], v8 offset:17248
    v_mfma_f32_16x16x32_bf16 v[56:59], v[144:147], v[200:203], v[56:59]
    ds_read_b64_tr_b16 v[184:185], v8 offset:17024
    v_mfma_f32_16x16x32_bf16 v[60:63], v[144:147], v[204:207], v[60:63]
    ds_read_b64_tr_b16 v[186:187], v8 offset:17280
    v_mfma_f32_16x16x32_bf16 v[64:67], v[148:151], v[200:203], v[64:67]
    ds_read_b64_tr_b16 v[188:189], v8 offset:17056
    v_mfma_f32_16x16x32_bf16 v[68:71], v[148:151], v[204:207], v[68:71]
    ds_read_b64_tr_b16 v[190:191], v8 offset:17312
    v_mfma_f32_16x16x32_bf16 v[72:75], v[152:155], v[200:203], v[72:75]
    ds_read_b64_tr_b16 v[192:193], v8 offset:17088
    v_mfma_f32_16x16x32_bf16 v[76:79], v[152:155], v[204:207], v[76:79]
    ds_read_b64_tr_b16 v[194:195], v8 offset:17344
    v_mfma_f32_16x16x32_bf16 v[80:83], v[156:159], v[200:203], v[80:83]
    ds_read_b64_tr_b16 v[196:197], v8 offset:17120
    v_mfma_f32_16x16x32_bf16 v[84:87], v[156:159], v[204:207], v[84:87]
    ds_read_b64_tr_b16 v[198:199], v8 offset:17376
    v_mfma_f32_16x16x32_bf16 v[88:91], v[160:163], v[200:203], v[88:91]
    v_mfma_f32_16x16x32_bf16 v[92:95], v[160:163], v[204:207], v[92:95]
    v_mfma_f32_16x16x32_bf16 v[96:99], v[164:167], v[200:203], v[96:99]
    v_mfma_f32_16x16x32_bf16 v[100:103], v[164:167], v[204:207], v[100:103]
    s_waitcnt vmcnt(6) lgkmcnt(0)
    s_barrier
    s_add_u32 m0, s64, 16896
    s_mov_b32 s26, 4194304
    buffer_load_dwordx4 v4, s[8:11], s26 offen offset:0 lds
    s_add_u32 m0, s64, 17952
    s_nop 0
    buffer_load_dwordx4 v5, s[8:11], s26 offen offset:0 lds
    s_add_u32 m0, s64, 25088
    s_nop 0
    buffer_load_dwordx4 v4, s[8:11], s26 offen offset:256 lds
    s_add_u32 m0, s64, 26144
    s_nop 0
    buffer_load_dwordx4 v5, s[8:11], s26 offen offset:256 lds
    s_add_u32 m0, s65, 8192
    s_mov_b32 s25, 132096
    buffer_load_dwordx4 v2, s[4:7], s25 offen lds
    s_add_u32 m0, s65, 12288
    s_nop 0
    buffer_load_dwordx4 v3, s[4:7], s25 offen lds
    ds_read_b128 v[216:219], v6 offset:16384
    ds_read_b128 v[220:223], v6 offset:18432
    ds_read_b128 v[224:227], v7 offset:16384
    ds_read_b128 v[228:231], v7 offset:18432
    ds_read_b64_tr_b16 v[136:137], v8 offset:33792
    ds_read_b64_tr_b16 v[138:139], v8 offset:34048
    ds_read_b64_tr_b16 v[140:141], v8 offset:33824
    ds_read_b64_tr_b16 v[142:143], v8 offset:34080
    v_mfma_f32_16x16x32_bf16 v[40:43], v[168:171], v[208:211], v[40:43]
    ds_read_b64_tr_b16 v[144:145], v8 offset:33856
    v_mfma_f32_16x16x32_bf16 v[44:47], v[168:171], v[212:215], v[44:47]
    ds_read_b64_tr_b16 v[146:147], v8 offset:34112
    v_mfma_f32_16x16x32_bf16 v[48:51], v[172:175], v[208:211], v[48:51]
    ds_read_b64_tr_b16 v[148:149], v8 offset:33888
    v_mfma_f32_16x16x32_bf16 v[52:55], v[172:175], v[212:215], v[52:55]
    ds_read_b64_tr_b16 v[150:151], v8 offset:34144
    v_mfma_f32_16x16x32_bf16 v[56:59], v[176:179], v[208:211], v[56:59]
    ds_read_b64_tr_b16 v[152:153], v8 offset:33920
    v_mfma_f32_16x16x32_bf16 v[60:63], v[176:179], v[212:215], v[60:63]
    ds_read_b64_tr_b16 v[154:155], v8 offset:34176
    v_mfma_f32_16x16x32_bf16 v[64:67], v[180:183], v[208:211], v[64:67]
    ds_read_b64_tr_b16 v[156:157], v8 offset:33952
    v_mfma_f32_16x16x32_bf16 v[68:71], v[180:183], v[212:215], v[68:71]
    ds_read_b64_tr_b16 v[158:159], v8 offset:34208
    v_mfma_f32_16x16x32_bf16 v[72:75], v[184:187], v[208:211], v[72:75]
    ds_read_b64_tr_b16 v[160:161], v8 offset:33984
    v_mfma_f32_16x16x32_bf16 v[76:79], v[184:187], v[212:215], v[76:79]
    ds_read_b64_tr_b16 v[162:163], v8 offset:34240
    v_mfma_f32_16x16x32_bf16 v[80:83], v[188:191], v[208:211], v[80:83]
    ds_read_b64_tr_b16 v[164:165], v8 offset:34016
    v_mfma_f32_16x16x32_bf16 v[84:87], v[188:191], v[212:215], v[84:87]
    ds_read_b64_tr_b16 v[166:167], v8 offset:34272
    v_mfma_f32_16x16x32_bf16 v[88:91], v[192:195], v[208:211], v[88:91]
    v_mfma_f32_16x16x32_bf16 v[92:95], v[192:195], v[212:215], v[92:95]
    v_mfma_f32_16x16x32_bf16 v[96:99], v[196:199], v[208:211], v[96:99]
    v_mfma_f32_16x16x32_bf16 v[100:103], v[196:199], v[212:215], v[100:103]
    s_waitcnt vmcnt(8) lgkmcnt(0)
    s_barrier
    s_add_u32 m0, s64, 33792
    s_mov_b32 s26, 4456448
    buffer_load_dwordx4 v4, s[8:11], s26 offen offset:0 lds
    s_add_u32 m0, s64, 34848
    s_nop 0
    buffer_load_dwordx4 v5, s[8:11], s26 offen offset:0 lds
    s_add_u32 m0, s64, 41984
    s_nop 0
    buffer_load_dwordx4 v4, s[8:11], s26 offen offset:256 lds
    s_add_u32 m0, s64, 43040
    s_nop 0
    buffer_load_dwordx4 v5, s[8:11], s26 offen offset:256 lds
    s_add_u32 m0, s65, 16384
    s_mov_b32 s25, 1152
    buffer_load_dwordx4 v2, s[4:7], s25 offen lds
    s_add_u32 m0, s65, 20480
    s_nop 0
    buffer_load_dwordx4 v3, s[4:7], s25 offen lds
    ds_read_b64_tr_b16 v[168:169], v8 offset:0
    ds_read_b64_tr_b16 v[170:171], v8 offset:256
    ds_read_b64_tr_b16 v[172:173], v8 offset:32
    ds_read_b64_tr_b16 v[174:175], v8 offset:288
    v_mfma_f32_16x16x32_bf16 v[40:43], v[136:139], v[216:219], v[40:43]
    ds_read_b64_tr_b16 v[176:177], v8 offset:64
    v_mfma_f32_16x16x32_bf16 v[44:47], v[136:139], v[220:223], v[44:47]
    ds_read_b64_tr_b16 v[178:179], v8 offset:320
    v_mfma_f32_16x16x32_bf16 v[48:51], v[140:143], v[216:219], v[48:51]
    ds_read_b64_tr_b16 v[180:181], v8 offset:96
    v_mfma_f32_16x16x32_bf16 v[52:55], v[140:143], v[220:223], v[52:55]
    ds_read_b64_tr_b16 v[182:183], v8 offset:352
    v_mfma_f32_16x16x32_bf16 v[56:59], v[144:147], v[216:219], v[56:59]
    ds_read_b64_tr_b16 v[184:185], v8 offset:128
    v_mfma_f32_16x16x32_bf16 v[60:63], v[144:147], v[220:223], v[60:63]
    ds_read_b64_tr_b16 v[186:187], v8 offset:384
    v_mfma_f32_16x16x32_bf16 v[64:67], v[148:151], v[216:219], v[64:67]
    ds_read_b64_tr_b16 v[188:189], v8 offset:160
    v_mfma_f32_16x16x32_bf16 v[68:71], v[148:151], v[220:223], v[68:71]
    ds_read_b64_tr_b16 v[190:191], v8 offset:416
    v_mfma_f32_16x16x32_bf16 v[72:75], v[152:155], v[216:219], v[72:75]
    ds_read_b64_tr_b16 v[192:193], v8 offset:192
    v_mfma_f32_16x16x32_bf16 v[76:79], v[152:155], v[220:223], v[76:79]
    ds_read_b64_tr_b16 v[194:195], v8 offset:448
    v_mfma_f32_16x16x32_bf16 v[80:83], v[156:159], v[216:219], v[80:83]
    ds_read_b64_tr_b16 v[196:197], v8 offset:224
    v_mfma_f32_16x16x32_bf16 v[84:87], v[156:159], v[220:223], v[84:87]
    ds_read_b64_tr_b16 v[198:199], v8 offset:480
    v_mfma_f32_16x16x32_bf16 v[88:91], v[160:163], v[216:219], v[88:91]
    v_mfma_f32_16x16x32_bf16 v[92:95], v[160:163], v[220:223], v[92:95]
    v_mfma_f32_16x16x32_bf16 v[96:99], v[164:167], v[216:219], v[96:99]
    v_mfma_f32_16x16x32_bf16 v[100:103], v[164:167], v[220:223], v[100:103]
    s_waitcnt vmcnt(6) lgkmcnt(0)
    s_barrier
    s_add_u32 m0, s64, 0
    s_mov_b32 s26, 4718592
    buffer_load_dwordx4 v4, s[8:11], s26 offen offset:0 lds
    s_add_u32 m0, s64, 1056
    s_nop 0
    buffer_load_dwordx4 v5, s[8:11], s26 offen offset:0 lds
    s_add_u32 m0, s64, 8192
    s_nop 0
    buffer_load_dwordx4 v4, s[8:11], s26 offen offset:256 lds
    s_add_u32 m0, s64, 9248
    s_nop 0
    buffer_load_dwordx4 v5, s[8:11], s26 offen offset:256 lds
    s_add_u32 m0, s65, 24576
    s_mov_b32 s25, 132224
    buffer_load_dwordx4 v2, s[4:7], s25 offen lds
    s_add_u32 m0, s65, 28672
    s_nop 0
    buffer_load_dwordx4 v3, s[4:7], s25 offen lds
    ds_read_b128 v[200:203], v6 offset:0
    ds_read_b128 v[204:207], v6 offset:2048
    ds_read_b128 v[208:211], v7 offset:0
    ds_read_b128 v[212:215], v7 offset:2048
    ds_read_b64_tr_b16 v[136:137], v8 offset:16896
    ds_read_b64_tr_b16 v[138:139], v8 offset:17152
    ds_read_b64_tr_b16 v[140:141], v8 offset:16928
    ds_read_b64_tr_b16 v[142:143], v8 offset:17184
    v_mfma_f32_16x16x32_bf16 v[40:43], v[168:171], v[224:227], v[40:43]
    ds_read_b64_tr_b16 v[144:145], v8 offset:16960
    v_mfma_f32_16x16x32_bf16 v[44:47], v[168:171], v[228:231], v[44:47]
    ds_read_b64_tr_b16 v[146:147], v8 offset:17216
    v_mfma_f32_16x16x32_bf16 v[48:51], v[172:175], v[224:227], v[48:51]
    ds_read_b64_tr_b16 v[148:149], v8 offset:16992
    v_mfma_f32_16x16x32_bf16 v[52:55], v[172:175], v[228:231], v[52:55]
    ds_read_b64_tr_b16 v[150:151], v8 offset:17248
    v_mfma_f32_16x16x32_bf16 v[56:59], v[176:179], v[224:227], v[56:59]
    ds_read_b64_tr_b16 v[152:153], v8 offset:17024
    v_mfma_f32_16x16x32_bf16 v[60:63], v[176:179], v[228:231], v[60:63]
    ds_read_b64_tr_b16 v[154:155], v8 offset:17280
    v_mfma_f32_16x16x32_bf16 v[64:67], v[180:183], v[224:227], v[64:67]
    ds_read_b64_tr_b16 v[156:157], v8 offset:17056
    v_mfma_f32_16x16x32_bf16 v[68:71], v[180:183], v[228:231], v[68:71]
    ds_read_b64_tr_b16 v[158:159], v8 offset:17312
    v_mfma_f32_16x16x32_bf16 v[72:75], v[184:187], v[224:227], v[72:75]
    ds_read_b64_tr_b16 v[160:161], v8 offset:17088
    v_mfma_f32_16x16x32_bf16 v[76:79], v[184:187], v[228:231], v[76:79]
    ds_read_b64_tr_b16 v[162:163], v8 offset:17344
    v_mfma_f32_16x16x32_bf16 v[80:83], v[188:191], v[224:227], v[80:83]
    ds_read_b64_tr_b16 v[164:165], v8 offset:17120
    v_mfma_f32_16x16x32_bf16 v[84:87], v[188:191], v[228:231], v[84:87]
    ds_read_b64_tr_b16 v[166:167], v8 offset:17376
    v_mfma_f32_16x16x32_bf16 v[88:91], v[192:195], v[224:227], v[88:91]
    v_mfma_f32_16x16x32_bf16 v[92:95], v[192:195], v[228:231], v[92:95]
    v_mfma_f32_16x16x32_bf16 v[96:99], v[196:199], v[224:227], v[96:99]
    v_mfma_f32_16x16x32_bf16 v[100:103], v[196:199], v[228:231], v[100:103]
    s_waitcnt vmcnt(8) lgkmcnt(0)
    s_barrier
    s_add_u32 m0, s64, 16896
    s_mov_b32 s26, 4980736
    buffer_load_dwordx4 v4, s[8:11], s26 offen offset:0 lds
    s_add_u32 m0, s64, 17952
    s_nop 0
    buffer_load_dwordx4 v5, s[8:11], s26 offen offset:0 lds
    s_add_u32 m0, s64, 25088
    s_nop 0
    buffer_load_dwordx4 v4, s[8:11], s26 offen offset:256 lds
    s_add_u32 m0, s64, 26144
    s_nop 0
    buffer_load_dwordx4 v5, s[8:11], s26 offen offset:256 lds
    s_add_u32 m0, s65, 0
    s_mov_b32 s25, 1280
    buffer_load_dwordx4 v2, s[4:7], s25 offen lds
    s_add_u32 m0, s65, 4096
    s_nop 0
    buffer_load_dwordx4 v3, s[4:7], s25 offen lds
    ds_read_b64_tr_b16 v[168:169], v8 offset:33792
    ds_read_b64_tr_b16 v[170:171], v8 offset:34048
    ds_read_b64_tr_b16 v[172:173], v8 offset:33824
    ds_read_b64_tr_b16 v[174:175], v8 offset:34080
    v_mfma_f32_16x16x32_bf16 v[40:43], v[136:139], v[200:203], v[40:43]
    ds_read_b64_tr_b16 v[176:177], v8 offset:33856
    v_mfma_f32_16x16x32_bf16 v[44:47], v[136:139], v[204:207], v[44:47]
    ds_read_b64_tr_b16 v[178:179], v8 offset:34112
    v_mfma_f32_16x16x32_bf16 v[48:51], v[140:143], v[200:203], v[48:51]
    ds_read_b64_tr_b16 v[180:181], v8 offset:33888
    v_mfma_f32_16x16x32_bf16 v[52:55], v[140:143], v[204:207], v[52:55]
    ds_read_b64_tr_b16 v[182:183], v8 offset:34144
    v_mfma_f32_16x16x32_bf16 v[56:59], v[144:147], v[200:203], v[56:59]
    ds_read_b64_tr_b16 v[184:185], v8 offset:33920
    v_mfma_f32_16x16x32_bf16 v[60:63], v[144:147], v[204:207], v[60:63]
    ds_read_b64_tr_b16 v[186:187], v8 offset:34176
    v_mfma_f32_16x16x32_bf16 v[64:67], v[148:151], v[200:203], v[64:67]
    ds_read_b64_tr_b16 v[188:189], v8 offset:33952
    v_mfma_f32_16x16x32_bf16 v[68:71], v[148:151], v[204:207], v[68:71]
    ds_read_b64_tr_b16 v[190:191], v8 offset:34208
    v_mfma_f32_16x16x32_bf16 v[72:75], v[152:155], v[200:203], v[72:75]
    ds_read_b64_tr_b16 v[192:193], v8 offset:33984
    v_mfma_f32_16x16x32_bf16 v[76:79], v[152:155], v[204:207], v[76:79]
    ds_read_b64_tr_b16 v[194:195], v8 offset:34240
    v_mfma_f32_16x16x32_bf16 v[80:83], v[156:159], v[200:203], v[80:83]
    ds_read_b64_tr_b16 v[196:197], v8 offset:34016
    v_mfma_f32_16x16x32_bf16 v[84:87], v[156:159], v[204:207], v[84:87]
    ds_read_b64_tr_b16 v[198:199], v8 offset:34272
    v_mfma_f32_16x16x32_bf16 v[88:91], v[160:163], v[200:203], v[88:91]
    v_mfma_f32_16x16x32_bf16 v[92:95], v[160:163], v[204:207], v[92:95]
    v_mfma_f32_16x16x32_bf16 v[96:99], v[164:167], v[200:203], v[96:99]
    v_mfma_f32_16x16x32_bf16 v[100:103], v[164:167], v[204:207], v[100:103]
    s_waitcnt vmcnt(6) lgkmcnt(0)
    s_barrier
    s_add_u32 m0, s64, 33792
    s_mov_b32 s26, 5242880
    buffer_load_dwordx4 v4, s[8:11], s26 offen offset:0 lds
    s_add_u32 m0, s64, 34848
    s_nop 0
    buffer_load_dwordx4 v5, s[8:11], s26 offen offset:0 lds
    s_add_u32 m0, s64, 41984
    s_nop 0
    buffer_load_dwordx4 v4, s[8:11], s26 offen offset:256 lds
    s_add_u32 m0, s64, 43040
    s_nop 0
    buffer_load_dwordx4 v5, s[8:11], s26 offen offset:256 lds
    s_add_u32 m0, s65, 8192
    s_mov_b32 s25, 132352
    buffer_load_dwordx4 v2, s[4:7], s25 offen lds
    s_add_u32 m0, s65, 12288
    s_nop 0
    buffer_load_dwordx4 v3, s[4:7], s25 offen lds
    ds_read_b128 v[216:219], v6 offset:16384
    ds_read_b128 v[220:223], v6 offset:18432
    ds_read_b128 v[224:227], v7 offset:16384
    ds_read_b128 v[228:231], v7 offset:18432
    ds_read_b64_tr_b16 v[136:137], v8 offset:0
    ds_read_b64_tr_b16 v[138:139], v8 offset:256
    ds_read_b64_tr_b16 v[140:141], v8 offset:32
    ds_read_b64_tr_b16 v[142:143], v8 offset:288
    v_mfma_f32_16x16x32_bf16 v[40:43], v[168:171], v[208:211], v[40:43]
    ds_read_b64_tr_b16 v[144:145], v8 offset:64
    v_mfma_f32_16x16x32_bf16 v[44:47], v[168:171], v[212:215], v[44:47]
    ds_read_b64_tr_b16 v[146:147], v8 offset:320
    v_mfma_f32_16x16x32_bf16 v[48:51], v[172:175], v[208:211], v[48:51]
    ds_read_b64_tr_b16 v[148:149], v8 offset:96
    v_mfma_f32_16x16x32_bf16 v[52:55], v[172:175], v[212:215], v[52:55]
    ds_read_b64_tr_b16 v[150:151], v8 offset:352
    v_mfma_f32_16x16x32_bf16 v[56:59], v[176:179], v[208:211], v[56:59]
    ds_read_b64_tr_b16 v[152:153], v8 offset:128
    v_mfma_f32_16x16x32_bf16 v[60:63], v[176:179], v[212:215], v[60:63]
    ds_read_b64_tr_b16 v[154:155], v8 offset:384
    v_mfma_f32_16x16x32_bf16 v[64:67], v[180:183], v[208:211], v[64:67]
    ds_read_b64_tr_b16 v[156:157], v8 offset:160
    v_mfma_f32_16x16x32_bf16 v[68:71], v[180:183], v[212:215], v[68:71]
    ds_read_b64_tr_b16 v[158:159], v8 offset:416
    v_mfma_f32_16x16x32_bf16 v[72:75], v[184:187], v[208:211], v[72:75]
    ds_read_b64_tr_b16 v[160:161], v8 offset:192
    v_mfma_f32_16x16x32_bf16 v[76:79], v[184:187], v[212:215], v[76:79]
    ds_read_b64_tr_b16 v[162:163], v8 offset:448
    v_mfma_f32_16x16x32_bf16 v[80:83], v[188:191], v[208:211], v[80:83]
    ds_read_b64_tr_b16 v[164:165], v8 offset:224
    v_mfma_f32_16x16x32_bf16 v[84:87], v[188:191], v[212:215], v[84:87]
    ds_read_b64_tr_b16 v[166:167], v8 offset:480
    v_mfma_f32_16x16x32_bf16 v[88:91], v[192:195], v[208:211], v[88:91]
    v_mfma_f32_16x16x32_bf16 v[92:95], v[192:195], v[212:215], v[92:95]
    v_mfma_f32_16x16x32_bf16 v[96:99], v[196:199], v[208:211], v[96:99]
    v_mfma_f32_16x16x32_bf16 v[100:103], v[196:199], v[212:215], v[100:103]
    s_waitcnt vmcnt(8) lgkmcnt(0)
    s_barrier
    s_add_u32 m0, s64, 0
    s_mov_b32 s26, 5505024
    buffer_load_dwordx4 v4, s[8:11], s26 offen offset:0 lds
    s_add_u32 m0, s64, 1056
    s_nop 0
    buffer_load_dwordx4 v5, s[8:11], s26 offen offset:0 lds
    s_add_u32 m0, s64, 8192
    s_nop 0
    buffer_load_dwordx4 v4, s[8:11], s26 offen offset:256 lds
    s_add_u32 m0, s64, 9248
    s_nop 0
    buffer_load_dwordx4 v5, s[8:11], s26 offen offset:256 lds
    s_add_u32 m0, s65, 16384
    s_mov_b32 s25, 1408
    buffer_load_dwordx4 v2, s[4:7], s25 offen lds
    s_add_u32 m0, s65, 20480
    s_nop 0
    buffer_load_dwordx4 v3, s[4:7], s25 offen lds
    ds_read_b64_tr_b16 v[168:169], v8 offset:16896
    ds_read_b64_tr_b16 v[170:171], v8 offset:17152
    ds_read_b64_tr_b16 v[172:173], v8 offset:16928
    ds_read_b64_tr_b16 v[174:175], v8 offset:17184
    v_mfma_f32_16x16x32_bf16 v[40:43], v[136:139], v[216:219], v[40:43]
    ds_read_b64_tr_b16 v[176:177], v8 offset:16960
    v_mfma_f32_16x16x32_bf16 v[44:47], v[136:139], v[220:223], v[44:47]
    ds_read_b64_tr_b16 v[178:179], v8 offset:17216
    v_mfma_f32_16x16x32_bf16 v[48:51], v[140:143], v[216:219], v[48:51]
    ds_read_b64_tr_b16 v[180:181], v8 offset:16992
    v_mfma_f32_16x16x32_bf16 v[52:55], v[140:143], v[220:223], v[52:55]
    ds_read_b64_tr_b16 v[182:183], v8 offset:17248
    v_mfma_f32_16x16x32_bf16 v[56:59], v[144:147], v[216:219], v[56:59]
    ds_read_b64_tr_b16 v[184:185], v8 offset:17024
    v_mfma_f32_16x16x32_bf16 v[60:63], v[144:147], v[220:223], v[60:63]
    ds_read_b64_tr_b16 v[186:187], v8 offset:17280
    v_mfma_f32_16x16x32_bf16 v[64:67], v[148:151], v[216:219], v[64:67]
    ds_read_b64_tr_b16 v[188:189], v8 offset:17056
    v_mfma_f32_16x16x32_bf16 v[68:71], v[148:151], v[220:223], v[68:71]
    ds_read_b64_tr_b16 v[190:191], v8 offset:17312
    v_mfma_f32_16x16x32_bf16 v[72:75], v[152:155], v[216:219], v[72:75]
    ds_read_b64_tr_b16 v[192:193], v8 offset:17088
    v_mfma_f32_16x16x32_bf16 v[76:79], v[152:155], v[220:223], v[76:79]
    ds_read_b64_tr_b16 v[194:195], v8 offset:17344
    v_mfma_f32_16x16x32_bf16 v[80:83], v[156:159], v[216:219], v[80:83]
    ds_read_b64_tr_b16 v[196:197], v8 offset:17120
    v_mfma_f32_16x16x32_bf16 v[84:87], v[156:159], v[220:223], v[84:87]
    ds_read_b64_tr_b16 v[198:199], v8 offset:17376
    v_mfma_f32_16x16x32_bf16 v[88:91], v[160:163], v[216:219], v[88:91]
    v_mfma_f32_16x16x32_bf16 v[92:95], v[160:163], v[220:223], v[92:95]
    v_mfma_f32_16x16x32_bf16 v[96:99], v[164:167], v[216:219], v[96:99]
    v_mfma_f32_16x16x32_bf16 v[100:103], v[164:167], v[220:223], v[100:103]
    s_waitcnt vmcnt(6) lgkmcnt(0)
    s_barrier
    s_add_u32 m0, s64, 16896
    s_mov_b32 s26, 5767168
    buffer_load_dwordx4 v4, s[8:11], s26 offen offset:0 lds
    s_add_u32 m0, s64, 17952
    s_nop 0
    buffer_load_dwordx4 v5, s[8:11], s26 offen offset:0 lds
    s_add_u32 m0, s64, 25088
    s_nop 0
    buffer_load_dwordx4 v4, s[8:11], s26 offen offset:256 lds
    s_add_u32 m0, s64, 26144
    s_nop 0
    buffer_load_dwordx4 v5, s[8:11], s26 offen offset:256 lds
    s_add_u32 m0, s65, 24576
    s_mov_b32 s25, 132480
    buffer_load_dwordx4 v2, s[4:7], s25 offen lds
    s_add_u32 m0, s65, 28672
    s_nop 0
    buffer_load_dwordx4 v3, s[4:7], s25 offen lds
    ds_read_b128 v[200:203], v6 offset:0
    ds_read_b128 v[204:207], v6 offset:2048
    ds_read_b128 v[208:211], v7 offset:0
    ds_read_b128 v[212:215], v7 offset:2048
    ds_read_b64_tr_b16 v[136:137], v8 offset:33792
    ds_read_b64_tr_b16 v[138:139], v8 offset:34048
    ds_read_b64_tr_b16 v[140:141], v8 offset:33824
    ds_read_b64_tr_b16 v[142:143], v8 offset:34080
    v_mfma_f32_16x16x32_bf16 v[40:43], v[168:171], v[224:227], v[40:43]
    ds_read_b64_tr_b16 v[144:145], v8 offset:33856
    v_mfma_f32_16x16x32_bf16 v[44:47], v[168:171], v[228:231], v[44:47]
    ds_read_b64_tr_b16 v[146:147], v8 offset:34112
    v_mfma_f32_16x16x32_bf16 v[48:51], v[172:175], v[224:227], v[48:51]
    ds_read_b64_tr_b16 v[148:149], v8 offset:33888
    v_mfma_f32_16x16x32_bf16 v[52:55], v[172:175], v[228:231], v[52:55]
    ds_read_b64_tr_b16 v[150:151], v8 offset:34144
    v_mfma_f32_16x16x32_bf16 v[56:59], v[176:179], v[224:227], v[56:59]
    ds_read_b64_tr_b16 v[152:153], v8 offset:33920
    v_mfma_f32_16x16x32_bf16 v[60:63], v[176:179], v[228:231], v[60:63]
    ds_read_b64_tr_b16 v[154:155], v8 offset:34176
    v_mfma_f32_16x16x32_bf16 v[64:67], v[180:183], v[224:227], v[64:67]
    ds_read_b64_tr_b16 v[156:157], v8 offset:33952
    v_mfma_f32_16x16x32_bf16 v[68:71], v[180:183], v[228:231], v[68:71]
    ds_read_b64_tr_b16 v[158:159], v8 offset:34208
    v_mfma_f32_16x16x32_bf16 v[72:75], v[184:187], v[224:227], v[72:75]
    ds_read_b64_tr_b16 v[160:161], v8 offset:33984
    v_mfma_f32_16x16x32_bf16 v[76:79], v[184:187], v[228:231], v[76:79]
    ds_read_b64_tr_b16 v[162:163], v8 offset:34240
    v_mfma_f32_16x16x32_bf16 v[80:83], v[188:191], v[224:227], v[80:83]
    ds_read_b64_tr_b16 v[164:165], v8 offset:34016
    v_mfma_f32_16x16x32_bf16 v[84:87], v[188:191], v[228:231], v[84:87]
    ds_read_b64_tr_b16 v[166:167], v8 offset:34272
    v_mfma_f32_16x16x32_bf16 v[88:91], v[192:195], v[224:227], v[88:91]
    v_mfma_f32_16x16x32_bf16 v[92:95], v[192:195], v[228:231], v[92:95]
    v_mfma_f32_16x16x32_bf16 v[96:99], v[196:199], v[224:227], v[96:99]
    v_mfma_f32_16x16x32_bf16 v[100:103], v[196:199], v[228:231], v[100:103]
    s_waitcnt vmcnt(8) lgkmcnt(0)
    s_barrier
    s_add_u32 m0, s64, 33792
    s_mov_b32 s26, 6029312
    buffer_load_dwordx4 v4, s[8:11], s26 offen offset:0 lds
    s_add_u32 m0, s64, 34848
    s_nop 0
    buffer_load_dwordx4 v5, s[8:11], s26 offen offset:0 lds
    s_add_u32 m0, s64, 41984
    s_nop 0
    buffer_load_dwordx4 v4, s[8:11], s26 offen offset:256 lds
    s_add_u32 m0, s64, 43040
    s_nop 0
    buffer_load_dwordx4 v5, s[8:11], s26 offen offset:256 lds
    s_add_u32 m0, s65, 0
    s_mov_b32 s25, 1536
    buffer_load_dwordx4 v2, s[4:7], s25 offen lds
    s_add_u32 m0, s65, 4096
    s_nop 0
    buffer_load_dwordx4 v3, s[4:7], s25 offen lds
    ds_read_b64_tr_b16 v[168:169], v8 offset:0
    ds_read_b64_tr_b16 v[170:171], v8 offset:256
    ds_read_b64_tr_b16 v[172:173], v8 offset:32
    ds_read_b64_tr_b16 v[174:175], v8 offset:288
    v_mfma_f32_16x16x32_bf16 v[40:43], v[136:139], v[200:203], v[40:43]
    ds_read_b64_tr_b16 v[176:177], v8 offset:64
    v_mfma_f32_16x16x32_bf16 v[44:47], v[136:139], v[204:207], v[44:47]
    ds_read_b64_tr_b16 v[178:179], v8 offset:320
    v_mfma_f32_16x16x32_bf16 v[48:51], v[140:143], v[200:203], v[48:51]
    ds_read_b64_tr_b16 v[180:181], v8 offset:96
    v_mfma_f32_16x16x32_bf16 v[52:55], v[140:143], v[204:207], v[52:55]
    ds_read_b64_tr_b16 v[182:183], v8 offset:352
    v_mfma_f32_16x16x32_bf16 v[56:59], v[144:147], v[200:203], v[56:59]
    ds_read_b64_tr_b16 v[184:185], v8 offset:128
    v_mfma_f32_16x16x32_bf16 v[60:63], v[144:147], v[204:207], v[60:63]
    ds_read_b64_tr_b16 v[186:187], v8 offset:384
    v_mfma_f32_16x16x32_bf16 v[64:67], v[148:151], v[200:203], v[64:67]
    ds_read_b64_tr_b16 v[188:189], v8 offset:160
    v_mfma_f32_16x16x32_bf16 v[68:71], v[148:151], v[204:207], v[68:71]
    ds_read_b64_tr_b16 v[190:191], v8 offset:416
    v_mfma_f32_16x16x32_bf16 v[72:75], v[152:155], v[200:203], v[72:75]
    ds_read_b64_tr_b16 v[192:193], v8 offset:192
    v_mfma_f32_16x16x32_bf16 v[76:79], v[152:155], v[204:207], v[76:79]
    ds_read_b64_tr_b16 v[194:195], v8 offset:448
    v_mfma_f32_16x16x32_bf16 v[80:83], v[156:159], v[200:203], v[80:83]
    ds_read_b64_tr_b16 v[196:197], v8 offset:224
    v_mfma_f32_16x16x32_bf16 v[84:87], v[156:159], v[204:207], v[84:87]
    ds_read_b64_tr_b16 v[198:199], v8 offset:480
    v_mfma_f32_16x16x32_bf16 v[88:91], v[160:163], v[200:203], v[88:91]
    v_mfma_f32_16x16x32_bf16 v[92:95], v[160:163], v[204:207], v[92:95]
    v_mfma_f32_16x16x32_bf16 v[96:99], v[164:167], v[200:203], v[96:99]
    v_mfma_f32_16x16x32_bf16 v[100:103], v[164:167], v[204:207], v[100:103]
    s_waitcnt vmcnt(6) lgkmcnt(0)
    s_barrier
    s_add_u32 m0, s64, 0
    s_mov_b32 s26, 6291456
    buffer_load_dwordx4 v4, s[8:11], s26 offen offset:0 lds
    s_add_u32 m0, s64, 1056
    s_nop 0
    buffer_load_dwordx4 v5, s[8:11], s26 offen offset:0 lds
    s_add_u32 m0, s64, 8192
    s_nop 0
    buffer_load_dwordx4 v4, s[8:11], s26 offen offset:256 lds
    s_add_u32 m0, s64, 9248
    s_nop 0
    buffer_load_dwordx4 v5, s[8:11], s26 offen offset:256 lds
    s_add_u32 m0, s65, 8192
    s_mov_b32 s25, 132608
    buffer_load_dwordx4 v2, s[4:7], s25 offen lds
    s_add_u32 m0, s65, 12288
    s_nop 0
    buffer_load_dwordx4 v3, s[4:7], s25 offen lds
    ds_read_b128 v[216:219], v6 offset:16384
    ds_read_b128 v[220:223], v6 offset:18432
    ds_read_b128 v[224:227], v7 offset:16384
    ds_read_b128 v[228:231], v7 offset:18432
    ds_read_b64_tr_b16 v[136:137], v8 offset:16896
    ds_read_b64_tr_b16 v[138:139], v8 offset:17152
    ds_read_b64_tr_b16 v[140:141], v8 offset:16928
    ds_read_b64_tr_b16 v[142:143], v8 offset:17184
    v_mfma_f32_16x16x32_bf16 v[40:43], v[168:171], v[208:211], v[40:43]
    ds_read_b64_tr_b16 v[144:145], v8 offset:16960
    v_mfma_f32_16x16x32_bf16 v[44:47], v[168:171], v[212:215], v[44:47]
    ds_read_b64_tr_b16 v[146:147], v8 offset:17216
    v_mfma_f32_16x16x32_bf16 v[48:51], v[172:175], v[208:211], v[48:51]
    ds_read_b64_tr_b16 v[148:149], v8 offset:16992
    v_mfma_f32_16x16x32_bf16 v[52:55], v[172:175], v[212:215], v[52:55]
    ds_read_b64_tr_b16 v[150:151], v8 offset:17248
    v_mfma_f32_16x16x32_bf16 v[56:59], v[176:179], v[208:211], v[56:59]
    ds_read_b64_tr_b16 v[152:153], v8 offset:17024
    v_mfma_f32_16x16x32_bf16 v[60:63], v[176:179], v[212:215], v[60:63]
    ds_read_b64_tr_b16 v[154:155], v8 offset:17280
    v_mfma_f32_16x16x32_bf16 v[64:67], v[180:183], v[208:211], v[64:67]
    ds_read_b64_tr_b16 v[156:157], v8 offset:17056
    v_mfma_f32_16x16x32_bf16 v[68:71], v[180:183], v[212:215], v[68:71]
    ds_read_b64_tr_b16 v[158:159], v8 offset:17312
    v_mfma_f32_16x16x32_bf16 v[72:75], v[184:187], v[208:211], v[72:75]
    ds_read_b64_tr_b16 v[160:161], v8 offset:17088
    v_mfma_f32_16x16x32_bf16 v[76:79], v[184:187], v[212:215], v[76:79]
    ds_read_b64_tr_b16 v[162:163], v8 offset:17344
    v_mfma_f32_16x16x32_bf16 v[80:83], v[188:191], v[208:211], v[80:83]
    ds_read_b64_tr_b16 v[164:165], v8 offset:17120
    v_mfma_f32_16x16x32_bf16 v[84:87], v[188:191], v[212:215], v[84:87]
    ds_read_b64_tr_b16 v[166:167], v8 offset:17376
    v_mfma_f32_16x16x32_bf16 v[88:91], v[192:195], v[208:211], v[88:91]
    v_mfma_f32_16x16x32_bf16 v[92:95], v[192:195], v[212:215], v[92:95]
    v_mfma_f32_16x16x32_bf16 v[96:99], v[196:199], v[208:211], v[96:99]
    v_mfma_f32_16x16x32_bf16 v[100:103], v[196:199], v[212:215], v[100:103]
    s_waitcnt vmcnt(8) lgkmcnt(0)
    s_barrier
    s_add_u32 m0, s64, 16896
    s_mov_b32 s26, 6553600
    buffer_load_dwordx4 v4, s[8:11], s26 offen offset:0 lds
    s_add_u32 m0, s64, 17952
    s_nop 0
    buffer_load_dwordx4 v5, s[8:11], s26 offen offset:0 lds
    s_add_u32 m0, s64, 25088
    s_nop 0
    buffer_load_dwordx4 v4, s[8:11], s26 offen offset:256 lds
    s_add_u32 m0, s64, 26144
    s_nop 0
    buffer_load_dwordx4 v5, s[8:11], s26 offen offset:256 lds
    s_add_u32 m0, s65, 16384
    s_mov_b32 s25, 1664
    buffer_load_dwordx4 v2, s[4:7], s25 offen lds
    s_add_u32 m0, s65, 20480
    s_nop 0
    buffer_load_dwordx4 v3, s[4:7], s25 offen lds
    ds_read_b64_tr_b16 v[168:169], v8 offset:33792
    ds_read_b64_tr_b16 v[170:171], v8 offset:34048
    ds_read_b64_tr_b16 v[172:173], v8 offset:33824
    ds_read_b64_tr_b16 v[174:175], v8 offset:34080
    v_mfma_f32_16x16x32_bf16 v[40:43], v[136:139], v[216:219], v[40:43]
    ds_read_b64_tr_b16 v[176:177], v8 offset:33856
    v_mfma_f32_16x16x32_bf16 v[44:47], v[136:139], v[220:223], v[44:47]
    ds_read_b64_tr_b16 v[178:179], v8 offset:34112
    v_mfma_f32_16x16x32_bf16 v[48:51], v[140:143], v[216:219], v[48:51]
    ds_read_b64_tr_b16 v[180:181], v8 offset:33888
    v_mfma_f32_16x16x32_bf16 v[52:55], v[140:143], v[220:223], v[52:55]
    ds_read_b64_tr_b16 v[182:183], v8 offset:34144
    v_mfma_f32_16x16x32_bf16 v[56:59], v[144:147], v[216:219], v[56:59]
    ds_read_b64_tr_b16 v[184:185], v8 offset:33920
    v_mfma_f32_16x16x32_bf16 v[60:63], v[144:147], v[220:223], v[60:63]
    ds_read_b64_tr_b16 v[186:187], v8 offset:34176
    v_mfma_f32_16x16x32_bf16 v[64:67], v[148:151], v[216:219], v[64:67]
    ds_read_b64_tr_b16 v[188:189], v8 offset:33952
    v_mfma_f32_16x16x32_bf16 v[68:71], v[148:151], v[220:223], v[68:71]
    ds_read_b64_tr_b16 v[190:191], v8 offset:34208
    v_mfma_f32_16x16x32_bf16 v[72:75], v[152:155], v[216:219], v[72:75]
    ds_read_b64_tr_b16 v[192:193], v8 offset:33984
    v_mfma_f32_16x16x32_bf16 v[76:79], v[152:155], v[220:223], v[76:79]
    ds_read_b64_tr_b16 v[194:195], v8 offset:34240
    v_mfma_f32_16x16x32_bf16 v[80:83], v[156:159], v[216:219], v[80:83]
    ds_read_b64_tr_b16 v[196:197], v8 offset:34016
    v_mfma_f32_16x16x32_bf16 v[84:87], v[156:159], v[220:223], v[84:87]
    ds_read_b64_tr_b16 v[198:199], v8 offset:34272
    v_mfma_f32_16x16x32_bf16 v[88:91], v[160:163], v[216:219], v[88:91]
    v_mfma_f32_16x16x32_bf16 v[92:95], v[160:163], v[220:223], v[92:95]
    v_mfma_f32_16x16x32_bf16 v[96:99], v[164:167], v[216:219], v[96:99]
    v_mfma_f32_16x16x32_bf16 v[100:103], v[164:167], v[220:223], v[100:103]
    s_waitcnt vmcnt(6) lgkmcnt(0)
    s_barrier
    s_add_u32 m0, s64, 33792
    s_mov_b32 s26, 6815744
    buffer_load_dwordx4 v4, s[8:11], s26 offen offset:0 lds
    s_add_u32 m0, s64, 34848
    s_nop 0
    buffer_load_dwordx4 v5, s[8:11], s26 offen offset:0 lds
    s_add_u32 m0, s64, 41984
    s_nop 0
    buffer_load_dwordx4 v4, s[8:11], s26 offen offset:256 lds
    s_add_u32 m0, s64, 43040
    s_nop 0
    buffer_load_dwordx4 v5, s[8:11], s26 offen offset:256 lds
    s_add_u32 m0, s65, 24576
    s_mov_b32 s25, 132736
    buffer_load_dwordx4 v2, s[4:7], s25 offen lds
    s_add_u32 m0, s65, 28672
    s_nop 0
    buffer_load_dwordx4 v3, s[4:7], s25 offen lds
    ds_read_b128 v[200:203], v6 offset:0
    ds_read_b128 v[204:207], v6 offset:2048
    ds_read_b128 v[208:211], v7 offset:0
    ds_read_b128 v[212:215], v7 offset:2048
    ds_read_b64_tr_b16 v[136:137], v8 offset:0
    ds_read_b64_tr_b16 v[138:139], v8 offset:256
    ds_read_b64_tr_b16 v[140:141], v8 offset:32
    ds_read_b64_tr_b16 v[142:143], v8 offset:288
    v_mfma_f32_16x16x32_bf16 v[40:43], v[168:171], v[224:227], v[40:43]
    ds_read_b64_tr_b16 v[144:145], v8 offset:64
    v_mfma_f32_16x16x32_bf16 v[44:47], v[168:171], v[228:231], v[44:47]
    ds_read_b64_tr_b16 v[146:147], v8 offset:320
    v_mfma_f32_16x16x32_bf16 v[48:51], v[172:175], v[224:227], v[48:51]
    ds_read_b64_tr_b16 v[148:149], v8 offset:96
    v_mfma_f32_16x16x32_bf16 v[52:55], v[172:175], v[228:231], v[52:55]
    ds_read_b64_tr_b16 v[150:151], v8 offset:352
    v_mfma_f32_16x16x32_bf16 v[56:59], v[176:179], v[224:227], v[56:59]
    ds_read_b64_tr_b16 v[152:153], v8 offset:128
    v_mfma_f32_16x16x32_bf16 v[60:63], v[176:179], v[228:231], v[60:63]
    ds_read_b64_tr_b16 v[154:155], v8 offset:384
    v_mfma_f32_16x16x32_bf16 v[64:67], v[180:183], v[224:227], v[64:67]
    ds_read_b64_tr_b16 v[156:157], v8 offset:160
    v_mfma_f32_16x16x32_bf16 v[68:71], v[180:183], v[228:231], v[68:71]
    ds_read_b64_tr_b16 v[158:159], v8 offset:416
    v_mfma_f32_16x16x32_bf16 v[72:75], v[184:187], v[224:227], v[72:75]
    ds_read_b64_tr_b16 v[160:161], v8 offset:192
    v_mfma_f32_16x16x32_bf16 v[76:79], v[184:187], v[228:231], v[76:79]
    ds_read_b64_tr_b16 v[162:163], v8 offset:448
    v_mfma_f32_16x16x32_bf16 v[80:83], v[188:191], v[224:227], v[80:83]
    ds_read_b64_tr_b16 v[164:165], v8 offset:224
    v_mfma_f32_16x16x32_bf16 v[84:87], v[188:191], v[228:231], v[84:87]
    ds_read_b64_tr_b16 v[166:167], v8 offset:480
    v_mfma_f32_16x16x32_bf16 v[88:91], v[192:195], v[224:227], v[88:91]
    v_mfma_f32_16x16x32_bf16 v[92:95], v[192:195], v[228:231], v[92:95]
    v_mfma_f32_16x16x32_bf16 v[96:99], v[196:199], v[224:227], v[96:99]
    v_mfma_f32_16x16x32_bf16 v[100:103], v[196:199], v[228:231], v[100:103]
    s_waitcnt vmcnt(8) lgkmcnt(0)
    s_barrier
    s_add_u32 m0, s64, 0
    s_mov_b32 s26, 7077888
    buffer_load_dwordx4 v4, s[8:11], s26 offen offset:0 lds
    s_add_u32 m0, s64, 1056
    s_nop 0
    buffer_load_dwordx4 v5, s[8:11], s26 offen offset:0 lds
    s_add_u32 m0, s64, 8192
    s_nop 0
    buffer_load_dwordx4 v4, s[8:11], s26 offen offset:256 lds
    s_add_u32 m0, s64, 9248
    s_nop 0
    buffer_load_dwordx4 v5, s[8:11], s26 offen offset:256 lds
    s_add_u32 m0, s65, 0
    s_mov_b32 s25, 1792
    buffer_load_dwordx4 v2, s[4:7], s25 offen lds
    s_add_u32 m0, s65, 4096
    s_nop 0
    buffer_load_dwordx4 v3, s[4:7], s25 offen lds
    ds_read_b64_tr_b16 v[168:169], v8 offset:16896
    ds_read_b64_tr_b16 v[170:171], v8 offset:17152
    ds_read_b64_tr_b16 v[172:173], v8 offset:16928
    ds_read_b64_tr_b16 v[174:175], v8 offset:17184
    v_mfma_f32_16x16x32_bf16 v[40:43], v[136:139], v[200:203], v[40:43]
    ds_read_b64_tr_b16 v[176:177], v8 offset:16960
    v_mfma_f32_16x16x32_bf16 v[44:47], v[136:139], v[204:207], v[44:47]
    ds_read_b64_tr_b16 v[178:179], v8 offset:17216
    v_mfma_f32_16x16x32_bf16 v[48:51], v[140:143], v[200:203], v[48:51]
    ds_read_b64_tr_b16 v[180:181], v8 offset:16992
    v_mfma_f32_16x16x32_bf16 v[52:55], v[140:143], v[204:207], v[52:55]
    ds_read_b64_tr_b16 v[182:183], v8 offset:17248
    v_mfma_f32_16x16x32_bf16 v[56:59], v[144:147], v[200:203], v[56:59]
    ds_read_b64_tr_b16 v[184:185], v8 offset:17024
    v_mfma_f32_16x16x32_bf16 v[60:63], v[144:147], v[204:207], v[60:63]
    ds_read_b64_tr_b16 v[186:187], v8 offset:17280
    v_mfma_f32_16x16x32_bf16 v[64:67], v[148:151], v[200:203], v[64:67]
    ds_read_b64_tr_b16 v[188:189], v8 offset:17056
    v_mfma_f32_16x16x32_bf16 v[68:71], v[148:151], v[204:207], v[68:71]
    ds_read_b64_tr_b16 v[190:191], v8 offset:17312
    v_mfma_f32_16x16x32_bf16 v[72:75], v[152:155], v[200:203], v[72:75]
    ds_read_b64_tr_b16 v[192:193], v8 offset:17088
    v_mfma_f32_16x16x32_bf16 v[76:79], v[152:155], v[204:207], v[76:79]
    ds_read_b64_tr_b16 v[194:195], v8 offset:17344
    v_mfma_f32_16x16x32_bf16 v[80:83], v[156:159], v[200:203], v[80:83]
    ds_read_b64_tr_b16 v[196:197], v8 offset:17120
    v_mfma_f32_16x16x32_bf16 v[84:87], v[156:159], v[204:207], v[84:87]
    ds_read_b64_tr_b16 v[198:199], v8 offset:17376
    v_mfma_f32_16x16x32_bf16 v[88:91], v[160:163], v[200:203], v[88:91]
    v_mfma_f32_16x16x32_bf16 v[92:95], v[160:163], v[204:207], v[92:95]
    v_mfma_f32_16x16x32_bf16 v[96:99], v[164:167], v[200:203], v[96:99]
    v_mfma_f32_16x16x32_bf16 v[100:103], v[164:167], v[204:207], v[100:103]
    s_waitcnt vmcnt(6) lgkmcnt(0)
    s_barrier
    s_add_u32 m0, s64, 16896
    s_mov_b32 s26, 7340032
    buffer_load_dwordx4 v4, s[8:11], s26 offen offset:0 lds
    s_add_u32 m0, s64, 17952
    s_nop 0
    buffer_load_dwordx4 v5, s[8:11], s26 offen offset:0 lds
    s_add_u32 m0, s64, 25088
    s_nop 0
    buffer_load_dwordx4 v4, s[8:11], s26 offen offset:256 lds
    s_add_u32 m0, s64, 26144
    s_nop 0
    buffer_load_dwordx4 v5, s[8:11], s26 offen offset:256 lds
    s_add_u32 m0, s65, 8192
    s_mov_b32 s25, 132864
    buffer_load_dwordx4 v2, s[4:7], s25 offen lds
    s_add_u32 m0, s65, 12288
    s_nop 0
    buffer_load_dwordx4 v3, s[4:7], s25 offen lds
    ds_read_b128 v[216:219], v6 offset:16384
    ds_read_b128 v[220:223], v6 offset:18432
    ds_read_b128 v[224:227], v7 offset:16384
    ds_read_b128 v[228:231], v7 offset:18432
    ds_read_b64_tr_b16 v[136:137], v8 offset:33792
    ds_read_b64_tr_b16 v[138:139], v8 offset:34048
    ds_read_b64_tr_b16 v[140:141], v8 offset:33824
    ds_read_b64_tr_b16 v[142:143], v8 offset:34080
    v_mfma_f32_16x16x32_bf16 v[40:43], v[168:171], v[208:211], v[40:43]
    ds_read_b64_tr_b16 v[144:145], v8 offset:33856
    v_mfma_f32_16x16x32_bf16 v[44:47], v[168:171], v[212:215], v[44:47]
    ds_read_b64_tr_b16 v[146:147], v8 offset:34112
    v_mfma_f32_16x16x32_bf16 v[48:51], v[172:175], v[208:211], v[48:51]
    ds_read_b64_tr_b16 v[148:149], v8 offset:33888
    v_mfma_f32_16x16x32_bf16 v[52:55], v[172:175], v[212:215], v[52:55]
    ds_read_b64_tr_b16 v[150:151], v8 offset:34144
    v_mfma_f32_16x16x32_bf16 v[56:59], v[176:179], v[208:211], v[56:59]
    ds_read_b64_tr_b16 v[152:153], v8 offset:33920
    v_mfma_f32_16x16x32_bf16 v[60:63], v[176:179], v[212:215], v[60:63]
    ds_read_b64_tr_b16 v[154:155], v8 offset:34176
    v_mfma_f32_16x16x32_bf16 v[64:67], v[180:183], v[208:211], v[64:67]
    ds_read_b64_tr_b16 v[156:157], v8 offset:33952
    v_mfma_f32_16x16x32_bf16 v[68:71], v[180:183], v[212:215], v[68:71]
    ds_read_b64_tr_b16 v[158:159], v8 offset:34208
    v_mfma_f32_16x16x32_bf16 v[72:75], v[184:187], v[208:211], v[72:75]
    ds_read_b64_tr_b16 v[160:161], v8 offset:33984
    v_mfma_f32_16x16x32_bf16 v[76:79], v[184:187], v[212:215], v[76:79]
    ds_read_b64_tr_b16 v[162:163], v8 offset:34240
    v_mfma_f32_16x16x32_bf16 v[80:83], v[188:191], v[208:211], v[80:83]
    ds_read_b64_tr_b16 v[164:165], v8 offset:34016
    v_mfma_f32_16x16x32_bf16 v[84:87], v[188:191], v[212:215], v[84:87]
    ds_read_b64_tr_b16 v[166:167], v8 offset:34272
    v_mfma_f32_16x16x32_bf16 v[88:91], v[192:195], v[208:211], v[88:91]
    v_mfma_f32_16x16x32_bf16 v[92:95], v[192:195], v[212:215], v[92:95]
    v_mfma_f32_16x16x32_bf16 v[96:99], v[196:199], v[208:211], v[96:99]
    v_mfma_f32_16x16x32_bf16 v[100:103], v[196:199], v[212:215], v[100:103]
    s_waitcnt vmcnt(8) lgkmcnt(0)
    s_barrier
    s_add_u32 m0, s64, 33792
    s_mov_b32 s26, 7602176
    buffer_load_dwordx4 v4, s[8:11], s26 offen offset:0 lds
    s_add_u32 m0, s64, 34848
    s_nop 0
    buffer_load_dwordx4 v5, s[8:11], s26 offen offset:0 lds
    s_add_u32 m0, s64, 41984
    s_nop 0
    buffer_load_dwordx4 v4, s[8:11], s26 offen offset:256 lds
    s_add_u32 m0, s64, 43040
    s_nop 0
    buffer_load_dwordx4 v5, s[8:11], s26 offen offset:256 lds
    s_add_u32 m0, s65, 16384
    s_mov_b32 s25, 1920
    buffer_load_dwordx4 v2, s[4:7], s25 offen lds
    s_add_u32 m0, s65, 20480
    s_nop 0
    buffer_load_dwordx4 v3, s[4:7], s25 offen lds
    ds_read_b64_tr_b16 v[168:169], v8 offset:0
    ds_read_b64_tr_b16 v[170:171], v8 offset:256
    ds_read_b64_tr_b16 v[172:173], v8 offset:32
    ds_read_b64_tr_b16 v[174:175], v8 offset:288
    v_mfma_f32_16x16x32_bf16 v[40:43], v[136:139], v[216:219], v[40:43]
    ds_read_b64_tr_b16 v[176:177], v8 offset:64
    v_mfma_f32_16x16x32_bf16 v[44:47], v[136:139], v[220:223], v[44:47]
    ds_read_b64_tr_b16 v[178:179], v8 offset:320
    v_mfma_f32_16x16x32_bf16 v[48:51], v[140:143], v[216:219], v[48:51]
    ds_read_b64_tr_b16 v[180:181], v8 offset:96
    v_mfma_f32_16x16x32_bf16 v[52:55], v[140:143], v[220:223], v[52:55]
    ds_read_b64_tr_b16 v[182:183], v8 offset:352
    v_mfma_f32_16x16x32_bf16 v[56:59], v[144:147], v[216:219], v[56:59]
    ds_read_b64_tr_b16 v[184:185], v8 offset:128
    v_mfma_f32_16x16x32_bf16 v[60:63], v[144:147], v[220:223], v[60:63]
    ds_read_b64_tr_b16 v[186:187], v8 offset:384
    v_mfma_f32_16x16x32_bf16 v[64:67], v[148:151], v[216:219], v[64:67]
    ds_read_b64_tr_b16 v[188:189], v8 offset:160
    v_mfma_f32_16x16x32_bf16 v[68:71], v[148:151], v[220:223], v[68:71]
    ds_read_b64_tr_b16 v[190:191], v8 offset:416
    v_mfma_f32_16x16x32_bf16 v[72:75], v[152:155], v[216:219], v[72:75]
    ds_read_b64_tr_b16 v[192:193], v8 offset:192
    v_mfma_f32_16x16x32_bf16 v[76:79], v[152:155], v[220:223], v[76:79]
    ds_read_b64_tr_b16 v[194:195], v8 offset:448
    v_mfma_f32_16x16x32_bf16 v[80:83], v[156:159], v[216:219], v[80:83]
    ds_read_b64_tr_b16 v[196:197], v8 offset:224
    v_mfma_f32_16x16x32_bf16 v[84:87], v[156:159], v[220:223], v[84:87]
    ds_read_b64_tr_b16 v[198:199], v8 offset:480
    v_mfma_f32_16x16x32_bf16 v[88:91], v[160:163], v[216:219], v[88:91]
    v_mfma_f32_16x16x32_bf16 v[92:95], v[160:163], v[220:223], v[92:95]
    v_mfma_f32_16x16x32_bf16 v[96:99], v[164:167], v[216:219], v[96:99]
    v_mfma_f32_16x16x32_bf16 v[100:103], v[164:167], v[220:223], v[100:103]
    s_waitcnt vmcnt(6) lgkmcnt(0)
    s_barrier
    s_add_u32 m0, s64, 0
    s_mov_b32 s26, 7864320
    buffer_load_dwordx4 v4, s[8:11], s26 offen offset:0 lds
    s_add_u32 m0, s64, 1056
    s_nop 0
    buffer_load_dwordx4 v5, s[8:11], s26 offen offset:0 lds
    s_add_u32 m0, s64, 8192
    s_nop 0
    buffer_load_dwordx4 v4, s[8:11], s26 offen offset:256 lds
    s_add_u32 m0, s64, 9248
    s_nop 0
    buffer_load_dwordx4 v5, s[8:11], s26 offen offset:256 lds
    s_add_u32 m0, s65, 24576
    s_mov_b32 s25, 132992
    buffer_load_dwordx4 v2, s[4:7], s25 offen lds
    s_add_u32 m0, s65, 28672
    s_nop 0
    buffer_load_dwordx4 v3, s[4:7], s25 offen lds
    ds_read_b128 v[200:203], v6 offset:0
    ds_read_b128 v[204:207], v6 offset:2048
    ds_read_b128 v[208:211], v7 offset:0
    ds_read_b128 v[212:215], v7 offset:2048
    ds_read_b64_tr_b16 v[136:137], v8 offset:16896
    ds_read_b64_tr_b16 v[138:139], v8 offset:17152
    ds_read_b64_tr_b16 v[140:141], v8 offset:16928
    ds_read_b64_tr_b16 v[142:143], v8 offset:17184
    v_mfma_f32_16x16x32_bf16 v[40:43], v[168:171], v[224:227], v[40:43]
    ds_read_b64_tr_b16 v[144:145], v8 offset:16960
    v_mfma_f32_16x16x32_bf16 v[44:47], v[168:171], v[228:231], v[44:47]
    ds_read_b64_tr_b16 v[146:147], v8 offset:17216
    v_mfma_f32_16x16x32_bf16 v[48:51], v[172:175], v[224:227], v[48:51]
    ds_read_b64_tr_b16 v[148:149], v8 offset:16992
    v_mfma_f32_16x16x32_bf16 v[52:55], v[172:175], v[228:231], v[52:55]
    ds_read_b64_tr_b16 v[150:151], v8 offset:17248
    v_mfma_f32_16x16x32_bf16 v[56:59], v[176:179], v[224:227], v[56:59]
    ds_read_b64_tr_b16 v[152:153], v8 offset:17024
    v_mfma_f32_16x16x32_bf16 v[60:63], v[176:179], v[228:231], v[60:63]
    ds_read_b64_tr_b16 v[154:155], v8 offset:17280
    v_mfma_f32_16x16x32_bf16 v[64:67], v[180:183], v[224:227], v[64:67]
    ds_read_b64_tr_b16 v[156:157], v8 offset:17056
    v_mfma_f32_16x16x32_bf16 v[68:71], v[180:183], v[228:231], v[68:71]
    ds_read_b64_tr_b16 v[158:159], v8 offset:17312
    v_mfma_f32_16x16x32_bf16 v[72:75], v[184:187], v[224:227], v[72:75]
    ds_read_b64_tr_b16 v[160:161], v8 offset:17088
    v_mfma_f32_16x16x32_bf16 v[76:79], v[184:187], v[228:231], v[76:79]
    ds_read_b64_tr_b16 v[162:163], v8 offset:17344
    v_mfma_f32_16x16x32_bf16 v[80:83], v[188:191], v[224:227], v[80:83]
    ds_read_b64_tr_b16 v[164:165], v8 offset:17120
    v_mfma_f32_16x16x32_bf16 v[84:87], v[188:191], v[228:231], v[84:87]
    ds_read_b64_tr_b16 v[166:167], v8 offset:17376
    v_mfma_f32_16x16x32_bf16 v[88:91], v[192:195], v[224:227], v[88:91]
    v_mfma_f32_16x16x32_bf16 v[92:95], v[192:195], v[228:231], v[92:95]
    v_mfma_f32_16x16x32_bf16 v[96:99], v[196:199], v[224:227], v[96:99]
    v_mfma_f32_16x16x32_bf16 v[100:103], v[196:199], v[228:231], v[100:103]
    s_waitcnt vmcnt(8) lgkmcnt(0)
    s_barrier
    s_add_u32 m0, s64, 16896
    s_mov_b32 s26, 8126464
    buffer_load_dwordx4 v4, s[8:11], s26 offen offset:0 lds
    s_add_u32 m0, s64, 17952
    s_nop 0
    buffer_load_dwordx4 v5, s[8:11], s26 offen offset:0 lds
    s_add_u32 m0, s64, 25088
    s_nop 0
    buffer_load_dwordx4 v4, s[8:11], s26 offen offset:256 lds
    s_add_u32 m0, s64, 26144
    s_nop 0
    buffer_load_dwordx4 v5, s[8:11], s26 offen offset:256 lds
    ds_read_b64_tr_b16 v[168:169], v8 offset:33792
    ds_read_b64_tr_b16 v[170:171], v8 offset:34048
    ds_read_b64_tr_b16 v[172:173], v8 offset:33824
    ds_read_b64_tr_b16 v[174:175], v8 offset:34080
    v_mfma_f32_16x16x32_bf16 v[40:43], v[136:139], v[200:203], v[40:43]
    ds_read_b64_tr_b16 v[176:177], v8 offset:33856
    v_mfma_f32_16x16x32_bf16 v[44:47], v[136:139], v[204:207], v[44:47]
    ds_read_b64_tr_b16 v[178:179], v8 offset:34112
    v_mfma_f32_16x16x32_bf16 v[48:51], v[140:143], v[200:203], v[48:51]
    ds_read_b64_tr_b16 v[180:181], v8 offset:33888
    v_mfma_f32_16x16x32_bf16 v[52:55], v[140:143], v[204:207], v[52:55]
    ds_read_b64_tr_b16 v[182:183], v8 offset:34144
    v_mfma_f32_16x16x32_bf16 v[56:59], v[144:147], v[200:203], v[56:59]
    ds_read_b64_tr_b16 v[184:185], v8 offset:33920
    v_mfma_f32_16x16x32_bf16 v[60:63], v[144:147], v[204:207], v[60:63]
    ds_read_b64_tr_b16 v[186:187], v8 offset:34176
    v_mfma_f32_16x16x32_bf16 v[64:67], v[148:151], v[200:203], v[64:67]
    ds_read_b64_tr_b16 v[188:189], v8 offset:33952
    v_mfma_f32_16x16x32_bf16 v[68:71], v[148:151], v[204:207], v[68:71]
    ds_read_b64_tr_b16 v[190:191], v8 offset:34208
    v_mfma_f32_16x16x32_bf16 v[72:75], v[152:155], v[200:203], v[72:75]
    ds_read_b64_tr_b16 v[192:193], v8 offset:33984
    v_mfma_f32_16x16x32_bf16 v[76:79], v[152:155], v[204:207], v[76:79]
    ds_read_b64_tr_b16 v[194:195], v8 offset:34240
    v_mfma_f32_16x16x32_bf16 v[80:83], v[156:159], v[200:203], v[80:83]
    ds_read_b64_tr_b16 v[196:197], v8 offset:34016
    v_mfma_f32_16x16x32_bf16 v[84:87], v[156:159], v[204:207], v[84:87]
    ds_read_b64_tr_b16 v[198:199], v8 offset:34272
    v_mfma_f32_16x16x32_bf16 v[88:91], v[160:163], v[200:203], v[88:91]
    v_mfma_f32_16x16x32_bf16 v[92:95], v[160:163], v[204:207], v[92:95]
    v_mfma_f32_16x16x32_bf16 v[96:99], v[164:167], v[200:203], v[96:99]
    v_mfma_f32_16x16x32_bf16 v[100:103], v[164:167], v[204:207], v[100:103]
    s_waitcnt vmcnt(4) lgkmcnt(0)
    s_barrier
    buffer_load_dwordx3 v[248:250], off, s[52:55], 0 sc1
    ds_read_b128 v[216:219], v6 offset:16384
    ds_read_b128 v[220:223], v6 offset:18432
    ds_read_b128 v[224:227], v7 offset:16384
    ds_read_b128 v[228:231], v7 offset:18432
    ds_read_b64_tr_b16 v[136:137], v8 offset:0
    ds_read_b64_tr_b16 v[138:139], v8 offset:256
    ds_read_b64_tr_b16 v[140:141], v8 offset:32
    ds_read_b64_tr_b16 v[142:143], v8 offset:288
    v_mfma_f32_16x16x32_bf16 v[40:43], v[168:171], v[208:211], v[40:43]
    ds_read_b64_tr_b16 v[144:145], v8 offset:64
    v_mfma_f32_16x16x32_bf16 v[44:47], v[168:171], v[212:215], v[44:47]
    ds_read_b64_tr_b16 v[146:147], v8 offset:320
    v_mfma_f32_16x16x32_bf16 v[48:51], v[172:175], v[208:211], v[48:51]
    ds_read_b64_tr_b16 v[148:149], v8 offset:96
    v_mfma_f32_16x16x32_bf16 v[52:55], v[172:175], v[212:215], v[52:55]
    ds_read_b64_tr_b16 v[150:151], v8 offset:352
    v_mfma_f32_16x16x32_bf16 v[56:59], v[176:179], v[208:211], v[56:59]
    ds_read_b64_tr_b16 v[152:153], v8 offset:128
    v_mfma_f32_16x16x32_bf16 v[60:63], v[176:179], v[212:215], v[60:63]
    ds_read_b64_tr_b16 v[154:155], v8 offset:384
    v_mfma_f32_16x16x32_bf16 v[64:67], v[180:183], v[208:211], v[64:67]
    ds_read_b64_tr_b16 v[156:157], v8 offset:160
    v_mfma_f32_16x16x32_bf16 v[68:71], v[180:183], v[212:215], v[68:71]
    ds_read_b64_tr_b16 v[158:159], v8 offset:416
    v_mfma_f32_16x16x32_bf16 v[72:75], v[184:187], v[208:211], v[72:75]
    ds_read_b64_tr_b16 v[160:161], v8 offset:192
    v_mfma_f32_16x16x32_bf16 v[76:79], v[184:187], v[212:215], v[76:79]
    ds_read_b64_tr_b16 v[162:163], v8 offset:448
    v_mfma_f32_16x16x32_bf16 v[80:83], v[188:191], v[208:211], v[80:83]
    ds_read_b64_tr_b16 v[164:165], v8 offset:224
    v_mfma_f32_16x16x32_bf16 v[84:87], v[188:191], v[212:215], v[84:87]
    ds_read_b64_tr_b16 v[166:167], v8 offset:480
    v_mfma_f32_16x16x32_bf16 v[88:91], v[192:195], v[208:211], v[88:91]
    v_mfma_f32_16x16x32_bf16 v[92:95], v[192:195], v[212:215], v[92:95]
    v_mfma_f32_16x16x32_bf16 v[96:99], v[196:199], v[208:211], v[96:99]
    v_mfma_f32_16x16x32_bf16 v[100:103], v[196:199], v[212:215], v[100:103]
    s_waitcnt vmcnt(1) lgkmcnt(0)
    s_barrier
    ds_read_b64_tr_b16 v[168:169], v8 offset:16896
    ds_read_b64_tr_b16 v[170:171], v8 offset:17152
    ds_read_b64_tr_b16 v[172:173], v8 offset:16928
    ds_read_b64_tr_b16 v[174:175], v8 offset:17184
    v_mfma_f32_16x16x32_bf16 v[40:43], v[136:139], v[216:219], v[40:43]
    ds_read_b64_tr_b16 v[176:177], v8 offset:16960
    v_mfma_f32_16x16x32_bf16 v[44:47], v[136:139], v[220:223], v[44:47]
    ds_read_b64_tr_b16 v[178:179], v8 offset:17216
    v_mfma_f32_16x16x32_bf16 v[48:51], v[140:143], v[216:219], v[48:51]
    ds_read_b64_tr_b16 v[180:181], v8 offset:16992
    v_mfma_f32_16x16x32_bf16 v[52:55], v[140:143], v[220:223], v[52:55]
    ds_read_b64_tr_b16 v[182:183], v8 offset:17248
    v_mfma_f32_16x16x32_bf16 v[56:59], v[144:147], v[216:219], v[56:59]
    ds_read_b64_tr_b16 v[184:185], v8 offset:17024
    v_mfma_f32_16x16x32_bf16 v[60:63], v[144:147], v[220:223], v[60:63]
    ds_read_b64_tr_b16 v[186:187], v8 offset:17280
    v_mfma_f32_16x16x32_bf16 v[64:67], v[148:151], v[216:219], v[64:67]
    ds_read_b64_tr_b16 v[188:189], v8 offset:17056
    v_mfma_f32_16x16x32_bf16 v[68:71], v[148:151], v[220:223], v[68:71]
    ds_read_b64_tr_b16 v[190:191], v8 offset:17312
    v_mfma_f32_16x16x32_bf16 v[72:75], v[152:155], v[216:219], v[72:75]
    ds_read_b64_tr_b16 v[192:193], v8 offset:17088
    v_mfma_f32_16x16x32_bf16 v[76:79], v[152:155], v[220:223], v[76:79]
    ds_read_b64_tr_b16 v[194:195], v8 offset:17344
    v_mfma_f32_16x16x32_bf16 v[80:83], v[156:159], v[216:219], v[80:83]
    ds_read_b64_tr_b16 v[196:197], v8 offset:17120
    v_mfma_f32_16x16x32_bf16 v[84:87], v[156:159], v[220:223], v[84:87]
    ds_read_b64_tr_b16 v[198:199], v8 offset:17376
    v_mfma_f32_16x16x32_bf16 v[88:91], v[160:163], v[216:219], v[88:91]
    v_mfma_f32_16x16x32_bf16 v[92:95], v[160:163], v[220:223], v[92:95]
    v_mfma_f32_16x16x32_bf16 v[96:99], v[164:167], v[216:219], v[96:99]
    v_mfma_f32_16x16x32_bf16 v[100:103], v[164:167], v[220:223], v[100:103]
    s_waitcnt vmcnt(0) lgkmcnt(0)
    s_setprio 0
    s_barrier
    s_branch L_qj
L_qa:
    s_or_b32 s27, s2, s24
    s_cbranch_scc1 L_notag
    s_add_u32 s0, s20, 50503680
    s_addc_u32 s1, s21, 0
    s_load_dwordx2 s[98:99], s[0:1], 0
    s_waitcnt lgkmcnt(0)
    s_mul_i32 s27, s98, 0x7f4a7c15
    s_mul_hi_u32 s28, s98, 0x7f4a7c15
    s_mul_i32 s98, s98, 0x9e3779b9
    s_add_u32 s28, s28, s98
    s_mul_i32 s99, s99, 0x7f4a7c15
    s_add_u32 s28, s28, s99
    s_add_u32 s27, s27, 0xd192ed03
    s_addc_u32 s28, s28, 0xd1b54a32
    v_mov_b32 v248, s27
    v_mov_b32 v249, s28
    v_mov_b32 v250, 1
    s_mov_b32 s27, 50503680
    s_mov_b64 exec, 1
    buffer_store_dwordx3 v[248:250], off, s[52:55], 0 sc1
    buffer_store_dwordx2 v[248:249], off, s[20:23], s27 sc1
    s_mov_b64 exec, -1
L_notag:
    s_waitcnt lgkmcnt(0)
    s_barrier
    s_setprio 2
    ds_read_b128 v[200:203], v6 offset:0
    ds_read_b128 v[204:207], v6 offset:2048
    ds_read_b128 v[208:211], v7 offset:0
    ds_read_b128 v[212:215], v7 offset:2048
    ds_read_b64_tr_b16 v[136:137], v8 offset:0
    ds_read_b64_tr_b16 v[138:139], v8 offset:256
    ds_read_b64_tr_b16 v[140:141], v8 offset:32
    ds_read_b64_tr_b16 v[142:143], v8 offset:288
    ds_read_b64_tr_b16 v[144:145], v8 offset:64
    ds_read_b64_tr_b16 v[146:147], v8 offset:320
    ds_read_b64_tr_b16 v[148:149], v8 offset:96
    ds_read_b64_tr_b16 v[150:151], v8 offset:352
    ds_read_b64_tr_b16 v[152:153], v8 offset:128
    s_setprio 0
    ds_read_b64_tr_b16 v[154:155], v8 offset:384
    ds_read_b64_tr_b16 v[156:157], v8 offset:160
    ds_read_b64_tr_b16 v[158:159], v8 offset:416
    ds_read_b64_tr_b16 v[160:161], v8 offset:192
    ds_read_b64_tr_b16 v[162:163], v8 offset:448
    ds_read_b64_tr_b16 v[164:165], v8 offset:224
    ds_read_b64_tr_b16 v[166:167], v8 offset:480
    s_mov_b32 exec_hi, 0
    buffer_load_dword v233, v234, s[8:11], s101 offen
    buffer_load_dword v233, v232, s[60:63], s29 offen
    s_mov_b32 exec_hi, -1
    s_waitcnt lgkmcnt(0)
    v_mfma_f32_16x16x32_bf16 v[40:43], v[136:139], v[200:203], 0
    v_mfma_f32_16x16x32_bf16 v[44:47], v[136:139], v[204:207], 0
    v_mfma_f32_16x16x32_bf16 v[48:51], v[140:143], v[200:203], 0
    s_barrier
    s_setprio 2
    v_mfma_f32_16x16x32_bf16 v[52:55], v[140:143], v[204:207], 0
    ds_read_b64_tr_b16 v[168:169], v8 offset:16896
    v_mfma_f32_16x16x32_bf16 v[56:59], v[144:147], v[200:203], 0
    ds_read_b64_tr_b16 v[170:171], v8 offset:17152
    v_mfma_f32_16x16x32_bf16 v[60:63], v[144:147], v[204:207], 0
    ds_read_b64_tr_b16 v[172:173], v8 offset:16928
    v_mfma_f32_16x16x32_bf16 v[64:67], v[148:151], v[200:203], 0
    ds_read_b64_tr_b16 v[174:175], v8 offset:17184
    v_mfma_f32_16x16x32_bf16 v[68:71], v[148:151], v[204:207], 0
    ds_read_b64_tr_b16 v[176:177], v8 offset:16960
    v_mfma_f32_16x16x32_bf16 v[72:75], v[152:155], v[200:203], 0
    ds_read_b64_tr_b16 v[178:179], v8 offset:17216
    v_mfma_f32_16x16x32_bf16 v[76:79], v[152:155], v[204:207], 0
    ds_read_b64_tr_b16 v[180:181], v8 offset:16992
    v_mfma_f32_16x16x32_bf16 v[80:83], v[156:159], v[200:203], 0
    ds_read_b64_tr_b16 v[182:183], v8 offset:17248
    v_mfma_f32_16x16x32_bf16 v[84:87], v[156:159], v[204:207], 0
    ds_read_b64_tr_b16 v[184:185], v8 offset:17024
    v_mfma_f32_16x16x32_bf16 v[88:91], v[160:163], v[200:203], 0
    ds_read_b64_tr_b16 v[186:187], v8 offset:17280
    v_mfma_f32_16x16x32_bf16 v[92:95], v[160:163], v[204:207], 0
    ds_read_b64_tr_b16 v[188:189], v8 offset:17056
    v_mfma_f32_16x16x32_bf16 v[96:99], v[164:167], v[200:203], 0
    ds_read_b64_tr_b16 v[190:191], v8 offset:17312
    v_mfma_f32_16x16x32_bf16 v[100:103], v[164:167], v[204:207], 0
    ds_read_b64_tr_b16 v[192:193], v8 offset:17088
    s_setprio 0
    ds_read_b64_tr_b16 v[194:195], v8 offset:17344
    ds_read_b64_tr_b16 v[196:197], v8 offset:17120
    ds_read_b64_tr_b16 v[198:199], v8 offset:17376
    s_waitcnt lgkmcnt(0)
    v_mfma_f32_16x16x32_bf16 v[40:43], v[168:171], v[208:211], v[40:43]
    v_mfma_f32_16x16x32_bf16 v[44:47], v[168:171], v[212:215], v[44:47]
    v_mfma_f32_16x16x32_bf16 v[48:51], v[172:175], v[208:211], v[48:51]
    s_barrier
    s_setprio 2
    v_mfma_f32_16x16x32_bf16 v[52:55], v[172:175], v[212:215], v[52:55]
    ds_read_b128 v[216:219], v6 offset:16384
    v_mfma_f32_16x16x32_bf16 v[56:59], v[176:179], v[208:211], v[56:59]
    ds_read_b128 v[220:223], v6 offset:18432
    v_mfma_f32_16x16x32_bf16 v[60:63], v[176:179], v[212:215], v[60:63]
    ds_read_b128 v[224:227], v7 offset:16384
    v_mfma_f32_16x16x32_bf16 v[64:67], v[180:183], v[208:211], v[64:67]
    ds_read_b128 v[228:231], v7 offset:18432
    v_mfma_f32_16x16x32_bf16 v[68:71], v[180:183], v[212:215], v[68:71]
    ds_read_b64_tr_b16 v[136:137], v8 offset:33792
    v_mfma_f32_16x16x32_bf16 v[72:75], v[184:187], v[208:211], v[72:75]
    ds_read_b64_tr_b16 v[138:139], v8 offset:34048
    v_mfma_f32_16x16x32_bf16 v[76:79], v[184:187], v[212:215], v[76:79]
    ds_read_b64_tr_b16 v[140:141], v8 offset:33824
    v_mfma_f32_16x16x32_bf16 v[80:83], v[188:191], v[208:211], v[80:83]
    ds_read_b64_tr_b16 v[142:143], v8 offset:34080
    v_mfma_f32_16x16x32_bf16 v[84:87], v[188:191], v[212:215], v[84:87]
    ds_read_b64_tr_b16 v[144:145], v8 offset:33856
    v_mfma_f32_16x16x32_bf16 v[88:91], v[192:195], v[208:211], v[88:91]
    ds_read_b64_tr_b16 v[146:147], v8 offset:34112
    v_mfma_f32_16x16x32_bf16 v[92:95], v[192:195], v[212:215], v[92:95]
    ds_read_b64_tr_b16 v[148:149], v8 offset:33888
    v_mfma_f32_16x16x32_bf16 v[96:99], v[196:199], v[208:211], v[96:99]
    ds_read_b64_tr_b16 v[150:151], v8 offset:34144
    v_mfma_f32_16x16x32_bf16 v[100:103], v[196:199], v[212:215], v[100:103]
    ds_read_b64_tr_b16 v[152:153], v8 offset:33920
    s_setprio 0
    ds_read_b64_tr_b16 v[154:155], v8 offset:34176
    ds_read_b64_tr_b16 v[156:157], v8 offset:33952
    ds_read_b64_tr_b16 v[158:159], v8 offset:34208
    ds_read_b64_tr_b16 v[160:161], v8 offset:33984
    ds_read_b64_tr_b16 v[162:163], v8 offset:34240
    ds_read_b64_tr_b16 v[164:165], v8 offset:34016
    ds_read_b64_tr_b16 v[166:167], v8 offset:34272
    s_cmp_eq_u32 s47, 0
    s_cbranch_scc0 L_j2
    s_add_u32 s101, s101, 0x200000
    s_mov_b32 exec_hi, 0
    buffer_load_dword v233, v234, s[8:11], s101 offen
    s_mov_b32 exec_hi, -1
L_j2:
    s_waitcnt lgkmcnt(0)
    v_mfma_f32_16x16x32_bf16 v[40:43], v[136:139], v[216:219], v[40:43]
    v_mfma_f32_16x16x32_bf16 v[44:47], v[136:139], v[220:223], v[44:47]
    v_mfma_f32_16x16x32_bf16 v[48:51], v[140:143], v[216:219], v[48:51]
    s_barrier
    s_setprio 2
    v_mfma_f32_16x16x32_bf16 v[52:55], v[140:143], v[220:223], v[52:55]
    ds_read_b64_tr_b16 v[168:169], v8 offset:0
    v_mfma_f32_16x16x32_bf16 v[56:59], v[144:147], v[216:219], v[56:59]
    ds_read_b64_tr_b16 v[170:171], v8 offset:256
    v_mfma_f32_16x16x32_bf16 v[60:63], v[144:147], v[220:223], v[60:63]
    ds_read_b64_tr_b16 v[172:173], v8 offset:32
    v_mfma_f32_16x16x32_bf16 v[64:67], v[148:151], v[216:219], v[64:67]
    ds_read_b64_tr_b16 v[174:175], v8 offset:288
    v_mfma_f32_16x16x32_bf16 v[68:71], v[148:151], v[220:223], v[68:71]
    ds_read_b64_tr_b16 v[176:177], v8 offset:64
    v_mfma_f32_16x16x32_bf16 v[72:75], v[152:155], v[216:219], v[72:75]
    ds_read_b64_tr_b16 v[178:179], v8 offset:320
    v_mfma_f32_16x16x32_bf16 v[76:79], v[152:155], v[220:223], v[76:79]
    ds_read_b64_tr_b16 v[180:181], v8 offset:96
    v_mfma_f32_16x16x32_bf16 v[80:83], v[156:159], v[216:219], v[80:83]
    ds_read_b64_tr_b16 v[182:183], v8 offset:352
    v_mfma_f32_16x16x32_bf16 v[84:87], v[156:159], v[220:223], v[84:87]
    ds_read_b64_tr_b16 v[184:185], v8 offset:128
    v_mfma_f32_16x16x32_bf16 v[88:91], v[160:163], v[216:219], v[88:91]
    ds_read_b64_tr_b16 v[186:187], v8 offset:384
    v_mfma_f32_16x16x32_bf16 v[92:95], v[160:163], v[220:223], v[92:95]
    ds_read_b64_tr_b16 v[188:189], v8 offset:160
    v_mfma_f32_16x16x32_bf16 v[96:99], v[164:167], v[216:219], v[96:99]
    ds_read_b64_tr_b16 v[190:191], v8 offset:416
    v_mfma_f32_16x16x32_bf16 v[100:103], v[164:167], v[220:223], v[100:103]
    ds_read_b64_tr_b16 v[192:193], v8 offset:192
    s_setprio 0
    ds_read_b64_tr_b16 v[194:195], v8 offset:448
    ds_read_b64_tr_b16 v[196:197], v8 offset:224
    ds_read_b64_tr_b16 v[198:199], v8 offset:480
    s_cmp_eq_u32 s47, 1
    s_cbranch_scc0 L_j3
    s_add_u32 s101, s101, 0x200000
    s_mov_b32 exec_hi, 0
    buffer_load_dword v233, v234, s[8:11], s101 offen
    s_mov_b32 exec_hi, -1
L_j3:
    s_waitcnt lgkmcnt(0)
    v_mfma_f32_16x16x32_bf16 v[40:43], v[168:171], v[224:227], v[40:43]
    v_mfma_f32_16x16x32_bf16 v[44:47], v[168:171], v[228:231], v[44:47]
    v_mfma_f32_16x16x32_bf16 v[48:51], v[172:175], v[224:227], v[48:51]
    s_barrier
    s_setprio 2
    v_mfma_f32_16x16x32_bf16 v[52:55], v[172:175], v[228:231], v[52:55]
    ds_read_b128 v[200:203], v6 offset:0
    v_mfma_f32_16x16x32_bf16 v[56:59], v[176:179], v[224:227], v[56:59]
    ds_read_b128 v[204:207], v6 offset:2048
    v_mfma_f32_16x16x32_bf16 v[60:63], v[176:179], v[228:231], v[60:63]
    ds_read_b128 v[208:211], v7 offset:0
    v_mfma_f32_16x16x32_bf16 v[64:67], v[180:183], v[224:227], v[64:67]
    ds_read_b128 v[212:215], v7 offset:2048
    v_mfma_f32_16x16x32_bf16 v[68:71], v[180:183], v[228:231], v[68:71]
    ds_read_b64_tr_b16 v[136:137], v8 offset:16896
    v_mfma_f32_16x16x32_bf16 v[72:75], v[184:187], v[224:227], v[72:75]
    ds_read_b64_tr_b16 v[138:139], v8 offset:17152
    v_mfma_f32_16x16x32_bf16 v[76:79], v[184:187], v[228:231], v[76:79]
    ds_read_b64_tr_b16 v[140:141], v8 offset:16928
    v_mfma_f32_16x16x32_bf16 v[80:83], v[188:191], v[224:227], v[80:83]
    ds_read_b64_tr_b16 v[142:143], v8 offset:17184
    v_mfma_f32_16x16x32_bf16 v[84:87], v[188:191], v[228:231], v[84:87]
    ds_read_b64_tr_b16 v[144:145], v8 offset:16960
    v_mfma_f32_16x16x32_bf16 v[88:91], v[192:195], v[224:227], v[88:91]
    ds_read_b64_tr_b16 v[146:147], v8 offset:17216
    v_mfma_f32_16x16x32_bf16 v[92:95], v[192:195], v[228:231], v[92:95]
    ds_read_b64_tr_b16 v[148:149], v8 offset:16992
    v_mfma_f32_16x16x32_bf16 v[96:99], v[196:199], v[224:227], v[96:99]
    ds_read_b64_tr_b16 v[150:151], v8 offset:17248
    v_mfma_f32_16x16x32_bf16 v[100:103], v[196:199], v[228:231], v[100:103]
    ds_read_b64_tr_b16 v[152:153], v8 offset:17024
    s_setprio 0
    ds_read_b64_tr_b16 v[154:155], v8 offset:17280
    ds_read_b64_tr_b16 v[156:157], v8 offset:17056
    ds_read_b64_tr_b16 v[158:159], v8 offset:17312
    ds_read_b64_tr_b16 v[160:161], v8 offset:17088
    ds_read_b64_tr_b16 v[162:163], v8 offset:17344
    ds_read_b64_tr_b16 v[164:165], v8 offset:17120
    ds_read_b64_tr_b16 v[166:167], v8 offset:17376
    s_cmp_eq_u32 s47, 0
    s_cbranch_scc0 L_j4
    s_add_u32 s29, s29, 512
    s_mov_b32 exec_hi, 0
    buffer_load_dword v233, v232, s[60:63], s29 offen
    s_mov_b32 exec_hi, -1
L_j4:
    s_waitcnt lgkmcnt(0)
    v_mfma_f32_16x16x32_bf16 v[40:43], v[136:139], v[200:203], v[40:43]
    v_mfma_f32_16x16x32_bf16 v[44:47], v[136:139], v[204:207], v[44:47]
    v_mfma_f32_16x16x32_bf16 v[48:51], v[140:143], v[200:203], v[48:51]
    s_barrier
    s_setprio 2
    v_mfma_f32_16x16x32_bf16 v[52:55], v[140:143], v[204:207], v[52:55]
    ds_read_b64_tr_b16 v[168:169], v8 offset:33792
    v_mfma_f32_16x16x32_bf16 v[56:59], v[144:147], v[200:203], v[56:59]
    ds_read_b64_tr_b16 v[170:171], v8 offset:34048
    v_mfma_f32_16x16x32_bf16 v[60:63], v[144:147], v[204:207], v[60:63]
    ds_read_b64_tr_b16 v[172:173], v8 offset:33824
    v_mfma_f32_16x16x32_bf16 v[64:67], v[148:151], v[200:203], v[64:67]
    ds_read_b64_tr_b16 v[174:175], v8 offset:34080
    v_mfma_f32_16x16x32_bf16 v[68:71], v[148:151], v[204:207], v[68:71]
    ds_read_b64_tr_b16 v[176:177], v8 offset:33856
    v_mfma_f32_16x16x32_bf16 v[72:75], v[152:155], v[200:203], v[72:75]
    ds_read_b64_tr_b16 v[178:179], v8 offset:34112
    v_mfma_f32_16x16x32_bf16 v[76:79], v[152:155], v[204:207], v[76:79]
    ds_read_b64_tr_b16 v[180:181], v8 offset:33888
    v_mfma_f32_16x16x32_bf16 v[80:83], v[156:159], v[200:203], v[80:83]
    ds_read_b64_tr_b16 v[182:183], v8 offset:34144
    v_mfma_f32_16x16x32_bf16 v[84:87], v[156:159], v[204:207], v[84:87]
    ds_read_b64_tr_b16 v[184:185], v8 offset:33920
    v_mfma_f32_16x16x32_bf16 v[88:91], v[160:163], v[200:203], v[88:91]
    ds_read_b64_tr_b16 v[186:187], v8 offset:34176
    v_mfma_f32_16x16x32_bf16 v[92:95], v[160:163], v[204:207], v[92:95]
    ds_read_b64_tr_b16 v[188:189], v8 offset:33952
    v_mfma_f32_16x16x32_bf16 v[96:99], v[164:167], v[200:203], v[96:99]
    ds_read_b64_tr_b16 v[190:191], v8 offset:34208
    v_mfma_f32_16x16x32_bf16 v[100:103], v[164:167], v[204:207], v[100:103]
    ds_read_b64_tr_b16 v[192:193], v8 offset:33984
    s_setprio 0
    ds_read_b64_tr_b16 v[194:195], v8 offset:34240
    ds_read_b64_tr_b16 v[196:197], v8 offset:34016
    ds_read_b64_tr_b16 v[198:199], v8 offset:34272
    s_cmp_eq_u32 s47, 1
    s_cbranch_scc0 L_j5
    s_add_u32 s29, s29, 512
    s_mov_b32 exec_hi, 0
    buffer_load_dword v233, v232, s[60:63], s29 offen
    s_mov_b32 exec_hi, -1
L_j5:
    s_waitcnt lgkmcnt(0)
    v_mfma_f32_16x16x32_bf16 v[40:43], v[168:171], v[208:211], v[40:43]
    v_mfma_f32_16x16x32_bf16 v[44:47], v[168:171], v[212:215], v[44:47]
    v_mfma_f32_16x16x32_bf16 v[48:51], v[172:175], v[208:211], v[48:51]
    s_barrier
    s_setprio 2
    v_mfma_f32_16x16x32_bf16 v[52:55], v[172:175], v[212:215], v[52:55]
    ds_read_b128 v[216:219], v6 offset:16384
    v_mfma_f32_16x16x32_bf16 v[56:59], v[176:179], v[208:211], v[56:59]
    ds_read_b128 v[220:223], v6 offset:18432
    v_mfma_f32_16x16x32_bf16 v[60:63], v[176:179], v[212:215], v[60:63]
    ds_read_b128 v[224:227], v7 offset:16384
    v_mfma_f32_16x16x32_bf16 v[64:67], v[180:183], v[208:211], v[64:67]
    ds_read_b128 v[228:231], v7 offset:18432
    v_mfma_f32_16x16x32_bf16 v[68:71], v[180:183], v[212:215], v[68:71]
    ds_read_b64_tr_b16 v[136:137], v8 offset:0
    v_mfma_f32_16x16x32_bf16 v[72:75], v[184:187], v[208:211], v[72:75]
    ds_read_b64_tr_b16 v[138:139], v8 offset:256
    v_mfma_f32_16x16x32_bf16 v[76:79], v[184:187], v[212:215], v[76:79]
    ds_read_b64_tr_b16 v[140:141], v8 offset:32
    v_mfma_f32_16x16x32_bf16 v[80:83], v[188:191], v[208:211], v[80:83]
    ds_read_b64_tr_b16 v[142:143], v8 offset:288
    v_mfma_f32_16x16x32_bf16 v[84:87], v[188:191], v[212:215], v[84:87]
    ds_read_b64_tr_b16 v[144:145], v8 offset:64
    v_mfma_f32_16x16x32_bf16 v[88:91], v[192:195], v[208:211], v[88:91]
    ds_read_b64_tr_b16 v[146:147], v8 offset:320
    v_mfma_f32_16x16x32_bf16 v[92:95], v[192:195], v[212:215], v[92:95]
    ds_read_b64_tr_b16 v[148:149], v8 offset:96
    v_mfma_f32_16x16x32_bf16 v[96:99], v[196:199], v[208:211], v[96:99]
    ds_read_b64_tr_b16 v[150:151], v8 offset:352
    v_mfma_f32_16x16x32_bf16 v[100:103], v[196:199], v[212:215], v[100:103]
    ds_read_b64_tr_b16 v[152:153], v8 offset:128
    s_setprio 0
    ds_read_b64_tr_b16 v[154:155], v8 offset:384
    ds_read_b64_tr_b16 v[156:157], v8 offset:160
    ds_read_b64_tr_b16 v[158:159], v8 offset:416
    ds_read_b64_tr_b16 v[160:161], v8 offset:192
    ds_read_b64_tr_b16 v[162:163], v8 offset:448
    ds_read_b64_tr_b16 v[164:165], v8 offset:224
    ds_read_b64_tr_b16 v[166:167], v8 offset:480
    s_cmp_eq_u32 s47, 0
    s_cbranch_scc0 L_j6
    s_add_u32 m0, s69, 0
    s_mov_b32 s28, 0
    buffer_load_dwordx4 v9, s[12:15], s28 offen offset:0 nt lds
    s_add_u32 m0, s69, 32
    s_mov_b32 s28, 0
    buffer_load_dwordx4 v9, s[12:15], s28 offen offset:1024 nt lds
    s_add_u32 m0, s69, 33792
    s_mov_b32 s28, 131072
    buffer_load_dwordx4 v9, s[12:15], s28 offen offset:0 nt lds
    s_add_u32 m0, s69, 33824
    s_mov_b32 s28, 131072
    buffer_load_dwordx4 v9, s[12:15], s28 offen offset:1024 nt lds
L_j6:
    s_waitcnt lgkmcnt(0)
    v_mfma_f32_16x16x32_bf16 v[40:43], v[136:139], v[216:219], v[40:43]
    v_mfma_f32_16x16x32_bf16 v[44:47], v[136:139], v[220:223], v[44:47]
    v_mfma_f32_16x16x32_bf16 v[48:51], v[140:143], v[216:219], v[48:51]
    s_barrier
    s_setprio 2
    v_mfma_f32_16x16x32_bf16 v[52:55], v[140:143], v[220:223], v[52:55]
    ds_read_b64_tr_b16 v[168:169], v8 offset:16896
    v_mfma_f32_16x16x32_bf16 v[56:59], v[144:147], v[216:219], v[56:59]
    ds_read_b64_tr_b16 v[170:171], v8 offset:17152
    v_mfma_f32_16x16x32_bf16 v[60:63], v[144:147], v[220:223], v[60:63]
    ds_read_b64_tr_b16 v[172:173], v8 offset:16928
    v_mfma_f32_16x16x32_bf16 v[64:67], v[148:151], v[216:219], v[64:67]
    ds_read_b64_tr_b16 v[174:175], v8 offset:17184
    v_mfma_f32_16x16x32_bf16 v[68:71], v[148:151], v[220:223], v[68:71]
    ds_read_b64_tr_b16 v[176:177], v8 offset:16960
    v_mfma_f32_16x16x32_bf16 v[72:75], v[152:155], v[216:219], v[72:75]
    ds_read_b64_tr_b16 v[178:179], v8 offset:17216
    v_mfma_f32_16x16x32_bf16 v[76:79], v[152:155], v[220:223], v[76:79]
    ds_read_b64_tr_b16 v[180:181], v8 offset:16992
    v_mfma_f32_16x16x32_bf16 v[80:83], v[156:159], v[216:219], v[80:83]
    ds_read_b64_tr_b16 v[182:183], v8 offset:17248
    v_mfma_f32_16x16x32_bf16 v[84:87], v[156:159], v[220:223], v[84:87]
    ds_read_b64_tr_b16 v[184:185], v8 offset:17024
    v_mfma_f32_16x16x32_bf16 v[88:91], v[160:163], v[216:219], v[88:91]
    ds_read_b64_tr_b16 v[186:187], v8 offset:17280
    v_mfma_f32_16x16x32_bf16 v[92:95], v[160:163], v[220:223], v[92:95]
    ds_read_b64_tr_b16 v[188:189], v8 offset:17056
    v_mfma_f32_16x16x32_bf16 v[96:99], v[164:167], v[216:219], v[96:99]
    ds_read_b64_tr_b16 v[190:191], v8 offset:17312
    v_mfma_f32_16x16x32_bf16 v[100:103], v[164:167], v[220:223], v[100:103]
    ds_read_b64_tr_b16 v[192:193], v8 offset:17088
    s_setprio 0
    ds_read_b64_tr_b16 v[194:195], v8 offset:17344
    ds_read_b64_tr_b16 v[196:197], v8 offset:17120
    ds_read_b64_tr_b16 v[198:199], v8 offset:17376
    s_cmp_eq_u32 s47, 1
    s_cbranch_scc0 L_j7
    s_add_u32 m0, s69, 0
    s_mov_b32 s28, 0
    buffer_load_dwordx4 v9, s[12:15], s28 offen offset:0 nt lds
    s_add_u32 m0, s69, 32
    s_mov_b32 s28, 0
    buffer_load_dwordx4 v9, s[12:15], s28 offen offset:1024 nt lds
    s_add_u32 m0, s69, 33792
    s_mov_b32 s28, 131072
    buffer_load_dwordx4 v9, s[12:15], s28 offen offset:0 nt lds
    s_add_u32 m0, s69, 33824
    s_mov_b32 s28, 131072
    buffer_load_dwordx4 v9, s[12:15], s28 offen offset:1024 nt lds
L_j7:
    s_waitcnt lgkmcnt(0)
    v_mfma_f32_16x16x32_bf16 v[40:43], v[168:171], v[224:227], v[40:43]
    v_mfma_f32_16x16x32_bf16 v[44:47], v[168:171], v[228:231], v[44:47]
    v_mfma_f32_16x16x32_bf16 v[48:51], v[172:175], v[224:227], v[48:51]
    s_barrier
    s_setprio 2
    v_mfma_f32_16x16x32_bf16 v[52:55], v[172:175], v[228:231], v[52:55]
    ds_read_b128 v[200:203], v6 offset:0
    v_mfma_f32_16x16x32_bf16 v[56:59], v[176:179], v[224:227], v[56:59]
    ds_read_b128 v[204:207], v6 offset:2048
    v_mfma_f32_16x16x32_bf16 v[60:63], v[176:179], v[228:231], v[60:63]
    ds_read_b128 v[208:211], v7 offset:0
    v_mfma_f32_16x16x32_bf16 v[64:67], v[180:183], v[224:227], v[64:67]
    ds_read_b128 v[212:215], v7 offset:2048
    v_mfma_f32_16x16x32_bf16 v[68:71], v[180:183], v[228:231], v[68:71]
    ds_read_b64_tr_b16 v[136:137], v8 offset:33792
    v_mfma_f32_16x16x32_bf16 v[72:75], v[184:187], v[224:227], v[72:75]
    ds_read_b64_tr_b16 v[138:139], v8 offset:34048
    v_mfma_f32_16x16x32_bf16 v[76:79], v[184:187], v[228:231], v[76:79]
    ds_read_b64_tr_b16 v[140:141], v8 offset:33824
    v_mfma_f32_16x16x32_bf16 v[80:83], v[188:191], v[224:227], v[80:83]
    ds_read_b64_tr_b16 v[142:143], v8 offset:34080
    v_mfma_f32_16x16x32_bf16 v[84:87], v[188:191], v[228:231], v[84:87]
    ds_read_b64_tr_b16 v[144:145], v8 offset:33856
    v_mfma_f32_16x16x32_bf16 v[88:91], v[192:195], v[224:227], v[88:91]
    ds_read_b64_tr_b16 v[146:147], v8 offset:34112
    v_mfma_f32_16x16x32_bf16 v[92:95], v[192:195], v[228:231], v[92:95]
    ds_read_b64_tr_b16 v[148:149], v8 offset:33888
    v_mfma_f32_16x16x32_bf16 v[96:99], v[196:199], v[224:227], v[96:99]
    ds_read_b64_tr_b16 v[150:151], v8 offset:34144
    v_mfma_f32_16x16x32_bf16 v[100:103], v[196:199], v[228:231], v[100:103]
    ds_read_b64_tr_b16 v[152:153], v8 offset:33920
    s_setprio 0
    ds_read_b64_tr_b16 v[154:155], v8 offset:34176
    ds_read_b64_tr_b16 v[156:157], v8 offset:33952
    ds_read_b64_tr_b16 v[158:159], v8 offset:34208
    ds_read_b64_tr_b16 v[160:161], v8 offset:33984
    ds_read_b64_tr_b16 v[162:163], v8 offset:34240
    ds_read_b64_tr_b16 v[164:165], v8 offset:34016
    ds_read_b64_tr_b16 v[166:167], v8 offset:34272
    s_cmp_eq_u32 s47, 0
    s_cbranch_scc0 L_j8
    s_add_u32 m0, s69, 8448
    s_mov_b32 s28, 0
    buffer_load_dwordx4 v9, s[16:19], s28 offen offset:0 nt lds
    s_add_u32 m0, s69, 8480
    s_mov_b32 s28, 0
    buffer_load_dwordx4 v9, s[16:19], s28 offen offset:1024 nt lds
    s_add_u32 m0, s69, 42240
    s_mov_b32 s28, 131072
    buffer_load_dwordx4 v9, s[16:19], s28 offen offset:0 nt lds
    s_add_u32 m0, s69, 42272
    s_mov_b32 s28, 131072
    buffer_load_dwordx4 v9, s[16:19], s28 offen offset:1024 nt lds
L_j8:
    s_waitcnt lgkmcnt(0)
    v_mfma_f32_16x16x32_bf16 v[40:43], v[136:139], v[200:203], v[40:43]
    v_mfma_f32_16x16x32_bf16 v[44:47], v[136:139], v[204:207], v[44:47]
    v_mfma_f32_16x16x32_bf16 v[48:51], v[140:143], v[200:203], v[48:51]
    s_barrier
    s_setprio 2
    v_mfma_f32_16x16x32_bf16 v[52:55], v[140:143], v[204:207], v[52:55]
    ds_read_b64_tr_b16 v[168:169], v8 offset:0
    v_mfma_f32_16x16x32_bf16 v[56:59], v[144:147], v[200:203], v[56:59]
    ds_read_b64_tr_b16 v[170:171], v8 offset:256
    v_mfma_f32_16x16x32_bf16 v[60:63], v[144:147], v[204:207], v[60:63]
    ds_read_b64_tr_b16 v[172:173], v8 offset:32
    v_mfma_f32_16x16x32_bf16 v[64:67], v[148:151], v[200:203], v[64:67]
    ds_read_b64_tr_b16 v[174:175], v8 offset:288
    v_mfma_f32_16x16x32_bf16 v[68:71], v[148:151], v[204:207], v[68:71]
    ds_read_b64_tr_b16 v[176:177], v8 offset:64
    v_mfma_f32_16x16x32_bf16 v[72:75], v[152:155], v[200:203], v[72:75]
    ds_read_b64_tr_b16 v[178:179], v8 offset:320
    v_mfma_f32_16x16x32_bf16 v[76:79], v[152:155], v[204:207], v[76:79]
    ds_read_b64_tr_b16 v[180:181], v8 offset:96
    v_mfma_f32_16x16x32_bf16 v[80:83], v[156:159], v[200:203], v[80:83]
    ds_read_b64_tr_b16 v[182:183], v8 offset:352
    v_mfma_f32_16x16x32_bf16 v[84:87], v[156:159], v[204:207], v[84:87]
    ds_read_b64_tr_b16 v[184:185], v8 offset:128
    v_mfma_f32_16x16x32_bf16 v[88:91], v[160:163], v[200:203], v[88:91]
    ds_read_b64_tr_b16 v[186:187], v8 offset:384
    v_mfma_f32_16x16x32_bf16 v[92:95], v[160:163], v[204:207], v[92:95]
    ds_read_b64_tr_b16 v[188:189], v8 offset:160
    v_mfma_f32_16x16x32_bf16 v[96:99], v[164:167], v[200:203], v[96:99]
    ds_read_b64_tr_b16 v[190:191], v8 offset:416
    v_mfma_f32_16x16x32_bf16 v[100:103], v[164:167], v[204:207], v[100:103]
    ds_read_b64_tr_b16 v[192:193], v8 offset:192
    s_setprio 0
    ds_read_b64_tr_b16 v[194:195], v8 offset:448
    ds_read_b64_tr_b16 v[196:197], v8 offset:224
    ds_read_b64_tr_b16 v[198:199], v8 offset:480
    s_cmp_eq_u32 s47, 1
    s_cbranch_scc0 L_j9
    s_add_u32 m0, s69, 8448
    s_mov_b32 s28, 0
    buffer_load_dwordx4 v9, s[16:19], s28 offen offset:0 nt lds
    s_add_u32 m0, s69, 8480
    s_mov_b32 s28, 0
    buffer_load_dwordx4 v9, s[16:19], s28 offen offset:1024 nt lds
    s_add_u32 m0, s69, 42240
    s_mov_b32 s28, 131072
    buffer_load_dwordx4 v9, s[16:19], s28 offen offset:0 nt lds
    s_add_u32 m0, s69, 42272
    s_mov_b32 s28, 131072
    buffer_load_dwordx4 v9, s[16:19], s28 offen offset:1024 nt lds
L_j9:
    s_waitcnt lgkmcnt(0)
    v_mfma_f32_16x16x32_bf16 v[40:43], v[168:171], v[208:211], v[40:43]
    v_mfma_f32_16x16x32_bf16 v[44:47], v[168:171], v[212:215], v[44:47]
    v_mfma_f32_16x16x32_bf16 v[48:51], v[172:175], v[208:211], v[48:51]
    s_barrier
    s_setprio 2
    v_mfma_f32_16x16x32_bf16 v[52:55], v[172:175], v[212:215], v[52:55]
    ds_read_b128 v[216:219], v6 offset:16384
    v_mfma_f32_16x16x32_bf16 v[56:59], v[176:179], v[208:211], v[56:59]
    ds_read_b128 v[220:223], v6 offset:18432
    v_mfma_f32_16x16x32_bf16 v[60:63], v[176:179], v[212:215], v[60:63]
    ds_read_b128 v[224:227], v7 offset:16384
    v_mfma_f32_16x16x32_bf16 v[64:67], v[180:183], v[208:211], v[64:67]
    ds_read_b128 v[228:231], v7 offset:18432
    v_mfma_f32_16x16x32_bf16 v[68:71], v[180:183], v[212:215], v[68:71]
    ds_read_b64_tr_b16 v[136:137], v8 offset:16896
    v_mfma_f32_16x16x32_bf16 v[72:75], v[184:187], v[208:211], v[72:75]
    ds_read_b64_tr_b16 v[138:139], v8 offset:17152
    v_mfma_f32_16x16x32_bf16 v[76:79], v[184:187], v[212:215], v[76:79]
    ds_read_b64_tr_b16 v[140:141], v8 offset:16928
    v_mfma_f32_16x16x32_bf16 v[80:83], v[188:191], v[208:211], v[80:83]
    ds_read_b64_tr_b16 v[142:143], v8 offset:17184
    v_mfma_f32_16x16x32_bf16 v[84:87], v[188:191], v[212:215], v[84:87]
    ds_read_b64_tr_b16 v[144:145], v8 offset:16960
    v_mfma_f32_16x16x32_bf16 v[88:91], v[192:195], v[208:211], v[88:91]
    ds_read_b64_tr_b16 v[146:147], v8 offset:17216
    v_mfma_f32_16x16x32_bf16 v[92:95], v[192:195], v[212:215], v[92:95]
    ds_read_b64_tr_b16 v[148:149], v8 offset:16992
    v_mfma_f32_16x16x32_bf16 v[96:99], v[196:199], v[208:211], v[96:99]
    ds_read_b64_tr_b16 v[150:151], v8 offset:17248
    v_mfma_f32_16x16x32_bf16 v[100:103], v[196:199], v[212:215], v[100:103]
    ds_read_b64_tr_b16 v[152:153], v8 offset:17024
    s_setprio 0
    ds_read_b64_tr_b16 v[154:155], v8 offset:17280
    ds_read_b64_tr_b16 v[156:157], v8 offset:17056
    ds_read_b64_tr_b16 v[158:159], v8 offset:17312
    ds_read_b64_tr_b16 v[160:161], v8 offset:17088
    ds_read_b64_tr_b16 v[162:163], v8 offset:17344
    ds_read_b64_tr_b16 v[164:165], v8 offset:17120
    ds_read_b64_tr_b16 v[166:167], v8 offset:17376
    s_cmp_eq_u32 s47, 0
    s_cbranch_scc0 L_j10
    s_add_u32 s101, s101, 0x200000
    s_mov_b32 exec_hi, 0
    buffer_load_dword v233, v234, s[8:11], s101 offen
    s_mov_b32 exec_hi, -1
L_j10:
    s_waitcnt lgkmcnt(0)
    v_mfma_f32_16x16x32_bf16 v[40:43], v[136:139], v[216:219], v[40:43]
    v_mfma_f32_16x16x32_bf16 v[44:47], v[136:139], v[220:223], v[44:47]
    v_mfma_f32_16x16x32_bf16 v[48:51], v[140:143], v[216:219], v[48:51]
    s_barrier
    s_setprio 2
    v_mfma_f32_16x16x32_bf16 v[52:55], v[140:143], v[220:223], v[52:55]
    ds_read_b64_tr_b16 v[168:169], v8 offset:33792
    v_mfma_f32_16x16x32_bf16 v[56:59], v[144:147], v[216:219], v[56:59]
    ds_read_b64_tr_b16 v[170:171], v8 offset:34048
    v_mfma_f32_16x16x32_bf16 v[60:63], v[144:147], v[220:223], v[60:63]
    ds_read_b64_tr_b16 v[172:173], v8 offset:33824
    v_mfma_f32_16x16x32_bf16 v[64:67], v[148:151], v[216:219], v[64:67]
    ds_read_b64_tr_b16 v[174:175], v8 offset:34080
    v_mfma_f32_16x16x32_bf16 v[68:71], v[148:151], v[220:223], v[68:71]
    ds_read_b64_tr_b16 v[176:177], v8 offset:33856
    v_mfma_f32_16x16x32_bf16 v[72:75], v[152:155], v[216:219], v[72:75]
    ds_read_b64_tr_b16 v[178:179], v8 offset:34112
    v_mfma_f32_16x16x32_bf16 v[76:79], v[152:155], v[220:223], v[76:79]
    ds_read_b64_tr_b16 v[180:181], v8 offset:33888
    v_mfma_f32_16x16x32_bf16 v[80:83], v[156:159], v[216:219], v[80:83]
    ds_read_b64_tr_b16 v[182:183], v8 offset:34144
    v_mfma_f32_16x16x32_bf16 v[84:87], v[156:159], v[220:223], v[84:87]
    ds_read_b64_tr_b16 v[184:185], v8 offset:33920
    v_mfma_f32_16x16x32_bf16 v[88:91], v[160:163], v[216:219], v[88:91]
    ds_read_b64_tr_b16 v[186:187], v8 offset:34176
    v_mfma_f32_16x16x32_bf16 v[92:95], v[160:163], v[220:223], v[92:95]
    ds_read_b64_tr_b16 v[188:189], v8 offset:33952
    v_mfma_f32_16x16x32_bf16 v[96:99], v[164:167], v[216:219], v[96:99]
    ds_read_b64_tr_b16 v[190:191], v8 offset:34208
    v_mfma_f32_16x16x32_bf16 v[100:103], v[164:167], v[220:223], v[100:103]
    ds_read_b64_tr_b16 v[192:193], v8 offset:33984
    s_setprio 0
    ds_read_b64_tr_b16 v[194:195], v8 offset:34240
    ds_read_b64_tr_b16 v[196:197], v8 offset:34016
    ds_read_b64_tr_b16 v[198:199], v8 offset:34272
    s_cmp_eq_u32 s47, 1
    s_cbranch_scc0 L_j11
    s_add_u32 s101, s101, 0x200000
    s_mov_b32 exec_hi, 0
    buffer_load_dword v233, v234, s[8:11], s101 offen
    s_mov_b32 exec_hi, -1
L_j11:
    s_waitcnt lgkmcnt(0)
    v_mfma_f32_16x16x32_bf16 v[40:43], v[168:171], v[224:227], v[40:43]
    v_mfma_f32_16x16x32_bf16 v[44:47], v[168:171], v[228:231], v[44:47]
    v_mfma_f32_16x16x32_bf16 v[48:51], v[172:175], v[224:227], v[48:51]
    s_barrier
    s_setprio 2
    v_mfma_f32_16x16x32_bf16 v[52:55], v[172:175], v[228:231], v[52:55]
    ds_read_b128 v[200:203], v6 offset:0
    v_mfma_f32_16x16x32_bf16 v[56:59], v[176:179], v[224:227], v[56:59]
    ds_read_b128 v[204:207], v6 offset:2048
    v_mfma_f32_16x16x32_bf16 v[60:63], v[176:179], v[228:231], v[60:63]
    ds_read_b128 v[208:211], v7 offset:0
    v_mfma_f32_16x16x32_bf16 v[64:67], v[180:183], v[224:227], v[64:67]
    ds_read_b128 v[212:215], v7 offset:2048
    v_mfma_f32_16x16x32_bf16 v[68:71], v[180:183], v[228:231], v[68:71]
    ds_read_b64_tr_b16 v[136:137], v8 offset:0
    v_mfma_f32_16x16x32_bf16 v[72:75], v[184:187], v[224:227], v[72:75]
    ds_read_b64_tr_b16 v[138:139], v8 offset:256
    v_mfma_f32_16x16x32_bf16 v[76:79], v[184:187], v[228:231], v[76:79]
    ds_read_b64_tr_b16 v[140:141], v8 offset:32
    v_mfma_f32_16x16x32_bf16 v[80:83], v[188:191], v[224:227], v[80:83]
    ds_read_b64_tr_b16 v[142:143], v8 offset:288
    v_mfma_f32_16x16x32_bf16 v[84:87], v[188:191], v[228:231], v[84:87]
    ds_read_b64_tr_b16 v[144:145], v8 offset:64
    v_mfma_f32_16x16x32_bf16 v[88:91], v[192:195], v[224:227], v[88:91]
    ds_read_b64_tr_b16 v[146:147], v8 offset:320
    v_mfma_f32_16x16x32_bf16 v[92:95], v[192:195], v[228:231], v[92:95]
    ds_read_b64_tr_b16 v[148:149], v8 offset:96
    v_mfma_f32_16x16x32_bf16 v[96:99], v[196:199], v[224:227], v[96:99]
    ds_read_b64_tr_b16 v[150:151], v8 offset:352
    v_mfma_f32_16x16x32_bf16 v[100:103], v[196:199], v[228:231], v[100:103]
    ds_read_b64_tr_b16 v[152:153], v8 offset:128
    s_setprio 0
    ds_read_b64_tr_b16 v[154:155], v8 offset:384
    ds_read_b64_tr_b16 v[156:157], v8 offset:160
    ds_read_b64_tr_b16 v[158:159], v8 offset:416
    ds_read_b64_tr_b16 v[160:161], v8 offset:192
    ds_read_b64_tr_b16 v[162:163], v8 offset:448
    ds_read_b64_tr_b16 v[164:165], v8 offset:224
    ds_read_b64_tr_b16 v[166:167], v8 offset:480
    s_cmp_eq_u32 s47, 0
    s_cbranch_scc0 L_j12
    s_add_u32 s29, s29, 512
    s_mov_b32 exec_hi, 0
    buffer_load_dword v233, v232, s[60:63], s29 offen
    s_mov_b32 exec_hi, -1
L_j12:
    s_waitcnt lgkmcnt(0)
    v_mfma_f32_16x16x32_bf16 v[40:43], v[136:139], v[200:203], v[40:43]
    v_mfma_f32_16x16x32_bf16 v[44:47], v[136:139], v[204:207], v[44:47]
    v_mfma_f32_16x16x32_bf16 v[48:51], v[140:143], v[200:203], v[48:51]
    s_barrier
    s_setprio 2
    v_mfma_f32_16x16x32_bf16 v[52:55], v[140:143], v[204:207], v[52:55]
    ds_read_b64_tr_b16 v[168:169], v8 offset:16896
    v_mfma_f32_16x16x32_bf16 v[56:59], v[144:147], v[200:203], v[56:59]
    ds_read_b64_tr_b16 v[170:171], v8 offset:17152
    v_mfma_f32_16x16x32_bf16 v[60:63], v[144:147], v[204:207], v[60:63]
    ds_read_b64_tr_b16 v[172:173], v8 offset:16928
    v_mfma_f32_16x16x32_bf16 v[64:67], v[148:151], v[200:203], v[64:67]
    ds_read_b64_tr_b16 v[174:175], v8 offset:17184
    v_mfma_f32_16x16x32_bf16 v[68:71], v[148:151], v[204:207], v[68:71]
    ds_read_b64_tr_b16 v[176:177], v8 offset:16960
    v_mfma_f32_16x16x32_bf16 v[72:75], v[152:155], v[200:203], v[72:75]
    ds_read_b64_tr_b16 v[178:179], v8 offset:17216
    v_mfma_f32_16x16x32_bf16 v[76:79], v[152:155], v[204:207], v[76:79]
    ds_read_b64_tr_b16 v[180:181], v8 offset:16992
    v_mfma_f32_16x16x32_bf16 v[80:83], v[156:159], v[200:203], v[80:83]
    ds_read_b64_tr_b16 v[182:183], v8 offset:17248
    v_mfma_f32_16x16x32_bf16 v[84:87], v[156:159], v[204:207], v[84:87]
    ds_read_b64_tr_b16 v[184:185], v8 offset:17024
    v_mfma_f32_16x16x32_bf16 v[88:91], v[160:163], v[200:203], v[88:91]
    ds_read_b64_tr_b16 v[186:187], v8 offset:17280
    v_mfma_f32_16x16x32_bf16 v[92:95], v[160:163], v[204:207], v[92:95]
    ds_read_b64_tr_b16 v[188:189], v8 offset:17056
    v_mfma_f32_16x16x32_bf16 v[96:99], v[164:167], v[200:203], v[96:99]
    ds_read_b64_tr_b16 v[190:191], v8 offset:17312
    v_mfma_f32_16x16x32_bf16 v[100:103], v[164:167], v[204:207], v[100:103]
    ds_read_b64_tr_b16 v[192:193], v8 offset:17088
    s_setprio 0
    ds_read_b64_tr_b16 v[194:195], v8 offset:17344
    ds_read_b64_tr_b16 v[196:197], v8 offset:17120
    ds_read_b64_tr_b16 v[198:199], v8 offset:17376
    s_cmp_eq_u32 s47, 1
    s_cbranch_scc0 L_j13
    s_add_u32 s29, s29, 512
    s_mov_b32 exec_hi, 0
    buffer_load_dword v233, v232, s[60:63], s29 offen
    s_mov_b32 exec_hi, -1
L_j13:
    s_waitcnt lgkmcnt(0)
    v_mfma_f32_16x16x32_bf16 v[40:43], v[168:171], v[208:211], v[40:43]
    v_mfma_f32_16x16x32_bf16 v[44:47], v[168:171], v[212:215], v[44:47]
    v_mfma_f32_16x16x32_bf16 v[48:51], v[172:175], v[208:211], v[48:51]
    s_barrier
    s_setprio 2
    v_mfma_f32_16x16x32_bf16 v[52:55], v[172:175], v[212:215], v[52:55]
    ds_read_b128 v[216:219], v6 offset:16384
    v_mfma_f32_16x16x32_bf16 v[56:59], v[176:179], v[208:211], v[56:59]
    ds_read_b128 v[220:223], v6 offset:18432
    v_mfma_f32_16x16x32_bf16 v[60:63], v[176:179], v[212:215], v[60:63]
    ds_read_b128 v[224:227], v7 offset:16384
    v_mfma_f32_16x16x32_bf16 v[64:67], v[180:183], v[208:211], v[64:67]
    ds_read_b128 v[228:231], v7 offset:18432
    v_mfma_f32_16x16x32_bf16 v[68:71], v[180:183], v[212:215], v[68:71]
    ds_read_b64_tr_b16 v[136:137], v8 offset:33792
    v_mfma_f32_16x16x32_bf16 v[72:75], v[184:187], v[208:211], v[72:75]
    ds_read_b64_tr_b16 v[138:139], v8 offset:34048
    v_mfma_f32_16x16x32_bf16 v[76:79], v[184:187], v[212:215], v[76:79]
    ds_read_b64_tr_b16 v[140:141], v8 offset:33824
    v_mfma_f32_16x16x32_bf16 v[80:83], v[188:191], v[208:211], v[80:83]
    ds_read_b64_tr_b16 v[142:143], v8 offset:34080
    v_mfma_f32_16x16x32_bf16 v[84:87], v[188:191], v[212:215], v[84:87]
    ds_read_b64_tr_b16 v[144:145], v8 offset:33856
    v_mfma_f32_16x16x32_bf16 v[88:91], v[192:195], v[208:211], v[88:91]
    ds_read_b64_tr_b16 v[146:147], v8 offset:34112
    v_mfma_f32_16x16x32_bf16 v[92:95], v[192:195], v[212:215], v[92:95]
    ds_read_b64_tr_b16 v[148:149], v8 offset:33888
    v_mfma_f32_16x16x32_bf16 v[96:99], v[196:199], v[208:211], v[96:99]
    ds_read_b64_tr_b16 v[150:151], v8 offset:34144
    v_mfma_f32_16x16x32_bf16 v[100:103], v[196:199], v[212:215], v[100:103]
    ds_read_b64_tr_b16 v[152:153], v8 offset:33920
    s_setprio 0
    ds_read_b64_tr_b16 v[154:155], v8 offset:34176
    ds_read_b64_tr_b16 v[156:157], v8 offset:33952
    ds_read_b64_tr_b16 v[158:159], v8 offset:34208
    ds_read_b64_tr_b16 v[160:161], v8 offset:33984
    ds_read_b64_tr_b16 v[162:163], v8 offset:34240
    ds_read_b64_tr_b16 v[164:165], v8 offset:34016
    ds_read_b64_tr_b16 v[166:167], v8 offset:34272
    s_cmp_eq_u32 s47, 0
    s_cbranch_scc0 L_j14
    s_add_u32 m0, s69, 16896
    s_mov_b32 s28, 8192
    buffer_load_dwordx4 v9, s[12:15], s28 offen offset:0 nt lds
    s_add_u32 m0, s69, 16928
    s_mov_b32 s28, 8192
    buffer_load_dwordx4 v9, s[12:15], s28 offen offset:1024 nt lds
    s_add_u32 m0, s69, 50688
    s_mov_b32 s28, 139264
    buffer_load_dwordx4 v9, s[12:15], s28 offen offset:0 nt lds
    s_add_u32 m0, s69, 50720
    s_mov_b32 s28, 139264
    buffer_load_dwordx4 v9, s[12:15], s28 offen offset:1024 nt lds
L_j14:
    s_waitcnt lgkmcnt(0)
    v_mfma_f32_16x16x32_bf16 v[40:43], v[136:139], v[216:219], v[40:43]
    v_mfma_f32_16x16x32_bf16 v[44:47], v[136:139], v[220:223], v[44:47]
    v_mfma_f32_16x16x32_bf16 v[48:51], v[140:143], v[216:219], v[48:51]
    s_barrier
    s_setprio 2
    v_mfma_f32_16x16x32_bf16 v[52:55], v[140:143], v[220:223], v[52:55]
    ds_read_b64_tr_b16 v[168:169], v8 offset:0
    v_mfma_f32_16x16x32_bf16 v[56:59], v[144:147], v[216:219], v[56:59]
    ds_read_b64_tr_b16 v[170:171], v8 offset:256
    v_mfma_f32_16x16x32_bf16 v[60:63], v[144:147], v[220:223], v[60:63]
    ds_read_b64_tr_b16 v[172:173], v8 offset:32
    v_mfma_f32_16x16x32_bf16 v[64:67], v[148:151], v[216:219], v[64:67]
    ds_read_b64_tr_b16 v[174:175], v8 offset:288
    v_mfma_f32_16x16x32_bf16 v[68:71], v[148:151], v[220:223], v[68:71]
    ds_read_b64_tr_b16 v[176:177], v8 offset:64
    v_mfma_f32_16x16x32_bf16 v[72:75], v[152:155], v[216:219], v[72:75]
    ds_read_b64_tr_b16 v[178:179], v8 offset:320
    v_mfma_f32_16x16x32_bf16 v[76:79], v[152:155], v[220:223], v[76:79]
    ds_read_b64_tr_b16 v[180:181], v8 offset:96
    v_mfma_f32_16x16x32_bf16 v[80:83], v[156:159], v[216:219], v[80:83]
    ds_read_b64_tr_b16 v[182:183], v8 offset:352
    v_mfma_f32_16x16x32_bf16 v[84:87], v[156:159], v[220:223], v[84:87]
    ds_read_b64_tr_b16 v[184:185], v8 offset:128
    v_mfma_f32_16x16x32_bf16 v[88:91], v[160:163], v[216:219], v[88:91]
    ds_read_b64_tr_b16 v[186:187], v8 offset:384
    v_mfma_f32_16x16x32_bf16 v[92:95], v[160:163], v[220:223], v[92:95]
    ds_read_b64_tr_b16 v[188:189], v8 offset:160
    v_mfma_f32_16x16x32_bf16 v[96:99], v[164:167], v[216:219], v[96:99]
    ds_read_b64_tr_b16 v[190:191], v8 offset:416
    v_mfma_f32_16x16x32_bf16 v[100:103], v[164:167], v[220:223], v[100:103]
    ds_read_b64_tr_b16 v[192:193], v8 offset:192
    s_setprio 0
    ds_read_b64_tr_b16 v[194:195], v8 offset:448
    ds_read_b64_tr_b16 v[196:197], v8 offset:224
    ds_read_b64_tr_b16 v[198:199], v8 offset:480
    s_cmp_eq_u32 s47, 1
    s_cbranch_scc0 L_j15
    s_add_u32 m0, s69, 16896
    s_mov_b32 s28, 8192
    buffer_load_dwordx4 v9, s[12:15], s28 offen offset:0 nt lds
    s_add_u32 m0, s69, 16928
    s_mov_b32 s28, 8192
    buffer_load_dwordx4 v9, s[12:15], s28 offen offset:1024 nt lds
    s_add_u32 m0, s69, 50688
    s_mov_b32 s28, 139264
    buffer_load_dwordx4 v9, s[12:15], s28 offen offset:0 nt lds
    s_add_u32 m0, s69, 50720
    s_mov_b32 s28, 139264
    buffer_load_dwordx4 v9, s[12:15], s28 offen offset:1024 nt lds
L_j15:
    s_waitcnt lgkmcnt(0)
    v_mfma_f32_16x16x32_bf16 v[40:43], v[168:171], v[224:227], v[40:43]
    v_mfma_f32_16x16x32_bf16 v[44:47], v[168:171], v[228:231], v[44:47]
    v_mfma_f32_16x16x32_bf16 v[48:51], v[172:175], v[224:227], v[48:51]
    s_barrier
    s_setprio 2
    v_mfma_f32_16x16x32_bf16 v[52:55], v[172:175], v[228:231], v[52:55]
    ds_read_b128 v[200:203], v6 offset:0
    v_mfma_f32_16x16x32_bf16 v[56:59], v[176:179], v[224:227], v[56:59]
    ds_read_b128 v[204:207], v6 offset:2048
    v_mfma_f32_16x16x32_bf16 v[60:63], v[176:179], v[228:231], v[60:63]
    ds_read_b128 v[208:211], v7 offset:0
    v_mfma_f32_16x16x32_bf16 v[64:67], v[180:183], v[224:227], v[64:67]
    ds_read_b128 v[212:215], v7 offset:2048
    v_mfma_f32_16x16x32_bf16 v[68:71], v[180:183], v[228:231], v[68:71]
    ds_read_b64_tr_b16 v[136:137], v8 offset:16896
    v_mfma_f32_16x16x32_bf16 v[72:75], v[184:187], v[224:227], v[72:75]
    ds_read_b64_tr_b16 v[138:139], v8 offset:17152
    v_mfma_f32_16x16x32_bf16 v[76:79], v[184:187], v[228:231], v[76:79]
    ds_read_b64_tr_b16 v[140:141], v8 offset:16928
    v_mfma_f32_16x16x32_bf16 v[80:83], v[188:191], v[224:227], v[80:83]
    ds_read_b64_tr_b16 v[142:143], v8 offset:17184
    v_mfma_f32_16x16x32_bf16 v[84:87], v[188:191], v[228:231], v[84:87]
    ds_read_b64_tr_b16 v[144:145], v8 offset:16960
    v_mfma_f32_16x16x32_bf16 v[88:91], v[192:195], v[224:227], v[88:91]
    ds_read_b64_tr_b16 v[146:147], v8 offset:17216
    v_mfma_f32_16x16x32_bf16 v[92:95], v[192:195], v[228:231], v[92:95]
    ds_read_b64_tr_b16 v[148:149], v8 offset:16992
    v_mfma_f32_16x16x32_bf16 v[96:99], v[196:199], v[224:227], v[96:99]
    ds_read_b64_tr_b16 v[150:151], v8 offset:17248
    v_mfma_f32_16x16x32_bf16 v[100:103], v[196:199], v[228:231], v[100:103]
    ds_read_b64_tr_b16 v[152:153], v8 offset:17024
    s_setprio 0
    ds_read_b64_tr_b16 v[154:155], v8 offset:17280
    ds_read_b64_tr_b16 v[156:157], v8 offset:17056
    ds_read_b64_tr_b16 v[158:159], v8 offset:17312
    ds_read_b64_tr_b16 v[160:161], v8 offset:17088
    ds_read_b64_tr_b16 v[162:163], v8 offset:17344
    ds_read_b64_tr_b16 v[164:165], v8 offset:17120
    ds_read_b64_tr_b16 v[166:167], v8 offset:17376
    s_cmp_eq_u32 s47, 0
    s_cbranch_scc0 L_j16
    s_add_u32 m0, s69, 25344
    s_mov_b32 s28, 8192
    buffer_load_dwordx4 v9, s[16:19], s28 offen offset:0 nt lds
    s_add_u32 m0, s69, 25376
    s_mov_b32 s28, 8192
    buffer_load_dwordx4 v9, s[16:19], s28 offen offset:1024 nt lds
    s_add_u32 m0, s69, 59136
    s_mov_b32 s28, 139264
    buffer_load_dwordx4 v9, s[16:19], s28 offen offset:0 nt lds
    s_add_u32 m0, s69, 59168
    s_mov_b32 s28, 139264
    buffer_load_dwordx4 v9, s[16:19], s28 offen offset:1024 nt lds
L_j16:
    s_waitcnt lgkmcnt(0)
    v_mfma_f32_16x16x32_bf16 v[40:43], v[136:139], v[200:203], v[40:43]
    v_mfma_f32_16x16x32_bf16 v[44:47], v[136:139], v[204:207], v[44:47]
    v_mfma_f32_16x16x32_bf16 v[48:51], v[140:143], v[200:203], v[48:51]
    s_barrier
    s_setprio 2
    v_mfma_f32_16x16x32_bf16 v[52:55], v[140:143], v[204:207], v[52:55]
    ds_read_b64_tr_b16 v[168:169], v8 offset:33792
    v_mfma_f32_16x16x32_bf16 v[56:59], v[144:147], v[200:203], v[56:59]
    ds_read_b64_tr_b16 v[170:171], v8 offset:34048
    v_mfma_f32_16x16x32_bf16 v[60:63], v[144:147], v[204:207], v[60:63]
    ds_read_b64_tr_b16 v[172:173], v8 offset:33824
    v_mfma_f32_16x16x32_bf16 v[64:67], v[148:151], v[200:203], v[64:67]
    ds_read_b64_tr_b16 v[174:175], v8 offset:34080
    v_mfma_f32_16x16x32_bf16 v[68:71], v[148:151], v[204:207], v[68:71]
    ds_read_b64_tr_b16 v[176:177], v8 offset:33856
    v_mfma_f32_16x16x32_bf16 v[72:75], v[152:155], v[200:203], v[72:75]
    ds_read_b64_tr_b16 v[178:179], v8 offset:34112
    v_mfma_f32_16x16x32_bf16 v[76:79], v[152:155], v[204:207], v[76:79]
    ds_read_b64_tr_b16 v[180:181], v8 offset:33888
    v_mfma_f32_16x16x32_bf16 v[80:83], v[156:159], v[200:203], v[80:83]
    ds_read_b64_tr_b16 v[182:183], v8 offset:34144
    v_mfma_f32_16x16x32_bf16 v[84:87], v[156:159], v[204:207], v[84:87]
    ds_read_b64_tr_b16 v[184:185], v8 offset:33920
    v_mfma_f32_16x16x32_bf16 v[88:91], v[160:163], v[200:203], v[88:91]
    ds_read_b64_tr_b16 v[186:187], v8 offset:34176
    v_mfma_f32_16x16x32_bf16 v[92:95], v[160:163], v[204:207], v[92:95]
    ds_read_b64_tr_b16 v[188:189], v8 offset:33952
    v_mfma_f32_16x16x32_bf16 v[96:99], v[164:167], v[200:203], v[96:99]
    ds_read_b64_tr_b16 v[190:191], v8 offset:34208
    v_mfma_f32_16x16x32_bf16 v[100:103], v[164:167], v[204:207], v[100:103]
    ds_read_b64_tr_b16 v[192:193], v8 offset:33984
    s_setprio 0
    ds_read_b64_tr_b16 v[194:195], v8 offset:34240
    ds_read_b64_tr_b16 v[196:197], v8 offset:34016
    ds_read_b64_tr_b16 v[198:199], v8 offset:34272
    s_cmp_eq_u32 s47, 1
    s_cbranch_scc0 L_j17
    s_add_u32 m0, s69, 25344
    s_mov_b32 s28, 8192
    buffer_load_dwordx4 v9, s[16:19], s28 offen offset:0 nt lds
    s_add_u32 m0, s69, 25376
    s_mov_b32 s28, 8192
    buffer_load_dwordx4 v9, s[16:19], s28 offen offset:1024 nt lds
    s_add_u32 m0, s69, 59136
    s_mov_b32 s28, 139264
    buffer_load_dwordx4 v9, s[16:19], s28 offen offset:0 nt lds
    s_add_u32 m0, s69, 59168
    s_mov_b32 s28, 139264
    buffer_load_dwordx4 v9, s[16:19], s28 offen offset:1024 nt lds
L_j17:
    s_waitcnt lgkmcnt(0)
    v_mfma_f32_16x16x32_bf16 v[40:43], v[168:171], v[208:211], v[40:43]
    v_mfma_f32_16x16x32_bf16 v[44:47], v[168:171], v[212:215], v[44:47]
    v_mfma_f32_16x16x32_bf16 v[48:51], v[172:175], v[208:211], v[48:51]
    s_barrier
    s_setprio 2
    v_mfma_f32_16x16x32_bf16 v[52:55], v[172:175], v[212:215], v[52:55]
    ds_read_b128 v[216:219], v6 offset:16384
    v_mfma_f32_16x16x32_bf16 v[56:59], v[176:179], v[208:211], v[56:59]
    ds_read_b128 v[220:223], v6 offset:18432
    v_mfma_f32_16x16x32_bf16 v[60:63], v[176:179], v[212:215], v[60:63]
    ds_read_b128 v[224:227], v7 offset:16384
    v_mfma_f32_16x16x32_bf16 v[64:67], v[180:183], v[208:211], v[64:67]
    ds_read_b128 v[228:231], v7 offset:18432
    v_mfma_f32_16x16x32_bf16 v[68:71], v[180:183], v[212:215], v[68:71]
    ds_read_b64_tr_b16 v[136:137], v8 offset:0
    v_mfma_f32_16x16x32_bf16 v[72:75], v[184:187], v[208:211], v[72:75]
    ds_read_b64_tr_b16 v[138:139], v8 offset:256
    v_mfma_f32_16x16x32_bf16 v[76:79], v[184:187], v[212:215], v[76:79]
    ds_read_b64_tr_b16 v[140:141], v8 offset:32
    v_mfma_f32_16x16x32_bf16 v[80:83], v[188:191], v[208:211], v[80:83]
    ds_read_b64_tr_b16 v[142:143], v8 offset:288
    v_mfma_f32_16x16x32_bf16 v[84:87], v[188:191], v[212:215], v[84:87]
    ds_read_b64_tr_b16 v[144:145], v8 offset:64
    v_mfma_f32_16x16x32_bf16 v[88:91], v[192:195], v[208:211], v[88:91]
    ds_read_b64_tr_b16 v[146:147], v8 offset:320
    v_mfma_f32_16x16x32_bf16 v[92:95], v[192:195], v[212:215], v[92:95]
    ds_read_b64_tr_b16 v[148:149], v8 offset:96
    v_mfma_f32_16x16x32_bf16 v[96:99], v[196:199], v[208:211], v[96:99]
    ds_read_b64_tr_b16 v[150:151], v8 offset:352
    v_mfma_f32_16x16x32_bf16 v[100:103], v[196:199], v[212:215], v[100:103]
    ds_read_b64_tr_b16 v[152:153], v8 offset:128
    s_setprio 0
    ds_read_b64_tr_b16 v[154:155], v8 offset:384
    ds_read_b64_tr_b16 v[156:157], v8 offset:160
    ds_read_b64_tr_b16 v[158:159], v8 offset:416
    ds_read_b64_tr_b16 v[160:161], v8 offset:192
    ds_read_b64_tr_b16 v[162:163], v8 offset:448
    ds_read_b64_tr_b16 v[164:165], v8 offset:224
    ds_read_b64_tr_b16 v[166:167], v8 offset:480
    buffer_load_dwordx3 v[248:250], off, s[52:55], 0 sc1
    s_cmp_eq_u32 s47, 0
    s_cbranch_scc0 L_j18
    s_add_u32 s101, s101, 0x200000
    s_mov_b32 exec_hi, 0
    buffer_load_dword v233, v234, s[8:11], s101 offen
    s_mov_b32 exec_hi, -1
L_j18:
    s_waitcnt lgkmcnt(0)
    v_mfma_f32_16x16x32_bf16 v[40:43], v[136:139], v[216:219], v[40:43]
    v_mfma_f32_16x16x32_bf16 v[44:47], v[136:139], v[220:223], v[44:47]
    v_mfma_f32_16x16x32_bf16 v[48:51], v[140:143], v[216:219], v[48:51]
    s_barrier
    s_setprio 2
    v_mfma_f32_16x16x32_bf16 v[52:55], v[140:143], v[220:223], v[52:55]
    ds_read_b64_tr_b16 v[168:169], v8 offset:16896
    v_mfma_f32_16x16x32_bf16 v[56:59], v[144:147], v[216:219], v[56:59]
    ds_read_b64_tr_b16 v[170:171], v8 offset:17152
    v_mfma_f32_16x16x32_bf16 v[60:63], v[144:147], v[220:223], v[60:63]
    ds_read_b64_tr_b16 v[172:173], v8 offset:16928
    v_mfma_f32_16x16x32_bf16 v[64:67], v[148:151], v[216:219], v[64:67]
    ds_read_b64_tr_b16 v[174:175], v8 offset:17184
    v_mfma_f32_16x16x32_bf16 v[68:71], v[148:151], v[220:223], v[68:71]
    ds_read_b64_tr_b16 v[176:177], v8 offset:16960
    v_mfma_f32_16x16x32_bf16 v[72:75], v[152:155], v[216:219], v[72:75]
    ds_read_b64_tr_b16 v[178:179], v8 offset:17216
    v_mfma_f32_16x16x32_bf16 v[76:79], v[152:155], v[220:223], v[76:79]
    ds_read_b64_tr_b16 v[180:181], v8 offset:16992
    v_mfma_f32_16x16x32_bf16 v[80:83], v[156:159], v[216:219], v[80:83]
    ds_read_b64_tr_b16 v[182:183], v8 offset:17248
    v_mfma_f32_16x16x32_bf16 v[84:87], v[156:159], v[220:223], v[84:87]
    ds_read_b64_tr_b16 v[184:185], v8 offset:17024
    v_mfma_f32_16x16x32_bf16 v[88:91], v[160:163], v[216:219], v[88:91]
    ds_read_b64_tr_b16 v[186:187], v8 offset:17280
    v_mfma_f32_16x16x32_bf16 v[92:95], v[160:163], v[220:223], v[92:95]
    ds_read_b64_tr_b16 v[188:189], v8 offset:17056
    v_mfma_f32_16x16x32_bf16 v[96:99], v[164:167], v[216:219], v[96:99]
    ds_read_b64_tr_b16 v[190:191], v8 offset:17312
    v_mfma_f32_16x16x32_bf16 v[100:103], v[164:167], v[220:223], v[100:103]
    ds_read_b64_tr_b16 v[192:193], v8 offset:17088
    s_setprio 0
    ds_read_b64_tr_b16 v[194:195], v8 offset:17344
    ds_read_b64_tr_b16 v[196:197], v8 offset:17120
    ds_read_b64_tr_b16 v[198:199], v8 offset:17376
    s_cmp_eq_u32 s47, 1
    s_cbranch_scc0 L_j19
    s_add_u32 s101, s101, 0x200000
    s_mov_b32 exec_hi, 0
    buffer_load_dword v233, v234, s[8:11], s101 offen
    s_mov_b32 exec_hi, -1
L_j19:
    s_waitcnt lgkmcnt(0)
    v_mfma_f32_16x16x32_bf16 v[40:43], v[168:171], v[224:227], v[40:43]
    v_mfma_f32_16x16x32_bf16 v[44:47], v[168:171], v[228:231], v[44:47]
    v_mfma_f32_16x16x32_bf16 v[48:51], v[172:175], v[224:227], v[48:51]
    s_barrier
    s_setprio 2
    v_mfma_f32_16x16x32_bf16 v[52:55], v[172:175], v[228:231], v[52:55]
    ds_read_b128 v[200:203], v6 offset:0
    v_mfma_f32_16x16x32_bf16 v[56:59], v[176:179], v[224:227], v[56:59]
    ds_read_b128 v[204:207], v6 offset:2048
    v_mfma_f32_16x16x32_bf16 v[60:63], v[176:179], v[228:231], v[60:63]
    ds_read_b128 v[208:211], v7 offset:0
    v_mfma_f32_16x16x32_bf16 v[64:67], v[180:183], v[224:227], v[64:67]
    ds_read_b128 v[212:215], v7 offset:2048
    v_mfma_f32_16x16x32_bf16 v[68:71], v[180:183], v[228:231], v[68:71]
    ds_read_b64_tr_b16 v[136:137], v8 offset:33792
    v_mfma_f32_16x16x32_bf16 v[72:75], v[184:187], v[224:227], v[72:75]
    ds_read_b64_tr_b16 v[138:139], v8 offset:34048
    v_mfma_f32_16x16x32_bf16 v[76:79], v[184:187], v[228:231], v[76:79]
    ds_read_b64_tr_b16 v[140:141], v8 offset:33824
    v_mfma_f32_16x16x32_bf16 v[80:83], v[188:191], v[224:227], v[80:83]
    ds_read_b64_tr_b16 v[142:143], v8 offset:34080
    v_mfma_f32_16x16x32_bf16 v[84:87], v[188:191], v[228:231], v[84:87]
    ds_read_b64_tr_b16 v[144:145], v8 offset:33856
    v_mfma_f32_16x16x32_bf16 v[88:91], v[192:195], v[224:227], v[88:91]
    ds_read_b64_tr_b16 v[146:147], v8 offset:34112
    v_mfma_f32_16x16x32_bf16 v[92:95], v[192:195], v[228:231], v[92:95]
    ds_read_b64_tr_b16 v[148:149], v8 offset:33888
    v_mfma_f32_16x16x32_bf16 v[96:99], v[196:199], v[224:227], v[96:99]
    ds_read_b64_tr_b16 v[150:151], v8 offset:34144
    v_mfma_f32_16x16x32_bf16 v[100:103], v[196:199], v[228:231], v[100:103]
    ds_read_b64_tr_b16 v[152:153], v8 offset:33920
    s_setprio 0
    ds_read_b64_tr_b16 v[154:155], v8 offset:34176
    ds_read_b64_tr_b16 v[156:157], v8 offset:33952
    ds_read_b64_tr_b16 v[158:159], v8 offset:34208
    ds_read_b64_tr_b16 v[160:161], v8 offset:33984
    ds_read_b64_tr_b16 v[162:163], v8 offset:34240
    ds_read_b64_tr_b16 v[164:165], v8 offset:34016
    ds_read_b64_tr_b16 v[166:167], v8 offset:34272
    s_cmp_eq_u32 s47, 0
    s_cbranch_scc0 L_j20
    s_add_u32 s29, s29, 512
    s_cmp_ge_u32 s67, 6
    s_cselect_b32 s29, 0x200000, s29
    s_mov_b32 exec_hi, 0
    buffer_load_dword v233, v232, s[60:63], s29 offen
    s_mov_b32 exec_hi, -1
L_j20:
    s_waitcnt lgkmcnt(0)
    v_mfma_f32_16x16x32_bf16 v[40:43], v[136:139], v[200:203], v[40:43]
    v_mfma_f32_16x16x32_bf16 v[44:47], v[136:139], v[204:207], v[44:47]
    v_mfma_f32_16x16x32_bf16 v[48:51], v[140:143], v[200:203], v[48:51]
    s_barrier
    s_setprio 2
    v_mfma_f32_16x16x32_bf16 v[52:55], v[140:143], v[204:207], v[52:55]
    ds_read_b64_tr_b16 v[168:169], v8 offset:0
    v_mfma_f32_16x16x32_bf16 v[56:59], v[144:147], v[200:203], v[56:59]
    ds_read_b64_tr_b16 v[170:171], v8 offset:256
    v_mfma_f32_16x16x32_bf16 v[60:63], v[144:147], v[204:207], v[60:63]
    ds_read_b64_tr_b16 v[172:173], v8 offset:32
    v_mfma_f32_16x16x32_bf16 v[64:67], v[148:151], v[200:203], v[64:67]
    ds_read_b64_tr_b16 v[174:175], v8 offset:288
    v_mfma_f32_16x16x32_bf16 v[68:71], v[148:151], v[204:207], v[68:71]
    ds_read_b64_tr_b16 v[176:177], v8 offset:64
    v_mfma_f32_16x16x32_bf16 v[72:75], v[152:155], v[200:203], v[72:75]
    ds_read_b64_tr_b16 v[178:179], v8 offset:320
    v_mfma_f32_16x16x32_bf16 v[76:79], v[152:155], v[204:207], v[76:79]
    ds_read_b64_tr_b16 v[180:181], v8 offset:96
    v_mfma_f32_16x16x32_bf16 v[80:83], v[156:159], v[200:203], v[80:83]
    ds_read_b64_tr_b16 v[182:183], v8 offset:352
    v_mfma_f32_16x16x32_bf16 v[84:87], v[156:159], v[204:207], v[84:87]
    ds_read_b64_tr_b16 v[184:185], v8 offset:128
    v_mfma_f32_16x16x32_bf16 v[88:91], v[160:163], v[200:203], v[88:91]
    ds_read_b64_tr_b16 v[186:187], v8 offset:384
    v_mfma_f32_16x16x32_bf16 v[92:95], v[160:163], v[204:207], v[92:95]
    ds_read_b64_tr_b16 v[188:189], v8 offset:160
    v_mfma_f32_16x16x32_bf16 v[96:99], v[164:167], v[200:203], v[96:99]
    ds_read_b64_tr_b16 v[190:191], v8 offset:416
    v_mfma_f32_16x16x32_bf16 v[100:103], v[164:167], v[204:207], v[100:103]
    ds_read_b64_tr_b16 v[192:193], v8 offset:192
    s_setprio 0
    ds_read_b64_tr_b16 v[194:195], v8 offset:448
    ds_read_b64_tr_b16 v[196:197], v8 offset:224
    ds_read_b64_tr_b16 v[198:199], v8 offset:480
    s_cmp_eq_u32 s47, 1
    s_cbranch_scc0 L_j21
    s_add_u32 s29, s29, 512
    s_cmp_ge_u32 s67, 6
    s_cselect_b32 s29, 0x200000, s29
    s_mov_b32 exec_hi, 0
    buffer_load_dword v233, v232, s[60:63], s29 offen
    s_mov_b32 exec_hi, -1
L_j21:
    s_waitcnt lgkmcnt(0)
    v_mfma_f32_16x16x32_bf16 v[40:43], v[168:171], v[208:211], v[40:43]
    v_mfma_f32_16x16x32_bf16 v[44:47], v[168:171], v[212:215], v[44:47]
    v_mfma_f32_16x16x32_bf16 v[48:51], v[172:175], v[208:211], v[48:51]
    s_barrier
    s_setprio 2
    v_mfma_f32_16x16x32_bf16 v[52:55], v[172:175], v[212:215], v[52:55]
    ds_read_b128 v[216:219], v6 offset:16384
    v_mfma_f32_16x16x32_bf16 v[56:59], v[176:179], v[208:211], v[56:59]
    ds_read_b128 v[220:223], v6 offset:18432
    v_mfma_f32_16x16x32_bf16 v[60:63], v[176:179], v[212:215], v[60:63]
    ds_read_b128 v[224:227], v7 offset:16384
    v_mfma_f32_16x16x32_bf16 v[64:67], v[180:183], v[208:211], v[64:67]
    ds_read_b128 v[228:231], v7 offset:18432
    v_mfma_f32_16x16x32_bf16 v[68:71], v[180:183], v[212:215], v[68:71]
    ds_read_b64_tr_b16 v[136:137], v8 offset:16896
    v_mfma_f32_16x16x32_bf16 v[72:75], v[184:187], v[208:211], v[72:75]
    ds_read_b64_tr_b16 v[138:139], v8 offset:17152
    v_mfma_f32_16x16x32_bf16 v[76:79], v[184:187], v[212:215], v[76:79]
    ds_read_b64_tr_b16 v[140:141], v8 offset:16928
    v_mfma_f32_16x16x32_bf16 v[80:83], v[188:191], v[208:211], v[80:83]
    ds_read_b64_tr_b16 v[142:143], v8 offset:17184
    v_mfma_f32_16x16x32_bf16 v[84:87], v[188:191], v[212:215], v[84:87]
    ds_read_b64_tr_b16 v[144:145], v8 offset:16960
    v_mfma_f32_16x16x32_bf16 v[88:91], v[192:195], v[208:211], v[88:91]
    ds_read_b64_tr_b16 v[146:147], v8 offset:17216
    v_mfma_f32_16x16x32_bf16 v[92:95], v[192:195], v[212:215], v[92:95]
    ds_read_b64_tr_b16 v[148:149], v8 offset:16992
    v_mfma_f32_16x16x32_bf16 v[96:99], v[196:199], v[208:211], v[96:99]
    ds_read_b64_tr_b16 v[150:151], v8 offset:17248
    v_mfma_f32_16x16x32_bf16 v[100:103], v[196:199], v[212:215], v[100:103]
    ds_read_b64_tr_b16 v[152:153], v8 offset:17024
    s_setprio 0
    ds_read_b64_tr_b16 v[154:155], v8 offset:17280
    ds_read_b64_tr_b16 v[156:157], v8 offset:17056
    ds_read_b64_tr_b16 v[158:159], v8 offset:17312
    ds_read_b64_tr_b16 v[160:161], v8 offset:17088
    ds_read_b64_tr_b16 v[162:163], v8 offset:17344
    ds_read_b64_tr_b16 v[164:165], v8 offset:17120
    ds_read_b64_tr_b16 v[166:167], v8 offset:17376
    s_cmp_eq_u32 s47, 0
    s_cbranch_scc0 L_j22
    s_lshl_b32 s27, s67, 18
    s_add_u32 s28, s27, s36
    s_mov_b32 exec_hi, 0
    buffer_load_dword v233, v232, s[48:51], s28 offen
    s_mov_b32 exec_hi, -1
L_j22:
    s_waitcnt lgkmcnt(0)
    v_mfma_f32_16x16x32_bf16 v[40:43], v[136:139], v[216:219], v[40:43]
    v_mfma_f32_16x16x32_bf16 v[44:47], v[136:139], v[220:223], v[44:47]
    v_mfma_f32_16x16x32_bf16 v[48:51], v[140:143], v[216:219], v[48:51]
    s_barrier
    s_setprio 2
    v_mfma_f32_16x16x32_bf16 v[52:55], v[140:143], v[220:223], v[52:55]
    ds_read_b64_tr_b16 v[168:169], v8 offset:33792
    v_mfma_f32_16x16x32_bf16 v[56:59], v[144:147], v[216:219], v[56:59]
    ds_read_b64_tr_b16 v[170:171], v8 offset:34048
    v_mfma_f32_16x16x32_bf16 v[60:63], v[144:147], v[220:223], v[60:63]
    ds_read_b64_tr_b16 v[172:173], v8 offset:33824
    v_mfma_f32_16x16x32_bf16 v[64:67], v[148:151], v[216:219], v[64:67]
    ds_read_b64_tr_b16 v[174:175], v8 offset:34080
    v_mfma_f32_16x16x32_bf16 v[68:71], v[148:151], v[220:223], v[68:71]
    ds_read_b64_tr_b16 v[176:177], v8 offset:33856
    v_mfma_f32_16x16x32_bf16 v[72:75], v[152:155], v[216:219], v[72:75]
    ds_read_b64_tr_b16 v[178:179], v8 offset:34112
    v_mfma_f32_16x16x32_bf16 v[76:79], v[152:155], v[220:223], v[76:79]
    ds_read_b64_tr_b16 v[180:181], v8 offset:33888
    v_mfma_f32_16x16x32_bf16 v[80:83], v[156:159], v[216:219], v[80:83]
    ds_read_b64_tr_b16 v[182:183], v8 offset:34144
    v_mfma_f32_16x16x32_bf16 v[84:87], v[156:159], v[220:223], v[84:87]
    ds_read_b64_tr_b16 v[184:185], v8 offset:33920
    v_mfma_f32_16x16x32_bf16 v[88:91], v[160:163], v[216:219], v[88:91]
    ds_read_b64_tr_b16 v[186:187], v8 offset:34176
    v_mfma_f32_16x16x32_bf16 v[92:95], v[160:163], v[220:223], v[92:95]
    ds_read_b64_tr_b16 v[188:189], v8 offset:33952
    v_mfma_f32_16x16x32_bf16 v[96:99], v[164:167], v[216:219], v[96:99]
    ds_read_b64_tr_b16 v[190:191], v8 offset:34208
    v_mfma_f32_16x16x32_bf16 v[100:103], v[164:167], v[220:223], v[100:103]
    ds_read_b64_tr_b16 v[192:193], v8 offset:33984
    s_setprio 0
    ds_read_b64_tr_b16 v[194:195], v8 offset:34240
    ds_read_b64_tr_b16 v[196:197], v8 offset:34016
    ds_read_b64_tr_b16 v[198:199], v8 offset:34272
    s_cmp_eq_u32 s47, 1
    s_cbranch_scc0 L_j23
    s_lshl_b32 s27, s67, 18
    s_add_u32 s28, s27, s36
    s_mov_b32 exec_hi, 0
    buffer_load_dword v233, v232, s[48:51], s28 offen
    s_mov_b32 exec_hi, -1
L_j23:
    s_waitcnt lgkmcnt(0)
    v_mfma_f32_16x16x32_bf16 v[40:43], v[168:171], v[224:227], v[40:43]
    v_mfma_f32_16x16x32_bf16 v[44:47], v[168:171], v[228:231], v[44:47]
    v_mfma_f32_16x16x32_bf16 v[48:51], v[172:175], v[224:227], v[48:51]
    s_barrier
    s_setprio 2
    v_mfma_f32_16x16x32_bf16 v[52:55], v[172:175], v[228:231], v[52:55]
    ds_read_b128 v[200:203], v6 offset:0
    v_mfma_f32_16x16x32_bf16 v[56:59], v[176:179], v[224:227], v[56:59]
    ds_read_b128 v[204:207], v6 offset:2048
    v_mfma_f32_16x16x32_bf16 v[60:63], v[176:179], v[228:231], v[60:63]
    ds_read_b128 v[208:211], v7 offset:0
    v_mfma_f32_16x16x32_bf16 v[64:67], v[180:183], v[224:227], v[64:67]
    ds_read_b128 v[212:215], v7 offset:2048
    v_mfma_f32_16x16x32_bf16 v[68:71], v[180:183], v[228:231], v[68:71]
    ds_read_b64_tr_b16 v[136:137], v8 offset:0
    v_mfma_f32_16x16x32_bf16 v[72:75], v[184:187], v[224:227], v[72:75]
    ds_read_b64_tr_b16 v[138:139], v8 offset:256
    v_mfma_f32_16x16x32_bf16 v[76:79], v[184:187], v[228:231], v[76:79]
    ds_read_b64_tr_b16 v[140:141], v8 offset:32
    v_mfma_f32_16x16x32_bf16 v[80:83], v[188:191], v[224:227], v[80:83]
    ds_read_b64_tr_b16 v[142:143], v8 offset:288
    v_mfma_f32_16x16x32_bf16 v[84:87], v[188:191], v[228:231], v[84:87]
    ds_read_b64_tr_b16 v[144:145], v8 offset:64
    v_mfma_f32_16x16x32_bf16 v[88:91], v[192:195], v[224:227], v[88:91]
    ds_read_b64_tr_b16 v[146:147], v8 offset:320
    v_mfma_f32_16x16x32_bf16 v[92:95], v[192:195], v[228:231], v[92:95]
    ds_read_b64_tr_b16 v[148:149], v8 offset:96
    v_mfma_f32_16x16x32_bf16 v[96:99], v[196:199], v[224:227], v[96:99]
    ds_read_b64_tr_b16 v[150:151], v8 offset:352
    v_mfma_f32_16x16x32_bf16 v[100:103], v[196:199], v[228:231], v[100:103]
    ds_read_b64_tr_b16 v[152:153], v8 offset:128
    s_setprio 0
    ds_read_b64_tr_b16 v[154:155], v8 offset:384
    ds_read_b64_tr_b16 v[156:157], v8 offset:160
    ds_read_b64_tr_b16 v[158:159], v8 offset:416
    ds_read_b64_tr_b16 v[160:161], v8 offset:192
    ds_read_b64_tr_b16 v[162:163], v8 offset:448
    ds_read_b64_tr_b16 v[164:165], v8 offset:224
    ds_read_b64_tr_b16 v[166:167], v8 offset:480
    s_cmp_eq_u32 s47, 0
    s_cbranch_scc0 L_j24
    s_add_u32 s28, s40, 0
    s_mov_b32 exec_hi, 0
    buffer_load_dword v233, v235, s[20:23], s28 offen
    s_mov_b32 exec_hi, -1
L_j24:
    s_waitcnt lgkmcnt(0)
    v_mfma_f32_16x16x32_bf16 v[40:43], v[136:139], v[200:203], v[40:43]
    v_mfma_f32_16x16x32_bf16 v[44:47], v[136:139], v[204:207], v[44:47]
    v_mfma_f32_16x16x32_bf16 v[48:51], v[140:143], v[200:203], v[48:51]
    s_barrier
    s_setprio 2
    v_mfma_f32_16x16x32_bf16 v[52:55], v[140:143], v[204:207], v[52:55]
    ds_read_b64_tr_b16 v[168:169], v8 offset:16896
    v_mfma_f32_16x16x32_bf16 v[56:59], v[144:147], v[200:203], v[56:59]
    ds_read_b64_tr_b16 v[170:171], v8 offset:17152
    v_mfma_f32_16x16x32_bf16 v[60:63], v[144:147], v[204:207], v[60:63]
    ds_read_b64_tr_b16 v[172:173], v8 offset:16928
    v_mfma_f32_16x16x32_bf16 v[64:67], v[148:151], v[200:203], v[64:67]
    ds_read_b64_tr_b16 v[174:175], v8 offset:17184
    v_mfma_f32_16x16x32_bf16 v[68:71], v[148:151], v[204:207], v[68:71]
    ds_read_b64_tr_b16 v[176:177], v8 offset:16960
    v_mfma_f32_16x16x32_bf16 v[72:75], v[152:155], v[200:203], v[72:75]
    ds_read_b64_tr_b16 v[178:179], v8 offset:17216
    v_mfma_f32_16x16x32_bf16 v[76:79], v[152:155], v[204:207], v[76:79]
    ds_read_b64_tr_b16 v[180:181], v8 offset:16992
    v_mfma_f32_16x16x32_bf16 v[80:83], v[156:159], v[200:203], v[80:83]
    ds_read_b64_tr_b16 v[182:183], v8 offset:17248
    v_mfma_f32_16x16x32_bf16 v[84:87], v[156:159], v[204:207], v[84:87]
    ds_read_b64_tr_b16 v[184:185], v8 offset:17024
    v_mfma_f32_16x16x32_bf16 v[88:91], v[160:163], v[200:203], v[88:91]
    ds_read_b64_tr_b16 v[186:187], v8 offset:17280
    v_mfma_f32_16x16x32_bf16 v[92:95], v[160:163], v[204:207], v[92:95]
    ds_read_b64_tr_b16 v[188:189], v8 offset:17056
    v_mfma_f32_16x16x32_bf16 v[96:99], v[164:167], v[200:203], v[96:99]
    ds_read_b64_tr_b16 v[190:191], v8 offset:17312
    v_mfma_f32_16x16x32_bf16 v[100:103], v[164:167], v[204:207], v[100:103]
    ds_read_b64_tr_b16 v[192:193], v8 offset:17088
    s_setprio 0
    ds_read_b64_tr_b16 v[194:195], v8 offset:17344
    ds_read_b64_tr_b16 v[196:197], v8 offset:17120
    ds_read_b64_tr_b16 v[198:199], v8 offset:17376
    s_cmp_eq_u32 s47, 1
    s_cbranch_scc0 L_j25
    s_add_u32 s28, s40, 0
    s_mov_b32 exec_hi, 0
    buffer_load_dword v233, v235, s[20:23], s28 offen
    s_mov_b32 exec_hi, -1
L_j25:
    s_waitcnt lgkmcnt(0)
    v_mfma_f32_16x16x32_bf16 v[40:43], v[168:171], v[208:211], v[40:43]
    v_mfma_f32_16x16x32_bf16 v[44:47], v[168:171], v[212:215], v[44:47]
    v_mfma_f32_16x16x32_bf16 v[48:51], v[172:175], v[208:211], v[48:51]
    s_barrier
    s_setprio 2
    v_mfma_f32_16x16x32_bf16 v[52:55], v[172:175], v[212:215], v[52:55]
    ds_read_b128 v[216:219], v6 offset:16384
    v_mfma_f32_16x16x32_bf16 v[56:59], v[176:179], v[208:211], v[56:59]
    ds_read_b128 v[220:223], v6 offset:18432
    v_mfma_f32_16x16x32_bf16 v[60:63], v[176:179], v[212:215], v[60:63]
    ds_read_b128 v[224:227], v7 offset:16384
    v_mfma_f32_16x16x32_bf16 v[64:67], v[180:183], v[208:211], v[64:67]
    ds_read_b128 v[228:231], v7 offset:18432
    v_mfma_f32_16x16x32_bf16 v[68:71], v[180:183], v[212:215], v[68:71]
    ds_read_b64_tr_b16 v[136:137], v8 offset:33792
    v_mfma_f32_16x16x32_bf16 v[72:75], v[184:187], v[208:211], v[72:75]
    ds_read_b64_tr_b16 v[138:139], v8 offset:34048
    v_mfma_f32_16x16x32_bf16 v[76:79], v[184:187], v[212:215], v[76:79]
    ds_read_b64_tr_b16 v[140:141], v8 offset:33824
    v_mfma_f32_16x16x32_bf16 v[80:83], v[188:191], v[208:211], v[80:83]
    ds_read_b64_tr_b16 v[142:143], v8 offset:34080
    v_mfma_f32_16x16x32_bf16 v[84:87], v[188:191], v[212:215], v[84:87]
    ds_read_b64_tr_b16 v[144:145], v8 offset:33856
    v_mfma_f32_16x16x32_bf16 v[88:91], v[192:195], v[208:211], v[88:91]
    ds_read_b64_tr_b16 v[146:147], v8 offset:34112
    v_mfma_f32_16x16x32_bf16 v[92:95], v[192:195], v[212:215], v[92:95]
    ds_read_b64_tr_b16 v[148:149], v8 offset:33888
    v_mfma_f32_16x16x32_bf16 v[96:99], v[196:199], v[208:211], v[96:99]
    ds_read_b64_tr_b16 v[150:151], v8 offset:34144
    v_mfma_f32_16x16x32_bf16 v[100:103], v[196:199], v[212:215], v[100:103]
    ds_read_b64_tr_b16 v[152:153], v8 offset:33920
    s_setprio 0
    ds_read_b64_tr_b16 v[154:155], v8 offset:34176
    ds_read_b64_tr_b16 v[156:157], v8 offset:33952
    ds_read_b64_tr_b16 v[158:159], v8 offset:34208
    ds_read_b64_tr_b16 v[160:161], v8 offset:33984
    ds_read_b64_tr_b16 v[162:163], v8 offset:34240
    ds_read_b64_tr_b16 v[164:165], v8 offset:34016
    ds_read_b64_tr_b16 v[166:167], v8 offset:34272
    s_cmp_eq_u32 s47, 0
    s_cbranch_scc0 L_j26
    s_add_u32 s28, s40, 16384
    s_mov_b32 exec_hi, 0
    buffer_load_dword v233, v235, s[20:23], s28 offen
    s_mov_b32 exec_hi, -1
L_j26:
    s_waitcnt lgkmcnt(0)
    v_mfma_f32_16x16x32_bf16 v[40:43], v[136:139], v[216:219], v[40:43]
    v_mfma_f32_16x16x32_bf16 v[44:47], v[136:139], v[220:223], v[44:47]
    v_mfma_f32_16x16x32_bf16 v[48:51], v[140:143], v[216:219], v[48:51]
    s_barrier
    s_setprio 2
    v_mfma_f32_16x16x32_bf16 v[52:55], v[140:143], v[220:223], v[52:55]
    ds_read_b64_tr_b16 v[168:169], v8 offset:0
    v_mfma_f32_16x16x32_bf16 v[56:59], v[144:147], v[216:219], v[56:59]
    ds_read_b64_tr_b16 v[170:171], v8 offset:256
    v_mfma_f32_16x16x32_bf16 v[60:63], v[144:147], v[220:223], v[60:63]
    ds_read_b64_tr_b16 v[172:173], v8 offset:32
    v_mfma_f32_16x16x32_bf16 v[64:67], v[148:151], v[216:219], v[64:67]
    ds_read_b64_tr_b16 v[174:175], v8 offset:288
    v_mfma_f32_16x16x32_bf16 v[68:71], v[148:151], v[220:223], v[68:71]
    ds_read_b64_tr_b16 v[176:177], v8 offset:64
    v_mfma_f32_16x16x32_bf16 v[72:75], v[152:155], v[216:219], v[72:75]
    ds_read_b64_tr_b16 v[178:179], v8 offset:320
    v_mfma_f32_16x16x32_bf16 v[76:79], v[152:155], v[220:223], v[76:79]
    ds_read_b64_tr_b16 v[180:181], v8 offset:96
    v_mfma_f32_16x16x32_bf16 v[80:83], v[156:159], v[216:219], v[80:83]
    ds_read_b64_tr_b16 v[182:183], v8 offset:352
    v_mfma_f32_16x16x32_bf16 v[84:87], v[156:159], v[220:223], v[84:87]
    ds_read_b64_tr_b16 v[184:185], v8 offset:128
    v_mfma_f32_16x16x32_bf16 v[88:91], v[160:163], v[216:219], v[88:91]
    ds_read_b64_tr_b16 v[186:187], v8 offset:384
    v_mfma_f32_16x16x32_bf16 v[92:95], v[160:163], v[220:223], v[92:95]
    ds_read_b64_tr_b16 v[188:189], v8 offset:160
    v_mfma_f32_16x16x32_bf16 v[96:99], v[164:167], v[216:219], v[96:99]
    ds_read_b64_tr_b16 v[190:191], v8 offset:416
    v_mfma_f32_16x16x32_bf16 v[100:103], v[164:167], v[220:223], v[100:103]
    ds_read_b64_tr_b16 v[192:193], v8 offset:192
    s_setprio 0
    ds_read_b64_tr_b16 v[194:195], v8 offset:448
    ds_read_b64_tr_b16 v[196:197], v8 offset:224
    ds_read_b64_tr_b16 v[198:199], v8 offset:480
    s_cmp_eq_u32 s47, 1
    s_cbranch_scc0 L_j27
    s_add_u32 s28, s40, 16384
    s_mov_b32 exec_hi, 0
    buffer_load_dword v233, v235, s[20:23], s28 offen
    s_mov_b32 exec_hi, -1
L_j27:
    s_waitcnt lgkmcnt(0)
    v_mfma_f32_16x16x32_bf16 v[40:43], v[168:171], v[224:227], v[40:43]
    v_mfma_f32_16x16x32_bf16 v[44:47], v[168:171], v[228:231], v[44:47]
    v_mfma_f32_16x16x32_bf16 v[48:51], v[172:175], v[224:227], v[48:51]
    s_barrier
    s_setprio 2
    v_mfma_f32_16x16x32_bf16 v[52:55], v[172:175], v[228:231], v[52:55]
    ds_read_b128 v[200:203], v6 offset:0
    v_mfma_f32_16x16x32_bf16 v[56:59], v[176:179], v[224:227], v[56:59]
    ds_read_b128 v[204:207], v6 offset:2048
    v_mfma_f32_16x16x32_bf16 v[60:63], v[176:179], v[228:231], v[60:63]
    ds_read_b128 v[208:211], v7 offset:0
    v_mfma_f32_16x16x32_bf16 v[64:67], v[180:183], v[224:227], v[64:67]
    ds_read_b128 v[212:215], v7 offset:2048
    v_mfma_f32_16x16x32_bf16 v[68:71], v[180:183], v[228:231], v[68:71]
    ds_read_b64_tr_b16 v[136:137], v8 offset:16896
    v_mfma_f32_16x16x32_bf16 v[72:75], v[184:187], v[224:227], v[72:75]
    ds_read_b64_tr_b16 v[138:139], v8 offset:17152
    v_mfma_f32_16x16x32_bf16 v[76:79], v[184:187], v[228:231], v[76:79]
    ds_read_b64_tr_b16 v[140:141], v8 offset:16928
    v_mfma_f32_16x16x32_bf16 v[80:83], v[188:191], v[224:227], v[80:83]
    ds_read_b64_tr_b16 v[142:143], v8 offset:17184
    v_mfma_f32_16x16x32_bf16 v[84:87], v[188:191], v[228:231], v[84:87]
    ds_read_b64_tr_b16 v[144:145], v8 offset:16960
    v_mfma_f32_16x16x32_bf16 v[88:91], v[192:195], v[224:227], v[88:91]
    ds_read_b64_tr_b16 v[146:147], v8 offset:17216
    v_mfma_f32_16x16x32_bf16 v[92:95], v[192:195], v[228:231], v[92:95]
    ds_read_b64_tr_b16 v[148:149], v8 offset:16992
    v_mfma_f32_16x16x32_bf16 v[96:99], v[196:199], v[224:227], v[96:99]
    ds_read_b64_tr_b16 v[150:151], v8 offset:17248
    v_mfma_f32_16x16x32_bf16 v[100:103], v[196:199], v[228:231], v[100:103]
    ds_read_b64_tr_b16 v[152:153], v8 offset:17024
    s_setprio 0
    ds_read_b64_tr_b16 v[154:155], v8 offset:17280
    ds_read_b64_tr_b16 v[156:157], v8 offset:17056
    ds_read_b64_tr_b16 v[158:159], v8 offset:17312
    ds_read_b64_tr_b16 v[160:161], v8 offset:17088
    ds_read_b64_tr_b16 v[162:163], v8 offset:17344
    ds_read_b64_tr_b16 v[164:165], v8 offset:17120
    ds_read_b64_tr_b16 v[166:167], v8 offset:17376
    s_getpc_b64 s[0:1]
    v_lshl_add_u32 v245, s24, 6, v0
    v_mul_u32_u24 v245, 40, v245
    global_load_dword v245, v245, s[0:1]
    s_cmp_eq_u32 s47, 0
    s_cbranch_scc0 L_j28
    s_add_u32 s28, s40, 32768
    s_mov_b32 exec_hi, 0
    buffer_load_dword v233, v235, s[20:23], s28 offen
    s_mov_b32 exec_hi, -1
L_j28:
    s_waitcnt lgkmcnt(0)
    v_mfma_f32_16x16x32_bf16 v[40:43], v[136:139], v[200:203], v[40:43]
    v_mfma_f32_16x16x32_bf16 v[44:47], v[136:139], v[204:207], v[44:47]
    v_mfma_f32_16x16x32_bf16 v[48:51], v[140:143], v[200:203], v[48:51]
    s_barrier
    s_setprio 2
    v_mfma_f32_16x16x32_bf16 v[52:55], v[140:143], v[204:207], v[52:55]
    ds_read_b64_tr_b16 v[168:169], v8 offset:33792
    v_mfma_f32_16x16x32_bf16 v[56:59], v[144:147], v[200:203], v[56:59]
    ds_read_b64_tr_b16 v[170:171], v8 offset:34048
    v_mfma_f32_16x16x32_bf16 v[60:63], v[144:147], v[204:207], v[60:63]
    ds_read_b64_tr_b16 v[172:173], v8 offset:33824
    v_mfma_f32_16x16x32_bf16 v[64:67], v[148:151], v[200:203], v[64:67]
    ds_read_b64_tr_b16 v[174:175], v8 offset:34080
    v_mfma_f32_16x16x32_bf16 v[68:71], v[148:151], v[204:207], v[68:71]
    ds_read_b64_tr_b16 v[176:177], v8 offset:33856
    v_mfma_f32_16x16x32_bf16 v[72:75], v[152:155], v[200:203], v[72:75]
    ds_read_b64_tr_b16 v[178:179], v8 offset:34112
    v_mfma_f32_16x16x32_bf16 v[76:79], v[152:155], v[204:207], v[76:79]
    ds_read_b64_tr_b16 v[180:181], v8 offset:33888
    v_mfma_f32_16x16x32_bf16 v[80:83], v[156:159], v[200:203], v[80:83]
    ds_read_b64_tr_b16 v[182:183], v8 offset:34144
    v_mfma_f32_16x16x32_bf16 v[84:87], v[156:159], v[204:207], v[84:87]
    ds_read_b64_tr_b16 v[184:185], v8 offset:33920
    v_mfma_f32_16x16x32_bf16 v[88:91], v[160:163], v[200:203], v[88:91]
    ds_read_b64_tr_b16 v[186:187], v8 offset:34176
    v_mfma_f32_16x16x32_bf16 v[92:95], v[160:163], v[204:207], v[92:95]
    ds_read_b64_tr_b16 v[188:189], v8 offset:33952
    v_mfma_f32_16x16x32_bf16 v[96:99], v[164:167], v[200:203], v[96:99]
    ds_read_b64_tr_b16 v[190:191], v8 offset:34208
    v_mfma_f32_16x16x32_bf16 v[100:103], v[164:167], v[204:207], v[100:103]
    ds_read_b64_tr_b16 v[192:193], v8 offset:33984
    s_setprio 0
    ds_read_b64_tr_b16 v[194:195], v8 offset:34240
    ds_read_b64_tr_b16 v[196:197], v8 offset:34016
    ds_read_b64_tr_b16 v[198:199], v8 offset:34272
    s_cmp_eq_u32 s47, 1
    s_cbranch_scc0 L_j29
    s_add_u32 s28, s40, 32768
    s_mov_b32 exec_hi, 0
    buffer_load_dword v233, v235, s[20:23], s28 offen
    s_mov_b32 exec_hi, -1
L_j29:
    s_waitcnt lgkmcnt(0)
    v_mfma_f32_16x16x32_bf16 v[40:43], v[168:171], v[208:211], v[40:43]
    v_mfma_f32_16x16x32_bf16 v[44:47], v[168:171], v[212:215], v[44:47]
    v_mfma_f32_16x16x32_bf16 v[48:51], v[172:175], v[208:211], v[48:51]
    s_barrier
    s_setprio 2
    v_mfma_f32_16x16x32_bf16 v[52:55], v[172:175], v[212:215], v[52:55]
    ds_read_b128 v[216:219], v6 offset:16384
    v_mfma_f32_16x16x32_bf16 v[56:59], v[176:179], v[208:211], v[56:59]
    ds_read_b128 v[220:223], v6 offset:18432
    v_mfma_f32_16x16x32_bf16 v[60:63], v[176:179], v[212:215], v[60:63]
    ds_read_b128 v[224:227], v7 offset:16384
    v_mfma_f32_16x16x32_bf16 v[64:67], v[180:183], v[208:211], v[64:67]
    ds_read_b128 v[228:231], v7 offset:18432
    v_mfma_f32_16x16x32_bf16 v[68:71], v[180:183], v[212:215], v[68:71]
    ds_read_b64_tr_b16 v[136:137], v8 offset:0
    v_mfma_f32_16x16x32_bf16 v[72:75], v[184:187], v[208:211], v[72:75]
    ds_read_b64_tr_b16 v[138:139], v8 offset:256
    v_mfma_f32_16x16x32_bf16 v[76:79], v[184:187], v[212:215], v[76:79]
    ds_read_b64_tr_b16 v[140:141], v8 offset:32
    v_mfma_f32_16x16x32_bf16 v[80:83], v[188:191], v[208:211], v[80:83]
    ds_read_b64_tr_b16 v[142:143], v8 offset:288
    v_mfma_f32_16x16x32_bf16 v[84:87], v[188:191], v[212:215], v[84:87]
    ds_read_b64_tr_b16 v[144:145], v8 offset:64
    v_mfma_f32_16x16x32_bf16 v[88:91], v[192:195], v[208:211], v[88:91]
    ds_read_b64_tr_b16 v[146:147], v8 offset:320
    v_mfma_f32_16x16x32_bf16 v[92:95], v[192:195], v[212:215], v[92:95]
    ds_read_b64_tr_b16 v[148:149], v8 offset:96
    v_mfma_f32_16x16x32_bf16 v[96:99], v[196:199], v[208:211], v[96:99]
    ds_read_b64_tr_b16 v[150:151], v8 offset:352
    v_mfma_f32_16x16x32_bf16 v[100:103], v[196:199], v[212:215], v[100:103]
    ds_read_b64_tr_b16 v[152:153], v8 offset:128
    s_setprio 0
    ds_read_b64_tr_b16 v[154:155], v8 offset:384
    ds_read_b64_tr_b16 v[156:157], v8 offset:160
    ds_read_b64_tr_b16 v[158:159], v8 offset:416
    ds_read_b64_tr_b16 v[160:161], v8 offset:192
    ds_read_b64_tr_b16 v[162:163], v8 offset:448
    ds_read_b64_tr_b16 v[164:165], v8 offset:224
    ds_read_b64_tr_b16 v[166:167], v8 offset:480
    s_cmp_eq_u32 s47, 0
    s_cbranch_scc0 L_j30
    s_add_u32 s28, s40, 49152
    s_mov_b32 exec_hi, 0
    buffer_load_dword v233, v235, s[20:23], s28 offen
    s_mov_b32 exec_hi, -1
L_j30:
    s_waitcnt lgkmcnt(0)
    v_mfma_f32_16x16x32_bf16 v[40:43], v[136:139], v[216:219], v[40:43]
    v_mfma_f32_16x16x32_bf16 v[44:47], v[136:139], v[220:223], v[44:47]
    v_mfma_f32_16x16x32_bf16 v[48:51], v[140:143], v[216:219], v[48:51]
    s_barrier
    s_setprio 2
    v_mfma_f32_16x16x32_bf16 v[52:55], v[140:143], v[220:223], v[52:55]
    ds_read_b64_tr_b16 v[168:169], v8 offset:16896
    v_mfma_f32_16x16x32_bf16 v[56:59], v[144:147], v[216:219], v[56:59]
    ds_read_b64_tr_b16 v[170:171], v8 offset:17152
    v_mfma_f32_16x16x32_bf16 v[60:63], v[144:147], v[220:223], v[60:63]
    ds_read_b64_tr_b16 v[172:173], v8 offset:16928
    v_mfma_f32_16x16x32_bf16 v[64:67], v[148:151], v[216:219], v[64:67]
    ds_read_b64_tr_b16 v[174:175], v8 offset:17184
    v_mfma_f32_16x16x32_bf16 v[68:71], v[148:151], v[220:223], v[68:71]
    ds_read_b64_tr_b16 v[176:177], v8 offset:16960
    v_mfma_f32_16x16x32_bf16 v[72:75], v[152:155], v[216:219], v[72:75]
    ds_read_b64_tr_b16 v[178:179], v8 offset:17216
    v_mfma_f32_16x16x32_bf16 v[76:79], v[152:155], v[220:223], v[76:79]
    ds_read_b64_tr_b16 v[180:181], v8 offset:16992
    v_mfma_f32_16x16x32_bf16 v[80:83], v[156:159], v[216:219], v[80:83]
    ds_read_b64_tr_b16 v[182:183], v8 offset:17248
    v_mfma_f32_16x16x32_bf16 v[84:87], v[156:159], v[220:223], v[84:87]
    ds_read_b64_tr_b16 v[184:185], v8 offset:17024
    v_mfma_f32_16x16x32_bf16 v[88:91], v[160:163], v[216:219], v[88:91]
    ds_read_b64_tr_b16 v[186:187], v8 offset:17280
    v_mfma_f32_16x16x32_bf16 v[92:95], v[160:163], v[220:223], v[92:95]
    ds_read_b64_tr_b16 v[188:189], v8 offset:17056
    v_mfma_f32_16x16x32_bf16 v[96:99], v[164:167], v[216:219], v[96:99]
    ds_read_b64_tr_b16 v[190:191], v8 offset:17312
    v_mfma_f32_16x16x32_bf16 v[100:103], v[164:167], v[220:223], v[100:103]
    ds_read_b64_tr_b16 v[192:193], v8 offset:17088
    s_setprio 0
    ds_read_b64_tr_b16 v[194:195], v8 offset:17344
    ds_read_b64_tr_b16 v[196:197], v8 offset:17120
    ds_read_b64_tr_b16 v[198:199], v8 offset:17376
    s_cmp_eq_u32 s47, 1
    s_cbranch_scc0 L_j31
    s_add_u32 s28, s40, 49152
    s_mov_b32 exec_hi, 0
    buffer_load_dword v233, v235, s[20:23], s28 offen
    s_mov_b32 exec_hi, -1
L_j31:
    s_waitcnt vmcnt(8) lgkmcnt(0)
    s_barrier
L_qj:
    v_mfma_f32_16x16x32_bf16 v[40:43], v[168:171], v[224:227], v[40:43]
    s_add_u32 m0, s69, 67584
    s_nop 0
    buffer_load_dwordx4 v9, s[12:15], s58 offen offset:0 nt lds
    v_mfma_f32_16x16x32_bf16 v[44:47], v[168:171], v[228:231], v[44:47]
    s_add_u32 m0, s69, 67616
    s_nop 0
    buffer_load_dwordx4 v9, s[12:15], s58 offen offset:1024 nt lds
    s_add_u32 s58, s58, 8192
    v_mfma_f32_16x16x32_bf16 v[48:51], v[172:175], v[224:227], v[48:51]
    s_add_u32 m0, s69, 76032
    s_nop 0
    buffer_load_dwordx4 v9, s[16:19], s59 offen offset:0 nt lds
    v_mfma_f32_16x16x32_bf16 v[52:55], v[172:175], v[228:231], v[52:55]
    v_mov_b32 v4, v104
    v_mfma_f32_16x16x32_bf16 v[56:59], v[176:179], v[224:227], v[56:59]
    v_mov_b32 v5, v105
    v_mfma_f32_16x16x32_bf16 v[60:63], v[176:179], v[228:231], v[60:63]
    v_mov_b32 v2, v106
    v_mfma_f32_16x16x32_bf16 v[64:67], v[180:183], v[224:227], v[64:67]
    v_mov_b32 v3, v107
    v_mfma_f32_16x16x32_bf16 v[68:71], v[180:183], v[228:231], v[68:71]
    v_mov_b32 v6, v108
    v_mfma_f32_16x16x32_bf16 v[72:75], v[184:187], v[224:227], v[72:75]
    v_mov_b32 v7, v109
    v_mfma_f32_16x16x32_bf16 v[76:79], v[184:187], v[228:231], v[76:79]
    v_mov_b32 v8, v110
    v_mfma_f32_16x16x32_bf16 v[80:83], v[188:191], v[224:227], v[80:83]
    v_mfma_f32_16x16x32_bf16 v[84:87], v[188:191], v[228:231], v[84:87]
    v_mfma_f32_16x16x32_bf16 v[88:91], v[192:195], v[224:227], v[88:91]
    v_mfma_f32_16x16x32_bf16 v[92:95], v[192:195], v[228:231], v[92:95]
    v_mfma_f32_16x16x32_bf16 v[96:99], v[196:199], v[224:227], v[96:99]
    v_mfma_f32_16x16x32_bf16 v[100:103], v[196:199], v[228:231], v[100:103]
    ds_read_b128 v[184:187], v10 offset:0
    ds_read_b128 v[188:191], v10 offset:64
    ds_read_b128 v[192:195], v10 offset:128
    ds_read_b128 v[196:199], v10 offset:192
    ds_read_b128 v[200:203], v10 offset:512
    ds_read_b128 v[204:207], v10 offset:576
    ds_read_b128 v[208:211], v10 offset:640
    ds_read_b128 v[212:215], v10 offset:704
    v_cmp_eq_u32 vcc, 0, v250
    s_cbranch_vccz L_initx
    s_mov_b32 s28, 1048576
L_init:
    buffer_load_dwordx3 v[248:250], off, s[52:55], 0 sc1
    s_waitcnt vmcnt(0)
    s_sub_u32 s28, s28, 1
    s_cbranch_scc1 L_initx
    v_cmp_eq_u32 vcc, 0, v250
    s_cbranch_vccnz L_init
L_initx:
    v_readfirstlane_b32 s98, v248
    v_readfirstlane_b32 s99, v249
    s_getreg_b32 s28, hwreg(HW_REG_XCC_ID)
    s_and_b32 s28, s28, 15
    v_mov_b32 v38, v248
    v_xor_b32 v39, s28, v249
    s_cmp_lg_u32 s24, 0
    s_cbranch_scc1 L_nopub
    s_xor_b32 exec_lo, s100, 15
    s_mov_b32 exec_hi, 0
    buffer_store_dwordx2 v[38:39], v15, s[20:23], 0 offen
    s_mov_b64 exec, -1
L_nopub:
    s_mov_b32 s26, 1040356334
    s_mov_b32 s27, 1040356334
    s_mov_b32 s63, 0
    s_mov_b64 s[4:5], s[56:57]
    s_mov_b32 s6, s68
    s_mul_i32 s28, s2, 49152
    s_lshl_b32 s64, s30, 11
    s_add_u32 s64, s64, s28
    s_lshl_b32 s28, s31, 12
    s_sub_u32 s64, s64, s28
    s_add_u32 s64, s64, 16777216
    s_and_b32 s28, s2, 0xfc
    s_lshl_b32 s28, s28, 7
    s_add_u32 s8, s28, s36
    s_mul_i32 s8, s8, 3
    s_add_u32 s8, s8, 50397184
    s_add_u32 s9, s28, s37
    s_mul_i32 s9, s9, 3
    s_add_u32 s9, s9, 50397312
    s_add_u32 s10, s28, s38
    s_mul_i32 s10, s10, 3
    s_add_u32 s10, s10, 50397440
    v_mul_f32 v40, s27, v40
    v_mul_f32 v41, s27, v41
    v_mul_f32 v42, s27, v42
    v_mul_f32 v43, s27, v43
    v_mul_f32 v48, s27, v48
    v_mul_f32 v49, s27, v49
    v_mul_f32 v50, s27, v50
    v_mul_f32 v51, s27, v51
    v_cvt_pk_bf16_f32 v104, v40, v41
    v_cvt_pk_bf16_f32 v105, v42, v43
    v_cvt_pk_bf16_f32 v106, v48, v49
    v_cvt_pk_bf16_f32 v107, v50, v51
    v_mul_f32 v44, s27, v44
    v_mul_f32 v45, s27, v45
    v_mul_f32 v46, s27, v46
    v_mul_f32 v47, s27, v47
    v_mul_f32 v52, s27, v52
    v_mul_f32 v53, s27, v53
    v_mul_f32 v54, s27, v54
    v_mul_f32 v55, s27, v55
    v_cvt_pk_bf16_f32 v120, v44, v45
    v_cvt_pk_bf16_f32 v121, v46, v47
    v_cvt_pk_bf16_f32 v122, v52, v53
    v_cvt_pk_bf16_f32 v123, v54, v55
    v_mul_f32 v56, s27, v56
    v_mul_f32 v57, s27, v57
    v_mul_f32 v58, s27, v58
    v_mul_f32 v59, s27, v59
    v_mul_f32 v64, s27, v64
    v_mul_f32 v65, s27, v65
    v_mul_f32 v66, s27, v66
    v_mul_f32 v67, s27, v67
    v_cvt_pk_bf16_f32 v108, v56, v57
    v_cvt_pk_bf16_f32 v109, v58, v59
    v_cvt_pk_bf16_f32 v110, v64, v65
    v_cvt_pk_bf16_f32 v111, v66, v67
    v_mul_f32 v60, s27, v60
    v_mul_f32 v61, s27, v61
    v_mul_f32 v62, s27, v62
    v_mul_f32 v63, s27, v63
    v_mul_f32 v68, s27, v68
    v_mul_f32 v69, s27, v69
    v_mul_f32 v70, s27, v70
    v_mul_f32 v71, s27, v71
    v_cvt_pk_bf16_f32 v124, v60, v61
    v_cvt_pk_bf16_f32 v125, v62, v63
    v_cvt_pk_bf16_f32 v126, v68, v69
    v_cvt_pk_bf16_f32 v127, v70, v71
    v_mul_f32 v72, s27, v72
    v_mul_f32 v73, s27, v73
    v_mul_f32 v74, s27, v74
    v_mul_f32 v75, s27, v75
    v_mul_f32 v80, s27, v80
    v_mul_f32 v81, s27, v81
    v_mul_f32 v82, s27, v82
    v_mul_f32 v83, s27, v83
    v_cvt_pk_bf16_f32 v112, v72, v73
    v_cvt_pk_bf16_f32 v113, v74, v75
    v_cvt_pk_bf16_f32 v114, v80, v81
    v_cvt_pk_bf16_f32 v115, v82, v83
    v_mul_f32 v76, s27, v76
    v_mul_f32 v77, s27, v77
    v_mul_f32 v78, s27, v78
    v_mul_f32 v79, s27, v79
    v_mul_f32 v84, s27, v84
    v_mul_f32 v85, s27, v85
    v_mul_f32 v86, s27, v86
    v_mul_f32 v87, s27, v87
    v_cvt_pk_bf16_f32 v128, v76, v77
    v_cvt_pk_bf16_f32 v129, v78, v79
    v_cvt_pk_bf16_f32 v130, v84, v85
    v_cvt_pk_bf16_f32 v131, v86, v87
    v_mul_f32 v88, s27, v88
    v_mul_f32 v89, s27, v89
    v_mul_f32 v90, s27, v90
    v_mul_f32 v91, s27, v91
    v_mul_f32 v96, s27, v96
    v_mul_f32 v97, s27, v97
    v_mul_f32 v98, s27, v98
    v_mul_f32 v99, s27, v99
    v_cvt_pk_bf16_f32 v116, v88, v89
    v_cvt_pk_bf16_f32 v117, v90, v91
    v_cvt_pk_bf16_f32 v118, v96, v97
    v_cvt_pk_bf16_f32 v119, v98, v99
    v_mul_f32 v92, s27, v92
    v_mul_f32 v93, s27, v93
    v_mul_f32 v94, s27, v94
    v_mul_f32 v95, s27, v95
    v_mul_f32 v100, s27, v100
    v_mul_f32 v101, s27, v101
    v_mul_f32 v102, s27, v102
    v_mul_f32 v103, s27, v103
    v_cvt_pk_bf16_f32 v132, v92, v93
    v_cvt_pk_bf16_f32 v133, v94, v95
    v_cvt_pk_bf16_f32 v134, v100, v101
    v_cvt_pk_bf16_f32 v135, v102, v103
    s_add_u32 m0, s69, 76064
    s_waitcnt vmcnt(2)
    buffer_load_dwordx4 v9, s[16:19], s59 offen offset:1024 nt lds
    s_add_u32 s59, s59, 8192
    v_permlane32_swap_b32 v104, v106
    v_permlane32_swap_b32 v105, v107
    v_permlane32_swap_b32 v108, v110
    v_permlane32_swap_b32 v109, v111
    v_permlane32_swap_b32 v112, v114
    v_permlane32_swap_b32 v113, v115
    v_permlane32_swap_b32 v116, v118
    v_permlane32_swap_b32 v117, v119
    v_permlane32_swap_b32 v120, v122
    v_permlane32_swap_b32 v121, v123
    v_permlane32_swap_b32 v124, v126
    v_permlane32_swap_b32 v125, v127
    v_permlane32_swap_b32 v128, v130
    v_permlane32_swap_b32 v129, v131
    v_permlane32_swap_b32 v132, v134
    v_permlane32_swap_b32 v133, v135
    v_permlane16_swap_b32 v104, v106
    v_permlane16_swap_b32 v105, v107
    v_permlane16_swap_b32 v108, v110
    v_permlane16_swap_b32 v109, v111
    v_permlane16_swap_b32 v112, v114
    v_permlane16_swap_b32 v113, v115
    v_permlane16_swap_b32 v116, v118
    v_permlane16_swap_b32 v117, v119
    v_permlane16_swap_b32 v120, v122
    v_permlane16_swap_b32 v121, v123
    v_permlane16_swap_b32 v124, v126
    v_permlane16_swap_b32 v125, v127
    v_permlane16_swap_b32 v128, v130
    v_permlane16_swap_b32 v129, v131
    v_permlane16_swap_b32 v132, v134
    v_permlane16_swap_b32 v133, v135
    s_add_u32 m0, s69, 84480
    s_waitcnt vmcnt(2)
    buffer_load_dwordx4 v9, s[12:15], s58 offen offset:0 nt lds
L_attn:
    s_mov_b32 s60, s69
    s_add_u32 s61, s69, 67584
    s_xor_b32 s62, s60, s61
    s_waitcnt lgkmcnt(0)
    v_mfma_f32_16x16x32_bf16 v[136:139], v[184:187], v[104:107], 0
    v_mfma_f32_16x16x32_bf16 v[136:139], v[188:191], v[108:111], v[136:139]
    v_mfma_f32_16x16x32_bf16 v[136:139], v[192:195], v[112:115], v[136:139]
    v_mfma_f32_16x16x32_bf16 v[136:139], v[196:199], v[116:119], v[136:139]
    v_mfma_f32_16x16x32_bf16 v[140:143], v[184:187], v[120:123], 0
    v_mfma_f32_16x16x32_bf16 v[140:143], v[188:191], v[124:127], v[140:143]
    v_mfma_f32_16x16x32_bf16 v[140:143], v[192:195], v[128:131], v[140:143]
    v_mfma_f32_16x16x32_bf16 v[140:143], v[196:199], v[132:135], v[140:143]
    v_mfma_f32_16x16x32_bf16 v[144:147], v[200:203], v[104:107], 0
    v_mfma_f32_16x16x32_bf16 v[144:147], v[204:207], v[108:111], v[144:147]
    v_mfma_f32_16x16x32_bf16 v[144:147], v[208:211], v[112:115], v[144:147]
    v_mfma_f32_16x16x32_bf16 v[144:147], v[212:215], v[116:119], v[144:147]
    v_mfma_f32_16x16x32_bf16 v[148:151], v[200:203], v[120:123], 0
    v_mfma_f32_16x16x32_bf16 v[148:151], v[204:207], v[124:127], v[148:151]
    v_mfma_f32_16x16x32_bf16 v[148:151], v[208:211], v[128:131], v[148:151]
    v_mfma_f32_16x16x32_bf16 v[148:151], v[212:215], v[132:135], v[148:151]
    s_nop 7
    v_max3_f32 v248, v136, v137, v138
    v_max3_f32 v249, v139, v144, v145
    v_max3_f32 v250, v146, v147, v36
    v_max3_f32 v248, v248, v249, v250
    v_max3_f32 v252, v140, v141, v142
    v_max3_f32 v253, v143, v148, v149
    v_max3_f32 v254, v150, v151, v37
    v_max3_f32 v252, v252, v253, v254
    v_mov_b32 v249, v248
    v_mov_b32 v253, v252
    s_nop 1
    v_permlane32_swap_b32 v248, v249
    v_permlane32_swap_b32 v252, v253
    v_max_f32 v248, v248, v249
    v_max_f32 v252, v252, v253
    v_mov_b32 v249, v248
    v_mov_b32 v253, v252
    s_nop 1
    v_permlane16_swap_b32 v248, v249
    v_permlane16_swap_b32 v252, v253
    v_max_f32 v248, v248, v249
    v_max_f32 v252, v252, v253
    v_sub_f32 v20, 0, v248
    v_sub_f32 v21, 0, v248
    v_sub_f32 v22, 0, v248
    v_sub_f32 v23, 0, v248
    v_sub_f32 v24, 0, v252
    v_sub_f32 v25, 0, v252
    v_sub_f32 v26, 0, v252
    v_sub_f32 v27, 0, v252
    v_sub_f32 v136, v136, v248
    v_sub_f32 v137, v137, v248
    v_sub_f32 v138, v138, v248
    v_sub_f32 v139, v139, v248
    v_sub_f32 v140, v140, v252
    v_sub_f32 v141, v141, v252
    v_sub_f32 v142, v142, v252
    v_sub_f32 v143, v143, v252
    v_sub_f32 v144, v144, v248
    v_sub_f32 v145, v145, v248
    v_sub_f32 v146, v146, v248
    v_sub_f32 v147, v147, v248
    v_sub_f32 v148, v148, v252
    v_sub_f32 v149, v149, v252
    v_sub_f32 v150, v150, v252
    v_sub_f32 v151, v151, v252
    s_waitcnt lgkmcnt(0)
    s_barrier
    ds_read_b128 v[184:187], v10 offset:16896
    ds_read_b128 v[188:191], v10 offset:16960
    ds_read_b128 v[192:195], v10 offset:17024
    ds_read_b128 v[196:199], v10 offset:17088
    ds_read_b128 v[200:203], v10 offset:17408
    ds_read_b128 v[204:207], v10 offset:17472
    ds_read_b128 v[208:211], v10 offset:17536
    ds_read_b128 v[212:215], v10 offset:17600
    v_exp_f32 v136, v136
    v_exp_f32 v137, v137
    v_exp_f32 v138, v138
    v_exp_f32 v139, v139
    s_waitcnt lgkmcnt(0)
    v_mfma_f32_16x16x32_bf16 v[152:155], v[184:187], v[104:107], v[20:23]
    ds_read_b64_tr_b16 v[216:217], v12 offset:8448
    ds_read_b64_tr_b16 v[218:219], v12 offset:8960
    v_exp_f32 v140, v140
    v_mfma_f32_16x16x32_bf16 v[152:155], v[188:191], v[108:111], v[152:155]
    ds_read_b64_tr_b16 v[220:221], v12 offset:8480
    v_exp_f32 v141, v141
    v_mfma_f32_16x16x32_bf16 v[152:155], v[192:195], v[112:115], v[152:155]
    ds_read_b64_tr_b16 v[222:223], v12 offset:8992
    v_exp_f32 v142, v142
    v_mfma_f32_16x16x32_bf16 v[152:155], v[196:199], v[116:119], v[152:155]
    ds_read_b64_tr_b16 v[224:225], v12 offset:8512
    ds_read_b64_tr_b16 v[226:227], v12 offset:9024
    v_exp_f32 v143, v143
    v_mfma_f32_16x16x32_bf16 v[156:159], v[184:187], v[120:123], v[24:27]
    ds_read_b64_tr_b16 v[228:229], v12 offset:8544
    s_add_u32 m0, s61, 16928
    s_waitcnt vmcnt(2)
    buffer_load_dwordx4 v9, s[12:15], s58 offen offset:1024 nt lds
    s_add_u32 s58, s58, 8192
    v_exp_f32 v144, v144
    v_mfma_f32_16x16x32_bf16 v[156:159], v[188:191], v[124:127], v[156:159]
    ds_read_b64_tr_b16 v[230:231], v12 offset:9056
    v_exp_f32 v145, v145
    v_mfma_f32_16x16x32_bf16 v[156:159], v[192:195], v[128:131], v[156:159]
    ds_read_b64_tr_b16 v[232:233], v12 offset:8576
    ds_read_b64_tr_b16 v[234:235], v12 offset:9088
    v_exp_f32 v146, v146
    v_mfma_f32_16x16x32_bf16 v[156:159], v[196:199], v[132:135], v[156:159]
    ds_read_b64_tr_b16 v[236:237], v12 offset:8608
    v_exp_f32 v147, v147
    v_mfma_f32_16x16x32_bf16 v[160:163], v[200:203], v[104:107], v[20:23]
    ds_read_b64_tr_b16 v[238:239], v12 offset:9120
    v_exp_f32 v148, v148
    v_mfma_f32_16x16x32_bf16 v[160:163], v[204:207], v[108:111], v[160:163]
    ds_read_b64_tr_b16 v[240:241], v12 offset:8640
    ds_read_b64_tr_b16 v[242:243], v12 offset:9152
    v_exp_f32 v149, v149
    v_mfma_f32_16x16x32_bf16 v[160:163], v[208:211], v[112:115], v[160:163]
    ds_read_b64_tr_b16 v[244:245], v12 offset:8672
    v_exp_f32 v150, v150
    v_mfma_f32_16x16x32_bf16 v[160:163], v[212:215], v[116:119], v[160:163]
    ds_read_b64_tr_b16 v[246:247], v12 offset:9184
    v_exp_f32 v151, v151
    v_mfma_f32_16x16x32_bf16 v[164:167], v[200:203], v[120:123], v[24:27]
    s_add_u32 m0, s61, 25344
    s_waitcnt vmcnt(2)
    buffer_load_dwordx4 v9, s[16:19], s59 offen offset:0 nt lds
    v_cvt_pk_bf16_f32 v168, v136, v137
    v_cvt_pk_bf16_f32 v169, v138, v139
    v_mfma_f32_16x16x32_bf16 v[164:167], v[204:207], v[124:127], v[164:167]
    v_cvt_pk_bf16_f32 v172, v140, v141
    v_cvt_pk_bf16_f32 v173, v142, v143
    v_mfma_f32_16x16x32_bf16 v[164:167], v[208:211], v[128:131], v[164:167]
    v_cvt_pk_bf16_f32 v170, v144, v145
    v_cvt_pk_bf16_f32 v171, v146, v147
    v_mfma_f32_16x16x32_bf16 v[164:167], v[212:215], v[132:135], v[164:167]
    v_cvt_pk_bf16_f32 v174, v148, v149
    v_cvt_pk_bf16_f32 v175, v150, v151
    s_waitcnt vmcnt(5) lgkmcnt(0)
    s_barrier
    v_xor_b32 v10, v10, v11
    v_mfma_f32_16x16x32_bf16 v[28:31], v[16:19], v[168:171], 0
    ds_read_b128 v[184:187], v10 offset:0
    v_mfma_f32_16x16x32_bf16 v[32:35], v[16:19], v[172:175], 0
    ds_read_b128 v[188:191], v10 offset:64
    v_mfma_f32_16x16x32_bf16 v[40:43], v[216:219], v[168:171], 0
    ds_read_b128 v[192:195], v10 offset:128
    v_mfma_f32_16x16x32_bf16 v[44:47], v[216:219], v[172:175], 0
    ds_read_b128 v[196:199], v10 offset:192
    v_mfma_f32_16x16x32_bf16 v[48:51], v[220:223], v[168:171], 0
    ds_read_b128 v[200:203], v10 offset:512
    v_mfma_f32_16x16x32_bf16 v[52:55], v[220:223], v[172:175], 0
    ds_read_b128 v[204:207], v10 offset:576
    v_mfma_f32_16x16x32_bf16 v[56:59], v[224:227], v[168:171], 0
    ds_read_b128 v[208:211], v10 offset:640
    v_mfma_f32_16x16x32_bf16 v[60:63], v[224:227], v[172:175], 0
    ds_read_b128 v[212:215], v10 offset:704
    v_mfma_f32_16x16x32_bf16 v[64:67], v[228:231], v[168:171], 0
    v_exp_f32 v152, v152
    v_mfma_f32_16x16x32_bf16 v[68:71], v[228:231], v[172:175], 0
    v_exp_f32 v153, v153
    v_mfma_f32_16x16x32_bf16 v[72:75], v[232:235], v[168:171], 0
    s_add_u32 m0, s61, 25376
    s_waitcnt vmcnt(2)
    buffer_load_dwordx4 v9, s[16:19], s59 offen offset:1024 nt lds
    s_add_u32 s59, s59, 8192
    v_exp_f32 v154, v154
    v_mfma_f32_16x16x32_bf16 v[76:79], v[232:235], v[172:175], 0
    v_exp_f32 v155, v155
    v_mfma_f32_16x16x32_bf16 v[80:83], v[236:239], v[168:171], 0
    ds_read_b64_tr_b16 v[216:217], v12 offset:25344
    v_exp_f32 v156, v156
    v_mfma_f32_16x16x32_bf16 v[84:87], v[236:239], v[172:175], 0
    v_exp_f32 v157, v157
    v_mfma_f32_16x16x32_bf16 v[88:91], v[240:243], v[168:171], 0
    ds_read_b64_tr_b16 v[218:219], v12 offset:25856
    v_exp_f32 v158, v158
    v_mfma_f32_16x16x32_bf16 v[92:95], v[240:243], v[172:175], 0
    v_exp_f32 v159, v159
    v_mfma_f32_16x16x32_bf16 v[96:99], v[244:247], v[168:171], 0
    ds_read_b64_tr_b16 v[220:221], v12 offset:25376
    v_exp_f32 v160, v160
    v_mfma_f32_16x16x32_bf16 v[100:103], v[244:247], v[172:175], 0
    ds_read_b64_tr_b16 v[222:223], v12 offset:25888
    v_exp_f32 v161, v161
    s_waitcnt lgkmcnt(4)
    v_mfma_f32_16x16x32_bf16 v[136:139], v[184:187], v[104:107], v[20:23]
    ds_read_b64_tr_b16 v[224:225], v12 offset:25408
    v_exp_f32 v162, v162
    v_mfma_f32_16x16x32_bf16 v[136:139], v[188:191], v[108:111], v[136:139]
    ds_read_b64_tr_b16 v[226:227], v12 offset:25920
    v_cvt_pk_bf16_f32 v176, v152, v153
    v_mfma_f32_16x16x32_bf16 v[136:139], v[192:195], v[112:115], v[136:139]
    ds_read_b64_tr_b16 v[228:229], v12 offset:25440
    v_exp_f32 v163, v163
    v_mfma_f32_16x16x32_bf16 v[136:139], v[196:199], v[116:119], v[136:139]
    ds_read_b64_tr_b16 v[230:231], v12 offset:25952
    v_cvt_pk_bf16_f32 v177, v154, v155
    v_mfma_f32_16x16x32_bf16 v[140:143], v[184:187], v[120:123], v[24:27]
    ds_read_b64_tr_b16 v[232:233], v12 offset:25472
    v_exp_f32 v164, v164
    v_mfma_f32_16x16x32_bf16 v[140:143], v[188:191], v[124:127], v[140:143]
    ds_read_b64_tr_b16 v[234:235], v12 offset:25984
    v_cvt_pk_bf16_f32 v180, v156, v157
    v_mfma_f32_16x16x32_bf16 v[140:143], v[192:195], v[128:131], v[140:143]
    ds_read_b64_tr_b16 v[236:237], v12 offset:25504
    v_exp_f32 v165, v165
    v_mfma_f32_16x16x32_bf16 v[140:143], v[196:199], v[132:135], v[140:143]
    ds_read_b64_tr_b16 v[238:239], v12 offset:26016
    v_cvt_pk_bf16_f32 v181, v158, v159
    v_mfma_f32_16x16x32_bf16 v[144:147], v[200:203], v[104:107], v[20:23]
    ds_read_b64_tr_b16 v[240:241], v12 offset:25536
    v_exp_f32 v166, v166
    v_mfma_f32_16x16x32_bf16 v[144:147], v[204:207], v[108:111], v[144:147]
    ds_read_b64_tr_b16 v[242:243], v12 offset:26048
    v_cvt_pk_bf16_f32 v178, v160, v161
    v_mfma_f32_16x16x32_bf16 v[144:147], v[208:211], v[112:115], v[144:147]
    ds_read_b64_tr_b16 v[244:245], v12 offset:25568
    s_add_u32 m0, s60, 0
    s_waitcnt vmcnt(2)
    buffer_load_dwordx4 v9, s[12:15], s58 offen offset:0 nt lds
    v_exp_f32 v167, v167
    v_mfma_f32_16x16x32_bf16 v[144:147], v[212:215], v[116:119], v[144:147]
    ds_read_b64_tr_b16 v[246:247], v12 offset:26080
    v_cvt_pk_bf16_f32 v179, v162, v163
    v_mfma_f32_16x16x32_bf16 v[148:151], v[200:203], v[120:123], v[24:27]
    v_cvt_pk_bf16_f32 v182, v164, v165
    v_mfma_f32_16x16x32_bf16 v[148:151], v[204:207], v[124:127], v[148:151]
    v_cvt_pk_bf16_f32 v183, v166, v167
    v_mfma_f32_16x16x32_bf16 v[148:151], v[208:211], v[128:131], v[148:151]
    v_mfma_f32_16x16x32_bf16 v[148:151], v[212:215], v[132:135], v[148:151]
    v_xor_b32 v12, v12, v13
    s_xor_b32 s60, s60, s62
    s_xor_b32 s61, s61, s62
    s_mov_b32 s29, 5
.p2align 3
L_u:
    s_waitcnt vmcnt(3) lgkmcnt(0)
    s_barrier
    v_mfma_f32_16x16x32_bf16 v[28:31], v[16:19], v[176:179], v[28:31]
    ds_read_b128 v[184:187], v10 offset:16896
    v_mfma_f32_16x16x32_bf16 v[32:35], v[16:19], v[180:183], v[32:35]
    ds_read_b128 v[188:191], v10 offset:16960
    v_mfma_f32_16x16x32_bf16 v[40:43], v[216:219], v[176:179], v[40:43]
    ds_read_b128 v[192:195], v10 offset:17024
    v_mfma_f32_16x16x32_bf16 v[44:47], v[216:219], v[180:183], v[44:47]
    ds_read_b128 v[196:199], v10 offset:17088
    v_mfma_f32_16x16x32_bf16 v[48:51], v[220:223], v[176:179], v[48:51]
    ds_read_b128 v[200:203], v10 offset:17408
    v_mfma_f32_16x16x32_bf16 v[52:55], v[220:223], v[180:183], v[52:55]
    ds_read_b128 v[204:207], v10 offset:17472
    v_mfma_f32_16x16x32_bf16 v[56:59], v[224:227], v[176:179], v[56:59]
    ds_read_b128 v[208:211], v10 offset:17536
    v_mfma_f32_16x16x32_bf16 v[60:63], v[224:227], v[180:183], v[60:63]
    ds_read_b128 v[212:215], v10 offset:17600
    s_add_u32 m0, s61, 32
    s_waitcnt vmcnt(2)
    buffer_load_dwordx4 v9, s[12:15], s58 offen offset:1024 nt lds
    s_add_u32 s58, s58, 8192
    v_mfma_f32_16x16x32_bf16 v[64:67], v[228:231], v[176:179], v[64:67]
    v_exp_f32 v136, v136
    v_mfma_f32_16x16x32_bf16 v[68:71], v[228:231], v[180:183], v[68:71]
    v_exp_f32 v137, v137
    v_mfma_f32_16x16x32_bf16 v[72:75], v[232:235], v[176:179], v[72:75]
    v_exp_f32 v138, v138
    v_mfma_f32_16x16x32_bf16 v[76:79], v[232:235], v[180:183], v[76:79]
    v_exp_f32 v139, v139
    v_mfma_f32_16x16x32_bf16 v[80:83], v[236:239], v[176:179], v[80:83]
    ds_read_b64_tr_b16 v[216:217], v12 offset:8448
    v_exp_f32 v140, v140
    v_mfma_f32_16x16x32_bf16 v[84:87], v[236:239], v[180:183], v[84:87]
    v_exp_f32 v141, v141
    v_mfma_f32_16x16x32_bf16 v[88:91], v[240:243], v[176:179], v[88:91]
    ds_read_b64_tr_b16 v[218:219], v12 offset:8960
    v_exp_f32 v142, v142
    v_mfma_f32_16x16x32_bf16 v[92:95], v[240:243], v[180:183], v[92:95]
    s_add_u32 m0, s61, 8448
    s_waitcnt vmcnt(2)
    buffer_load_dwordx4 v9, s[16:19], s59 offen offset:0 nt lds
    v_exp_f32 v143, v143
    v_mfma_f32_16x16x32_bf16 v[96:99], v[244:247], v[176:179], v[96:99]
    ds_read_b64_tr_b16 v[220:221], v12 offset:8480
    v_exp_f32 v144, v144
    v_mfma_f32_16x16x32_bf16 v[100:103], v[244:247], v[180:183], v[100:103]
    ds_read_b64_tr_b16 v[222:223], v12 offset:8992
    v_exp_f32 v145, v145
    s_waitcnt lgkmcnt(4)
    v_mfma_f32_16x16x32_bf16 v[152:155], v[184:187], v[104:107], v[20:23]
    ds_read_b64_tr_b16 v[224:225], v12 offset:8512
    v_exp_f32 v146, v146
    v_mfma_f32_16x16x32_bf16 v[152:155], v[188:191], v[108:111], v[152:155]
    ds_read_b64_tr_b16 v[226:227], v12 offset:9024
    v_cvt_pk_bf16_f32 v168, v136, v137
    v_mfma_f32_16x16x32_bf16 v[152:155], v[192:195], v[112:115], v[152:155]
    ds_read_b64_tr_b16 v[228:229], v12 offset:8544
    v_exp_f32 v147, v147
    v_mfma_f32_16x16x32_bf16 v[152:155], v[196:199], v[116:119], v[152:155]
    ds_read_b64_tr_b16 v[230:231], v12 offset:9056
    v_cvt_pk_bf16_f32 v169, v138, v139
    v_mfma_f32_16x16x32_bf16 v[156:159], v[184:187], v[120:123], v[24:27]
    ds_read_b64_tr_b16 v[232:233], v12 offset:8576
    v_exp_f32 v148, v148
    v_mfma_f32_16x16x32_bf16 v[156:159], v[188:191], v[124:127], v[156:159]
    ds_read_b64_tr_b16 v[234:235], v12 offset:9088
    v_cvt_pk_bf16_f32 v172, v140, v141
    v_mfma_f32_16x16x32_bf16 v[156:159], v[192:195], v[128:131], v[156:159]
    ds_read_b64_tr_b16 v[236:237], v12 offset:8608
    s_add_u32 m0, s61, 8480
    s_waitcnt vmcnt(2)
    buffer_load_dwordx4 v9, s[16:19], s59 offen offset:1024 nt lds
    s_add_u32 s59, s59, 8192
    v_exp_f32 v149, v149
    v_mfma_f32_16x16x32_bf16 v[156:159], v[196:199], v[132:135], v[156:159]
    ds_read_b64_tr_b16 v[238:239], v12 offset:9120
    v_cvt_pk_bf16_f32 v173, v142, v143
    v_mfma_f32_16x16x32_bf16 v[160:163], v[200:203], v[104:107], v[20:23]
    ds_read_b64_tr_b16 v[240:241], v12 offset:8640
    v_exp_f32 v150, v150
    v_mfma_f32_16x16x32_bf16 v[160:163], v[204:207], v[108:111], v[160:163]
    ds_read_b64_tr_b16 v[242:243], v12 offset:9152
    v_cvt_pk_bf16_f32 v170, v144, v145
    v_mfma_f32_16x16x32_bf16 v[160:163], v[208:211], v[112:115], v[160:163]
    ds_read_b64_tr_b16 v[244:245], v12 offset:8672
    v_exp_f32 v151, v151
    v_mfma_f32_16x16x32_bf16 v[160:163], v[212:215], v[116:119], v[160:163]
    ds_read_b64_tr_b16 v[246:247], v12 offset:9184
    v_cvt_pk_bf16_f32 v171, v146, v147
    v_mfma_f32_16x16x32_bf16 v[164:167], v[200:203], v[120:123], v[24:27]
    v_cvt_pk_bf16_f32 v174, v148, v149
    v_mfma_f32_16x16x32_bf16 v[164:167], v[204:207], v[124:127], v[164:167]
    v_cvt_pk_bf16_f32 v175, v150, v151
    v_mfma_f32_16x16x32_bf16 v[164:167], v[208:211], v[128:131], v[164:167]
    s_add_u32 m0, s61, 16896
    s_waitcnt vmcnt(2)
    buffer_load_dwordx4 v9, s[12:15], s58 offen offset:0 nt lds
    v_mfma_f32_16x16x32_bf16 v[164:167], v[212:215], v[132:135], v[164:167]
    s_waitcnt vmcnt(3) lgkmcnt(0)
    s_barrier
    v_xor_b32 v10, v10, v11
    v_mfma_f32_16x16x32_bf16 v[28:31], v[16:19], v[168:171], v[28:31]
    ds_read_b128 v[184:187], v10 offset:0
    v_mfma_f32_16x16x32_bf16 v[32:35], v[16:19], v[172:175], v[32:35]
    ds_read_b128 v[188:191], v10 offset:64
    v_mfma_f32_16x16x32_bf16 v[40:43], v[216:219], v[168:171], v[40:43]
    ds_read_b128 v[192:195], v10 offset:128
    v_mfma_f32_16x16x32_bf16 v[44:47], v[216:219], v[172:175], v[44:47]
    ds_read_b128 v[196:199], v10 offset:192
    v_mfma_f32_16x16x32_bf16 v[48:51], v[220:223], v[168:171], v[48:51]
    ds_read_b128 v[200:203], v10 offset:512
    v_mfma_f32_16x16x32_bf16 v[52:55], v[220:223], v[172:175], v[52:55]
    ds_read_b128 v[204:207], v10 offset:576
    v_mfma_f32_16x16x32_bf16 v[56:59], v[224:227], v[168:171], v[56:59]
    ds_read_b128 v[208:211], v10 offset:640
    v_mfma_f32_16x16x32_bf16 v[60:63], v[224:227], v[172:175], v[60:63]
    ds_read_b128 v[212:215], v10 offset:704
    s_add_u32 m0, s61, 16928
    s_waitcnt vmcnt(2)
    buffer_load_dwordx4 v9, s[12:15], s58 offen offset:1024 nt lds
    s_add_u32 s58, s58, 8192
    v_mfma_f32_16x16x32_bf16 v[64:67], v[228:231], v[168:171], v[64:67]
    v_exp_f32 v152, v152
    v_mfma_f32_16x16x32_bf16 v[68:71], v[228:231], v[172:175], v[68:71]
    v_exp_f32 v153, v153
    v_mfma_f32_16x16x32_bf16 v[72:75], v[232:235], v[168:171], v[72:75]
    v_exp_f32 v154, v154
    v_mfma_f32_16x16x32_bf16 v[76:79], v[232:235], v[172:175], v[76:79]
    v_exp_f32 v155, v155
    v_mfma_f32_16x16x32_bf16 v[80:83], v[236:239], v[168:171], v[80:83]
    ds_read_b64_tr_b16 v[216:217], v12 offset:25344
    v_exp_f32 v156, v156
    v_mfma_f32_16x16x32_bf16 v[84:87], v[236:239], v[172:175], v[84:87]
    v_exp_f32 v157, v157
    v_mfma_f32_16x16x32_bf16 v[88:91], v[240:243], v[168:171], v[88:91]
    ds_read_b64_tr_b16 v[218:219], v12 offset:25856
    v_exp_f32 v158, v158
    v_mfma_f32_16x16x32_bf16 v[92:95], v[240:243], v[172:175], v[92:95]
    s_add_u32 m0, s61, 25344
    s_waitcnt vmcnt(2)
    buffer_load_dwordx4 v9, s[16:19], s59 offen offset:0 nt lds
    v_exp_f32 v159, v159
    v_mfma_f32_16x16x32_bf16 v[96:99], v[244:247], v[168:171], v[96:99]
    ds_read_b64_tr_b16 v[220:221], v12 offset:25376
    v_exp_f32 v160, v160
    v_mfma_f32_16x16x32_bf16 v[100:103], v[244:247], v[172:175], v[100:103]
    ds_read_b64_tr_b16 v[222:223], v12 offset:25888
    v_exp_f32 v161, v161
    s_waitcnt lgkmcnt(4)
    v_mfma_f32_16x16x32_bf16 v[136:139], v[184:187], v[104:107], v[20:23]
    ds_read_b64_tr_b16 v[224:225], v12 offset:25408
    v_exp_f32 v162, v162
    v_mfma_f32_16x16x32_bf16 v[136:139], v[188:191], v[108:111], v[136:139]
    ds_read_b64_tr_b16 v[226:227], v12 offset:25920
    v_cvt_pk_bf16_f32 v176, v152, v153
    v_mfma_f32_16x16x32_bf16 v[136:139], v[192:195], v[112:115], v[136:139]
    ds_read_b64_tr_b16 v[228:229], v12 offset:25440
    v_exp_f32 v163, v163
    v_mfma_f32_16x16x32_bf16 v[136:139], v[196:199], v[116:119], v[136:139]
    ds_read_b64_tr_b16 v[230:231], v12 offset:25952
    v_cvt_pk_bf16_f32 v177, v154, v155
    v_mfma_f32_16x16x32_bf16 v[140:143], v[184:187], v[120:123], v[24:27]
    ds_read_b64_tr_b16 v[232:233], v12 offset:25472
    v_exp_f32 v164, v164
    v_mfma_f32_16x16x32_bf16 v[140:143], v[188:191], v[124:127], v[140:143]
    ds_read_b64_tr_b16 v[234:235], v12 offset:25984
    v_cvt_pk_bf16_f32 v180, v156, v157
    v_mfma_f32_16x16x32_bf16 v[140:143], v[192:195], v[128:131], v[140:143]
    ds_read_b64_tr_b16 v[236:237], v12 offset:25504
    s_add_u32 m0, s61, 25376
    s_waitcnt vmcnt(2)
    buffer_load_dwordx4 v9, s[16:19], s59 offen offset:1024 nt lds
    s_add_u32 s59, s59, 8192
    v_exp_f32 v165, v165
    v_mfma_f32_16x16x32_bf16 v[140:143], v[196:199], v[132:135], v[140:143]
    ds_read_b64_tr_b16 v[238:239], v12 offset:26016
    v_cvt_pk_bf16_f32 v181, v158, v159
    v_mfma_f32_16x16x32_bf16 v[144:147], v[200:203], v[104:107], v[20:23]
    ds_read_b64_tr_b16 v[240:241], v12 offset:25536
    v_exp_f32 v166, v166
    v_mfma_f32_16x16x32_bf16 v[144:147], v[204:207], v[108:111], v[144:147]
    ds_read_b64_tr_b16 v[242:243], v12 offset:26048
    v_cvt_pk_bf16_f32 v178, v160, v161
    v_mfma_f32_16x16x32_bf16 v[144:147], v[208:211], v[112:115], v[144:147]
    ds_read_b64_tr_b16 v[244:245], v12 offset:25568
    v_exp_f32 v167, v167
    v_mfma_f32_16x16x32_bf16 v[144:147], v[212:215], v[116:119], v[144:147]
    ds_read_b64_tr_b16 v[246:247], v12 offset:26080
    v_cvt_pk_bf16_f32 v179, v162, v163
    v_mfma_f32_16x16x32_bf16 v[148:151], v[200:203], v[120:123], v[24:27]
    v_cvt_pk_bf16_f32 v182, v164, v165
    v_mfma_f32_16x16x32_bf16 v[148:151], v[204:207], v[124:127], v[148:151]
    v_cvt_pk_bf16_f32 v183, v166, v167
    v_mfma_f32_16x16x32_bf16 v[148:151], v[208:211], v[128:131], v[148:151]
    s_add_u32 m0, s60, 0
    s_waitcnt vmcnt(2)
    buffer_load_dwordx4 v9, s[12:15], s58 offen offset:0 nt lds
    v_mfma_f32_16x16x32_bf16 v[148:151], v[212:215], v[132:135], v[148:151]
    v_xor_b32 v12, v12, v13
    s_xor_b32 s60, s60, s62
    s_xor_b32 s61, s61, s62
    s_sub_u32 s29, s29, 1
    s_cmp_lg_u32 s29, 0
    s_cbranch_scc1 L_u
    s_waitcnt vmcnt(3) lgkmcnt(0)
    s_barrier
    v_mfma_f32_16x16x32_bf16 v[28:31], v[16:19], v[176:179], v[28:31]
    ds_read_b128 v[184:187], v10 offset:16896
    v_mfma_f32_16x16x32_bf16 v[32:35], v[16:19], v[180:183], v[32:35]
    ds_read_b128 v[188:191], v10 offset:16960
    v_mfma_f32_16x16x32_bf16 v[40:43], v[216:219], v[176:179], v[40:43]
    ds_read_b128 v[192:195], v10 offset:17024
    v_mfma_f32_16x16x32_bf16 v[44:47], v[216:219], v[180:183], v[44:47]
    ds_read_b128 v[196:199], v10 offset:17088
    v_mfma_f32_16x16x32_bf16 v[48:51], v[220:223], v[176:179], v[48:51]
    ds_read_b128 v[200:203], v10 offset:17408
    v_mfma_f32_16x16x32_bf16 v[52:55], v[220:223], v[180:183], v[52:55]
    ds_read_b128 v[204:207], v10 offset:17472
    v_mfma_f32_16x16x32_bf16 v[56:59], v[224:227], v[176:179], v[56:59]
    ds_read_b128 v[208:211], v10 offset:17536
    v_mfma_f32_16x16x32_bf16 v[60:63], v[224:227], v[180:183], v[60:63]
    ds_read_b128 v[212:215], v10 offset:17600
    s_add_u32 m0, s61, 32
    s_waitcnt vmcnt(2)
    buffer_load_dwordx4 v9, s[12:15], s58 offen offset:1024 nt lds
    s_add_u32 s58, s58, 8192
    v_mfma_f32_16x16x32_bf16 v[64:67], v[228:231], v[176:179], v[64:67]
    v_exp_f32 v136, v136
    v_mfma_f32_16x16x32_bf16 v[68:71], v[228:231], v[180:183], v[68:71]
    v_exp_f32 v137, v137
    v_mfma_f32_16x16x32_bf16 v[72:75], v[232:235], v[176:179], v[72:75]
    v_exp_f32 v138, v138
    v_mfma_f32_16x16x32_bf16 v[76:79], v[232:235], v[180:183], v[76:79]
    v_exp_f32 v139, v139
    v_mfma_f32_16x16x32_bf16 v[80:83], v[236:239], v[176:179], v[80:83]
    ds_read_b64_tr_b16 v[216:217], v12 offset:8448
    v_exp_f32 v140, v140
    v_mfma_f32_16x16x32_bf16 v[84:87], v[236:239], v[180:183], v[84:87]
    v_exp_f32 v141, v141
    v_mfma_f32_16x16x32_bf16 v[88:91], v[240:243], v[176:179], v[88:91]
    ds_read_b64_tr_b16 v[218:219], v12 offset:8960
    v_exp_f32 v142, v142
    v_mfma_f32_16x16x32_bf16 v[92:95], v[240:243], v[180:183], v[92:95]
    s_add_u32 m0, s61, 8448
    s_waitcnt vmcnt(2)
    buffer_load_dwordx4 v9, s[16:19], s59 offen offset:0 nt lds
    v_exp_f32 v143, v143
    v_mfma_f32_16x16x32_bf16 v[96:99], v[244:247], v[176:179], v[96:99]
    ds_read_b64_tr_b16 v[220:221], v12 offset:8480
    v_exp_f32 v144, v144
    v_mfma_f32_16x16x32_bf16 v[100:103], v[244:247], v[180:183], v[100:103]
    ds_read_b64_tr_b16 v[222:223], v12 offset:8992
    v_exp_f32 v145, v145
    s_waitcnt lgkmcnt(4)
    v_mfma_f32_16x16x32_bf16 v[152:155], v[184:187], v[104:107], v[20:23]
    ds_read_b64_tr_b16 v[224:225], v12 offset:8512
    v_exp_f32 v146, v146
    v_mfma_f32_16x16x32_bf16 v[152:155], v[188:191], v[108:111], v[152:155]
    ds_read_b64_tr_b16 v[226:227], v12 offset:9024
    v_cvt_pk_bf16_f32 v168, v136, v137
    v_mfma_f32_16x16x32_bf16 v[152:155], v[192:195], v[112:115], v[152:155]
    ds_read_b64_tr_b16 v[228:229], v12 offset:8544
    v_exp_f32 v147, v147
    v_mfma_f32_16x16x32_bf16 v[152:155], v[196:199], v[116:119], v[152:155]
    ds_read_b64_tr_b16 v[230:231], v12 offset:9056
    v_cvt_pk_bf16_f32 v169, v138, v139
    v_mfma_f32_16x16x32_bf16 v[156:159], v[184:187], v[120:123], v[24:27]
    ds_read_b64_tr_b16 v[232:233], v12 offset:8576
    v_exp_f32 v148, v148
    v_mfma_f32_16x16x32_bf16 v[156:159], v[188:191], v[124:127], v[156:159]
    ds_read_b64_tr_b16 v[234:235], v12 offset:9088
    v_cvt_pk_bf16_f32 v172, v140, v141
    v_mfma_f32_16x16x32_bf16 v[156:159], v[192:195], v[128:131], v[156:159]
    ds_read_b64_tr_b16 v[236:237], v12 offset:8608
    s_add_u32 m0, s61, 8480
    s_waitcnt vmcnt(2)
    buffer_load_dwordx4 v9, s[16:19], s59 offen offset:1024 nt lds
    s_add_u32 s59, s59, 8192
    v_exp_f32 v149, v149
    v_mfma_f32_16x16x32_bf16 v[156:159], v[196:199], v[132:135], v[156:159]
    ds_read_b64_tr_b16 v[238:239], v12 offset:9120
    v_cvt_pk_bf16_f32 v173, v142, v143
    v_mfma_f32_16x16x32_bf16 v[160:163], v[200:203], v[104:107], v[20:23]
    ds_read_b64_tr_b16 v[240:241], v12 offset:8640
    v_exp_f32 v150, v150
    v_mfma_f32_16x16x32_bf16 v[160:163], v[204:207], v[108:111], v[160:163]
    ds_read_b64_tr_b16 v[242:243], v12 offset:9152
    v_cvt_pk_bf16_f32 v170, v144, v145
    v_mfma_f32_16x16x32_bf16 v[160:163], v[208:211], v[112:115], v[160:163]
    ds_read_b64_tr_b16 v[244:245], v12 offset:8672
    v_exp_f32 v151, v151
    v_mfma_f32_16x16x32_bf16 v[160:163], v[212:215], v[116:119], v[160:163]
    ds_read_b64_tr_b16 v[246:247], v12 offset:9184
    v_cvt_pk_bf16_f32 v171, v146, v147
    v_mfma_f32_16x16x32_bf16 v[164:167], v[200:203], v[120:123], v[24:27]
    v_cvt_pk_bf16_f32 v174, v148, v149
    v_mfma_f32_16x16x32_bf16 v[164:167], v[204:207], v[124:127], v[164:167]
    v_cvt_pk_bf16_f32 v175, v150, v151
    v_mfma_f32_16x16x32_bf16 v[164:167], v[208:211], v[128:131], v[164:167]
    s_add_u32 m0, s61, 16896
    s_waitcnt vmcnt(2)
    buffer_load_dwordx4 v9, s[12:15], s58 offen offset:0 nt lds
    v_mfma_f32_16x16x32_bf16 v[164:167], v[212:215], v[132:135], v[164:167]
    s_waitcnt vmcnt(3) lgkmcnt(0)
    s_barrier
    v_xor_b32 v10, v10, v11
    v_mfma_f32_16x16x32_bf16 v[28:31], v[16:19], v[168:171], v[28:31]
    ds_read_b128 v[184:187], v10 offset:0
    v_mfma_f32_16x16x32_bf16 v[32:35], v[16:19], v[172:175], v[32:35]
    ds_read_b128 v[188:191], v10 offset:64
    v_mfma_f32_16x16x32_bf16 v[40:43], v[216:219], v[168:171], v[40:43]
    ds_read_b128 v[192:195], v10 offset:128
    v_mfma_f32_16x16x32_bf16 v[44:47], v[216:219], v[172:175], v[44:47]
    ds_read_b128 v[196:199], v10 offset:192
    v_mfma_f32_16x16x32_bf16 v[48:51], v[220:223], v[168:171], v[48:51]
    ds_read_b128 v[200:203], v10 offset:512
    v_mfma_f32_16x16x32_bf16 v[52:55], v[220:223], v[172:175], v[52:55]
    ds_read_b128 v[204:207], v10 offset:576
    v_mfma_f32_16x16x32_bf16 v[56:59], v[224:227], v[168:171], v[56:59]
    ds_read_b128 v[208:211], v10 offset:640
    v_mfma_f32_16x16x32_bf16 v[60:63], v[224:227], v[172:175], v[60:63]
    ds_read_b128 v[212:215], v10 offset:704
    s_add_u32 m0, s61, 16928
    s_waitcnt vmcnt(2)
    buffer_load_dwordx4 v9, s[12:15], s58 offen offset:1024 nt lds
    s_add_u32 s58, s58, 8192
    v_mfma_f32_16x16x32_bf16 v[64:67], v[228:231], v[168:171], v[64:67]
    v_exp_f32 v152, v152
    v_mfma_f32_16x16x32_bf16 v[68:71], v[228:231], v[172:175], v[68:71]
    v_exp_f32 v153, v153
    v_mfma_f32_16x16x32_bf16 v[72:75], v[232:235], v[168:171], v[72:75]
    v_exp_f32 v154, v154
    v_mfma_f32_16x16x32_bf16 v[76:79], v[232:235], v[172:175], v[76:79]
    v_exp_f32 v155, v155
    v_mfma_f32_16x16x32_bf16 v[80:83], v[236:239], v[168:171], v[80:83]
    ds_read_b64_tr_b16 v[216:217], v12 offset:25344
    v_exp_f32 v156, v156
    v_mfma_f32_16x16x32_bf16 v[84:87], v[236:239], v[172:175], v[84:87]
    v_exp_f32 v157, v157
    v_mfma_f32_16x16x32_bf16 v[88:91], v[240:243], v[168:171], v[88:91]
    ds_read_b64_tr_b16 v[218:219], v12 offset:25856
    v_exp_f32 v158, v158
    v_mfma_f32_16x16x32_bf16 v[92:95], v[240:243], v[172:175], v[92:95]
    s_add_u32 m0, s61, 25344
    s_waitcnt vmcnt(2)
    buffer_load_dwordx4 v9, s[16:19], s59 offen offset:0 nt lds
    v_exp_f32 v159, v159
    v_mfma_f32_16x16x32_bf16 v[96:99], v[244:247], v[168:171], v[96:99]
    ds_read_b64_tr_b16 v[220:221], v12 offset:25376
    v_exp_f32 v160, v160
    v_mfma_f32_16x16x32_bf16 v[100:103], v[244:247], v[172:175], v[100:103]
    ds_read_b64_tr_b16 v[222:223], v12 offset:25888
    v_exp_f32 v161, v161
    s_waitcnt lgkmcnt(4)
    v_mfma_f32_16x16x32_bf16 v[136:139], v[184:187], v[104:107], v[20:23]
    ds_read_b64_tr_b16 v[224:225], v12 offset:25408
    v_exp_f32 v162, v162
    v_mfma_f32_16x16x32_bf16 v[136:139], v[188:191], v[108:111], v[136:139]
    ds_read_b64_tr_b16 v[226:227], v12 offset:25920
    v_cvt_pk_bf16_f32 v176, v152, v153
    v_mfma_f32_16x16x32_bf16 v[136:139], v[192:195], v[112:115], v[136:139]
    ds_read_b64_tr_b16 v[228:229], v12 offset:25440
    v_exp_f32 v163, v163
    v_mfma_f32_16x16x32_bf16 v[136:139], v[196:199], v[116:119], v[136:139]
    ds_read_b64_tr_b16 v[230:231], v12 offset:25952
    v_cvt_pk_bf16_f32 v177, v154, v155
    v_mfma_f32_16x16x32_bf16 v[140:143], v[184:187], v[120:123], v[24:27]
    ds_read_b64_tr_b16 v[232:233], v12 offset:25472
    v_exp_f32 v164, v164
    v_mfma_f32_16x16x32_bf16 v[140:143], v[188:191], v[124:127], v[140:143]
    ds_read_b64_tr_b16 v[234:235], v12 offset:25984
    v_cvt_pk_bf16_f32 v180, v156, v157
    v_mfma_f32_16x16x32_bf16 v[140:143], v[192:195], v[128:131], v[140:143]
    ds_read_b64_tr_b16 v[236:237], v12 offset:25504
    s_add_u32 m0, s61, 25376
    s_waitcnt vmcnt(2)
    buffer_load_dwordx4 v9, s[16:19], s59 offen offset:1024 nt lds
    s_add_u32 s59, s59, 8192
    v_exp_f32 v165, v165
    v_mfma_f32_16x16x32_bf16 v[140:143], v[196:199], v[132:135], v[140:143]
    ds_read_b64_tr_b16 v[238:239], v12 offset:26016
    v_cvt_pk_bf16_f32 v181, v158, v159
    v_mfma_f32_16x16x32_bf16 v[144:147], v[200:203], v[104:107], v[20:23]
    ds_read_b64_tr_b16 v[240:241], v12 offset:25536
    v_exp_f32 v166, v166
    v_mfma_f32_16x16x32_bf16 v[144:147], v[204:207], v[108:111], v[144:147]
    ds_read_b64_tr_b16 v[242:243], v12 offset:26048
    v_cvt_pk_bf16_f32 v178, v160, v161
    v_mfma_f32_16x16x32_bf16 v[144:147], v[208:211], v[112:115], v[144:147]
    ds_read_b64_tr_b16 v[244:245], v12 offset:25568
    v_exp_f32 v167, v167
    v_mfma_f32_16x16x32_bf16 v[144:147], v[212:215], v[116:119], v[144:147]
    ds_read_b64_tr_b16 v[246:247], v12 offset:26080
    v_cvt_pk_bf16_f32 v179, v162, v163
    v_mfma_f32_16x16x32_bf16 v[148:151], v[200:203], v[120:123], v[24:27]
    v_cvt_pk_bf16_f32 v182, v164, v165
    v_mfma_f32_16x16x32_bf16 v[148:151], v[204:207], v[124:127], v[148:151]
    v_cvt_pk_bf16_f32 v183, v166, v167
    v_mfma_f32_16x16x32_bf16 v[148:151], v[208:211], v[128:131], v[148:151]
    s_add_u32 s27, s32, s36
    s_add_u32 m0, s69, 0
    s_nop 0
    buffer_load_dwordx4 v4, s[48:51], s27 offen lds
    s_add_u32 m0, m0, 1056
    s_nop 0
    buffer_load_dwordx4 v5, s[48:51], s27 offen lds
    s_add_u32 s27, s27, 0x20000
    s_add_u32 m0, s69, 8448
    s_nop 0
    buffer_load_dwordx4 v4, s[48:51], s27 offen lds
    s_add_u32 m0, m0, 1056
    s_nop 0
    buffer_load_dwordx4 v5, s[48:51], s27 offen lds
    v_mfma_f32_16x16x32_bf16 v[148:151], v[212:215], v[132:135], v[148:151]
    v_xor_b32 v12, v12, v13
    s_xor_b32 s60, s60, s62
    s_xor_b32 s61, s61, s62
    s_waitcnt vmcnt(6) lgkmcnt(0)
    s_barrier
    v_mfma_f32_16x16x32_bf16 v[28:31], v[16:19], v[176:179], v[28:31]
    ds_read_b128 v[184:187], v10 offset:16896
    s_add_u32 s27, s33, s36
    s_add_u32 m0, s69, 16896
    s_nop 0
    buffer_load_dwordx4 v4, s[48:51], s27 offen lds
    s_add_u32 m0, m0, 1056
    s_nop 0
    buffer_load_dwordx4 v5, s[48:51], s27 offen lds
    s_add_u32 s27, s27, 0x20000
    s_add_u32 m0, s69, 25344
    s_nop 0
    buffer_load_dwordx4 v4, s[48:51], s27 offen lds
    s_add_u32 m0, m0, 1056
    s_nop 0
    buffer_load_dwordx4 v5, s[48:51], s27 offen lds
    v_mfma_f32_16x16x32_bf16 v[32:35], v[16:19], v[180:183], v[32:35]
    ds_read_b128 v[188:191], v10 offset:16960
    v_mfma_f32_16x16x32_bf16 v[40:43], v[216:219], v[176:179], v[40:43]
    ds_read_b128 v[192:195], v10 offset:17024
    v_mfma_f32_16x16x32_bf16 v[44:47], v[216:219], v[180:183], v[44:47]
    ds_read_b128 v[196:199], v10 offset:17088
    v_mfma_f32_16x16x32_bf16 v[48:51], v[220:223], v[176:179], v[48:51]
    ds_read_b128 v[200:203], v10 offset:17408
    s_getpc_b64 s[0:1]
    v_lshl_add_u32 v250, s24, 6, v0
    v_mul_u32_u24 v250, 32, v250
    global_load_dword v250, v250, s[0:1]
    buffer_load_dwordx2 v[248:249], v15, s[20:23], 0 offen sc1
    v_mfma_f32_16x16x32_bf16 v[52:55], v[220:223], v[180:183], v[52:55]
    ds_read_b128 v[204:207], v10 offset:17472
    v_mfma_f32_16x16x32_bf16 v[56:59], v[224:227], v[176:179], v[56:59]
    ds_read_b128 v[208:211], v10 offset:17536
    v_mfma_f32_16x16x32_bf16 v[60:63], v[224:227], v[180:183], v[60:63]
    ds_read_b128 v[212:215], v10 offset:17600
    v_mfma_f32_16x16x32_bf16 v[64:67], v[228:231], v[176:179], v[64:67]
    v_exp_f32 v136, v136
    v_mfma_f32_16x16x32_bf16 v[68:71], v[228:231], v[180:183], v[68:71]
    v_exp_f32 v137, v137
    v_mfma_f32_16x16x32_bf16 v[72:75], v[232:235], v[176:179], v[72:75]
    v_exp_f32 v138, v138
    v_mfma_f32_16x16x32_bf16 v[76:79], v[232:235], v[180:183], v[76:79]
    v_exp_f32 v139, v139
    v_mfma_f32_16x16x32_bf16 v[80:83], v[236:239], v[176:179], v[80:83]
    ds_read_b64_tr_b16 v[216:217], v12 offset:8448
    v_exp_f32 v140, v140
    v_mfma_f32_16x16x32_bf16 v[84:87], v[236:239], v[180:183], v[84:87]
    v_exp_f32 v141, v141
    v_mfma_f32_16x16x32_bf16 v[88:91], v[240:243], v[176:179], v[88:91]
    ds_read_b64_tr_b16 v[218:219], v12 offset:8960
    v_exp_f32 v142, v142
    v_mfma_f32_16x16x32_bf16 v[92:95], v[240:243], v[180:183], v[92:95]
    v_exp_f32 v143, v143
    v_mfma_f32_16x16x32_bf16 v[96:99], v[244:247], v[176:179], v[96:99]
    ds_read_b64_tr_b16 v[220:221], v12 offset:8480
    v_exp_f32 v144, v144
    v_mfma_f32_16x16x32_bf16 v[100:103], v[244:247], v[180:183], v[100:103]
    ds_read_b64_tr_b16 v[222:223], v12 offset:8992
    v_exp_f32 v145, v145
    s_waitcnt lgkmcnt(4)
    v_mfma_f32_16x16x32_bf16 v[152:155], v[184:187], v[104:107], v[20:23]
    ds_read_b64_tr_b16 v[224:225], v12 offset:8512
    v_exp_f32 v146, v146
    v_mfma_f32_16x16x32_bf16 v[152:155], v[188:191], v[108:111], v[152:155]
    ds_read_b64_tr_b16 v[226:227], v12 offset:9024
    v_cvt_pk_bf16_f32 v168, v136, v137
    v_mfma_f32_16x16x32_bf16 v[152:155], v[192:195], v[112:115], v[152:155]
    ds_read_b64_tr_b16 v[228:229], v12 offset:8544
    v_exp_f32 v147, v147
    v_mfma_f32_16x16x32_bf16 v[152:155], v[196:199], v[116:119], v[152:155]
    ds_read_b64_tr_b16 v[230:231], v12 offset:9056
    v_cvt_pk_bf16_f32 v169, v138, v139
    v_mfma_f32_16x16x32_bf16 v[156:159], v[184:187], v[120:123], v[24:27]
    ds_read_b64_tr_b16 v[232:233], v12 offset:8576
    v_exp_f32 v148, v148
    v_mfma_f32_16x16x32_bf16 v[156:159], v[188:191], v[124:127], v[156:159]
    ds_read_b64_tr_b16 v[234:235], v12 offset:9088
    v_cvt_pk_bf16_f32 v172, v140, v141
    v_mfma_f32_16x16x32_bf16 v[156:159], v[192:195], v[128:131], v[156:159]
    ds_read_b64_tr_b16 v[236:237], v12 offset:8608
    v_exp_f32 v149, v149
    v_mfma_f32_16x16x32_bf16 v[156:159], v[196:199], v[132:135], v[156:159]
    ds_read_b64_tr_b16 v[238:239], v12 offset:9120
    v_cvt_pk_bf16_f32 v173, v142, v143
    v_mfma_f32_16x16x32_bf16 v[160:163], v[200:203], v[104:107], v[20:23]
    ds_read_b64_tr_b16 v[240:241], v12 offset:8640
    v_exp_f32 v150, v150
    v_mfma_f32_16x16x32_bf16 v[160:163], v[204:207], v[108:111], v[160:163]
    ds_read_b64_tr_b16 v[242:243], v12 offset:9152
    v_cvt_pk_bf16_f32 v170, v144, v145
    v_mfma_f32_16x16x32_bf16 v[160:163], v[208:211], v[112:115], v[160:163]
    ds_read_b64_tr_b16 v[244:245], v12 offset:8672
    v_exp_f32 v151, v151
    v_mfma_f32_16x16x32_bf16 v[160:163], v[212:215], v[116:119], v[160:163]
    ds_read_b64_tr_b16 v[246:247], v12 offset:9184
    v_cvt_pk_bf16_f32 v171, v146, v147
    v_mfma_f32_16x16x32_bf16 v[164:167], v[200:203], v[120:123], v[24:27]
    v_cvt_pk_bf16_f32 v174, v148, v149
    v_mfma_f32_16x16x32_bf16 v[164:167], v[204:207], v[124:127], v[164:167]
    v_cvt_pk_bf16_f32 v175, v150, v151
    v_mfma_f32_16x16x32_bf16 v[164:167], v[208:211], v[128:131], v[164:167]
    v_mfma_f32_16x16x32_bf16 v[164:167], v[212:215], v[132:135], v[164:167]
    s_waitcnt vmcnt(10) lgkmcnt(0)
    s_barrier
    v_mfma_f32_16x16x32_bf16 v[28:31], v[16:19], v[168:171], v[28:31]
    v_exp_f32 v152, v152
    s_add_u32 s27, s34, s36
    s_add_u32 m0, s69, 67584
    s_nop 0
    buffer_load_dwordx4 v4, s[48:51], s27 offen lds
    s_add_u32 m0, m0, 1056
    s_nop 0
    buffer_load_dwordx4 v5, s[48:51], s27 offen lds
    s_add_u32 s27, s27, 0x20000
    s_add_u32 m0, s69, 76032
    s_nop 0
    buffer_load_dwordx4 v4, s[48:51], s27 offen lds
    s_add_u32 m0, m0, 1056
    s_nop 0
    buffer_load_dwordx4 v5, s[48:51], s27 offen lds
    s_lshl_b32 s26, s24, 4
    v_add_u32 v1, s26, v0
    v_lshlrev_b32 v1, 11, v1
    s_lshl_b32 s26, s67, 18
    s_lshl_b32 s27, s30, 18
    s_sub_u32 s26, s26, s27
    s_add_u32 s26, s26, s37
    s_max_i32 s26, s26, 0
    s_mov_b64 exec, 0xffff
    buffer_load_dword v1, v1, s[48:51], s26 offen
    s_mov_b64 exec, -1
    v_mfma_f32_16x16x32_bf16 v[32:35], v[16:19], v[172:175], v[32:35]
    v_exp_f32 v153, v153
    v_mfma_f32_16x16x32_bf16 v[40:43], v[216:219], v[168:171], v[40:43]
    v_exp_f32 v154, v154
    v_mfma_f32_16x16x32_bf16 v[44:47], v[216:219], v[172:175], v[44:47]
    ds_read_b64_tr_b16 v[216:217], v12 offset:25344
    ds_read_b64_tr_b16 v[218:219], v12 offset:25856
    v_exp_f32 v155, v155
    v_mfma_f32_16x16x32_bf16 v[48:51], v[220:223], v[168:171], v[48:51]
    v_exp_f32 v156, v156
    v_mfma_f32_16x16x32_bf16 v[52:55], v[220:223], v[172:175], v[52:55]
    ds_read_b64_tr_b16 v[220:221], v12 offset:25376
    ds_read_b64_tr_b16 v[222:223], v12 offset:25888
    v_exp_f32 v157, v157
    v_mfma_f32_16x16x32_bf16 v[56:59], v[224:227], v[168:171], v[56:59]
    v_exp_f32 v158, v158
    v_mfma_f32_16x16x32_bf16 v[60:63], v[224:227], v[172:175], v[60:63]
    ds_read_b64_tr_b16 v[224:225], v12 offset:25408
    ds_read_b64_tr_b16 v[226:227], v12 offset:25920
    v_exp_f32 v159, v159
    v_mfma_f32_16x16x32_bf16 v[64:67], v[228:231], v[168:171], v[64:67]
    v_exp_f32 v160, v160
    v_mfma_f32_16x16x32_bf16 v[68:71], v[228:231], v[172:175], v[68:71]
    ds_read_b64_tr_b16 v[228:229], v12 offset:25440
    ds_read_b64_tr_b16 v[230:231], v12 offset:25952
    v_exp_f32 v161, v161
    v_mfma_f32_16x16x32_bf16 v[72:75], v[232:235], v[168:171], v[72:75]
    v_exp_f32 v162, v162
    v_mfma_f32_16x16x32_bf16 v[76:79], v[232:235], v[172:175], v[76:79]
    ds_read_b64_tr_b16 v[232:233], v12 offset:25472
    ds_read_b64_tr_b16 v[234:235], v12 offset:25984
    v_exp_f32 v163, v163
    v_mfma_f32_16x16x32_bf16 v[80:83], v[236:239], v[168:171], v[80:83]
    v_exp_f32 v164, v164
    v_mfma_f32_16x16x32_bf16 v[84:87], v[236:239], v[172:175], v[84:87]
    ds_read_b64_tr_b16 v[236:237], v12 offset:25504
    ds_read_b64_tr_b16 v[238:239], v12 offset:26016
    v_exp_f32 v165, v165
    v_mfma_f32_16x16x32_bf16 v[88:91], v[240:243], v[168:171], v[88:91]
    v_exp_f32 v166, v166
    v_mfma_f32_16x16x32_bf16 v[92:95], v[240:243], v[172:175], v[92:95]
    ds_read_b64_tr_b16 v[240:241], v12 offset:25536
    ds_read_b64_tr_b16 v[242:243], v12 offset:26048
    v_exp_f32 v167, v167
    v_mfma_f32_16x16x32_bf16 v[96:99], v[244:247], v[168:171], v[96:99]
    v_cvt_pk_bf16_f32 v176, v152, v153
    v_cvt_pk_bf16_f32 v177, v154, v155
    v_cvt_pk_bf16_f32 v180, v156, v157
    v_cvt_pk_bf16_f32 v181, v158, v159
    v_mfma_f32_16x16x32_bf16 v[100:103], v[244:247], v[172:175], v[100:103]
    ds_read_b64_tr_b16 v[244:245], v12 offset:25568
    ds_read_b64_tr_b16 v[246:247], v12 offset:26080
    v_cvt_pk_bf16_f32 v178, v160, v161
    v_cvt_pk_bf16_f32 v179, v162, v163
    v_cvt_pk_bf16_f32 v182, v164, v165
    v_cvt_pk_bf16_f32 v183, v166, v167
    v_xor_b32 v12, v12, v13
    s_xor_b32 s60, s60, s62
    s_xor_b32 s61, s61, s62
    s_waitcnt vmcnt(5) lgkmcnt(0)
    v_cmp_ne_u64 vcc, v[38:39], v[248:249]
    s_and_b32 s27, vcc_lo, 15
    s_cselect_b32 s47, 0, 1
    buffer_load_dwordx2 v[254:255], v8, s[20:23], 0 offen sc1
    s_add_u32 s27, s40, 4096
    s_lshl_b32 s26, s24, 8
    s_add_u32 s26, s26, 135168
    s_cmp_eq_u32 s47, 1
    s_cbranch_scc1 L_fast
    v_mfma_f32_16x16x32_bf16 v[28:31], v[16:19], v[176:179], v[28:31]
    v_mfma_f32_16x16x32_bf16 v[32:35], v[16:19], v[180:183], v[32:35]
    v_mfma_f32_16x16x32_bf16 v[40:43], v[216:219], v[176:179], v[40:43]
    v_mfma_f32_16x16x32_bf16 v[44:47], v[216:219], v[180:183], v[44:47]
    v_lshl_add_u32 v249, v0, 2, s26
    v_lshlrev_b32 v250, 2, v0
    v_mfma_f32_16x16x32_bf16 v[48:51], v[220:223], v[176:179], v[48:51]
    v_add_u32 v250, 135168, v250
    v_mfma_f32_16x16x32_bf16 v[52:55], v[220:223], v[180:183], v[52:55]
    v_mfma_f32_16x16x32_bf16 v[56:59], v[224:227], v[176:179], v[56:59]
    v_rcp_f32 v20, v28
    v_mfma_f32_16x16x32_bf16 v[60:63], v[224:227], v[180:183], v[60:63]
    v_rcp_f32 v22, v32
    v_mfma_f32_16x16x32_bf16 v[64:67], v[228:231], v[176:179], v[64:67]
    v_add_f32 v248, v28, v32
    v_mfma_f32_16x16x32_bf16 v[68:71], v[228:231], v[180:183], v[68:71]
    ds_write_b32 v249, v248
    v_mfma_f32_16x16x32_bf16 v[72:75], v[232:235], v[176:179], v[72:75]
    v_mul_f32 v40, v20, v40
    v_mul_f32 v41, v20, v41
    v_mul_f32 v42, v20, v42
    v_mul_f32 v43, v20, v43
    v_mul_f32 v48, v20, v48
    v_mfma_f32_16x16x32_bf16 v[76:79], v[232:235], v[180:183], v[76:79]
    v_mul_f32 v49, v20, v49
    v_mul_f32 v50, v20, v50
    v_mul_f32 v51, v20, v51
    v_cvt_pk_bf16_f32 v136, v40, v41
    v_cvt_pk_bf16_f32 v137, v42, v43
    v_mfma_f32_16x16x32_bf16 v[80:83], v[236:239], v[176:179], v[80:83]
    v_cvt_pk_bf16_f32 v138, v48, v49
    v_cvt_pk_bf16_f32 v139, v50, v51
    buffer_store_dwordx4 v[136:139], v14, s[20:23], s40 offen offset:0 sc1
    v_mul_f32 v44, v22, v44
    v_mul_f32 v45, v22, v45
    v_mfma_f32_16x16x32_bf16 v[84:87], v[236:239], v[180:183], v[84:87]
    v_mul_f32 v46, v22, v46
    v_mul_f32 v47, v22, v47
    v_mul_f32 v52, v22, v52
    v_mul_f32 v53, v22, v53
    v_mul_f32 v54, v22, v54
    v_mfma_f32_16x16x32_bf16 v[88:91], v[240:243], v[176:179], v[88:91]
    v_mul_f32 v55, v22, v55
    v_cvt_pk_bf16_f32 v140, v44, v45
    v_cvt_pk_bf16_f32 v141, v46, v47
    v_cvt_pk_bf16_f32 v142, v52, v53
    v_cvt_pk_bf16_f32 v143, v54, v55
    v_mfma_f32_16x16x32_bf16 v[92:95], v[240:243], v[180:183], v[92:95]
    buffer_store_dwordx4 v[140:143], v14, s[20:23], s40 offen offset:1024 sc1
    v_mul_f32 v56, v20, v56
    v_mul_f32 v57, v20, v57
    v_mul_f32 v58, v20, v58
    v_mul_f32 v59, v20, v59
    v_mfma_f32_16x16x32_bf16 v[96:99], v[244:247], v[176:179], v[96:99]
    v_mul_f32 v64, v20, v64
    v_mul_f32 v65, v20, v65
    v_mul_f32 v66, v20, v66
    v_mul_f32 v67, v20, v67
    v_cvt_pk_bf16_f32 v144, v56, v57
    v_mfma_f32_16x16x32_bf16 v[100:103], v[244:247], v[180:183], v[100:103]
    v_cvt_pk_bf16_f32 v145, v58, v59
    v_cvt_pk_bf16_f32 v146, v64, v65
    v_cvt_pk_bf16_f32 v147, v66, v67
    buffer_store_dwordx4 v[144:147], v14, s[20:23], s40 offen offset:2048 sc1
    v_mul_f32 v60, v22, v60
    v_mul_f32 v61, v22, v61
    v_mul_f32 v62, v22, v62
    v_mul_f32 v63, v22, v63
    v_mul_f32 v68, v22, v68
    v_mul_f32 v69, v22, v69
    v_mul_f32 v70, v22, v70
    v_mul_f32 v71, v22, v71
    v_cvt_pk_bf16_f32 v148, v60, v61
    v_cvt_pk_bf16_f32 v149, v62, v63
    v_cvt_pk_bf16_f32 v150, v68, v69
    v_cvt_pk_bf16_f32 v151, v70, v71
    buffer_store_dwordx4 v[148:151], v14, s[20:23], s40 offen offset:3072 sc1
    v_mul_f32 v72, v20, v72
    v_mul_f32 v73, v20, v73
    v_mul_f32 v74, v20, v74
    v_mul_f32 v75, v20, v75
    v_mul_f32 v80, v20, v80
    v_mul_f32 v81, v20, v81
    v_mul_f32 v82, v20, v82
    v_mul_f32 v83, v20, v83
    v_cvt_pk_bf16_f32 v152, v72, v73
    v_cvt_pk_bf16_f32 v153, v74, v75
    v_cvt_pk_bf16_f32 v154, v80, v81
    v_cvt_pk_bf16_f32 v155, v82, v83
    buffer_store_dwordx4 v[152:155], v14, s[20:23], s27 offen offset:0 sc1
    v_mul_f32 v76, v22, v76
    v_mul_f32 v77, v22, v77
    v_mul_f32 v78, v22, v78
    v_mul_f32 v79, v22, v79
    v_mul_f32 v84, v22, v84
    v_mul_f32 v85, v22, v85
    v_mul_f32 v86, v22, v86
    v_mul_f32 v87, v22, v87
    v_cvt_pk_bf16_f32 v156, v76, v77
    v_cvt_pk_bf16_f32 v157, v78, v79
    v_cvt_pk_bf16_f32 v158, v84, v85
    v_cvt_pk_bf16_f32 v159, v86, v87
    buffer_store_dwordx4 v[156:159], v14, s[20:23], s27 offen offset:1024 sc1
    v_mul_f32 v88, v20, v88
    v_mul_f32 v89, v20, v89
    v_mul_f32 v90, v20, v90
    v_mul_f32 v91, v20, v91
    v_mul_f32 v96, v20, v96
    v_mul_f32 v97, v20, v97
    v_mul_f32 v98, v20, v98
    v_mul_f32 v99, v20, v99
    v_cvt_pk_bf16_f32 v160, v88, v89
    v_cvt_pk_bf16_f32 v161, v90, v91
    v_cvt_pk_bf16_f32 v162, v96, v97
    v_cvt_pk_bf16_f32 v163, v98, v99
    buffer_store_dwordx4 v[160:163], v14, s[20:23], s27 offen offset:2048 sc1
    v_mul_f32 v92, v22, v92
    v_mul_f32 v93, v22, v93
    v_mul_f32 v94, v22, v94
    v_mul_f32 v95, v22, v95
    v_mul_f32 v100, v22, v100
    v_mul_f32 v101, v22, v101
    v_mul_f32 v102, v22, v102
    v_mul_f32 v103, v22, v103
    v_cvt_pk_bf16_f32 v164, v92, v93
    v_cvt_pk_bf16_f32 v165, v94, v95
    v_cvt_pk_bf16_f32 v166, v100, v101
    v_cvt_pk_bf16_f32 v167, v102, v103
    buffer_store_dwordx4 v[164:167], v14, s[20:23], s27 offen offset:3072 sc1
    s_branch L_stored
L_fast:
    v_mfma_f32_16x16x32_bf16 v[28:31], v[16:19], v[176:179], v[28:31]
    v_mfma_f32_16x16x32_bf16 v[32:35], v[16:19], v[180:183], v[32:35]
    v_mfma_f32_16x16x32_bf16 v[40:43], v[216:219], v[176:179], v[40:43]
    v_mfma_f32_16x16x32_bf16 v[44:47], v[216:219], v[180:183], v[44:47]
    v_lshl_add_u32 v249, v0, 2, s26
    v_lshlrev_b32 v250, 2, v0
    v_mfma_f32_16x16x32_bf16 v[48:51], v[220:223], v[176:179], v[48:51]
    v_add_u32 v250, 135168, v250
    v_mfma_f32_16x16x32_bf16 v[52:55], v[220:223], v[180:183], v[52:55]
    v_mfma_f32_16x16x32_bf16 v[56:59], v[224:227], v[176:179], v[56:59]
    v_rcp_f32 v20, v28
    v_mfma_f32_16x16x32_bf16 v[60:63], v[224:227], v[180:183], v[60:63]
    v_rcp_f32 v22, v32
    v_mfma_f32_16x16x32_bf16 v[64:67], v[228:231], v[176:179], v[64:67]
    v_add_f32 v248, v28, v32
    v_mfma_f32_16x16x32_bf16 v[68:71], v[228:231], v[180:183], v[68:71]
    ds_write_b32 v249, v248
    v_mfma_f32_16x16x32_bf16 v[72:75], v[232:235], v[176:179], v[72:75]
    v_mul_f32 v40, v20, v40
    v_mul_f32 v41, v20, v41
    v_mul_f32 v42, v20, v42
    v_mul_f32 v43, v20, v43
    v_mul_f32 v48, v20, v48
    v_mfma_f32_16x16x32_bf16 v[76:79], v[232:235], v[180:183], v[76:79]
    v_mul_f32 v49, v20, v49
    v_mul_f32 v50, v20, v50
    v_mul_f32 v51, v20, v51
    v_cvt_pk_bf16_f32 v136, v40, v41
    v_cvt_pk_bf16_f32 v137, v42, v43
    v_mfma_f32_16x16x32_bf16 v[80:83], v[236:239], v[176:179], v[80:83]
    v_cvt_pk_bf16_f32 v138, v48, v49
    v_cvt_pk_bf16_f32 v139, v50, v51
    buffer_store_dwordx4 v[136:139], v14, s[20:23], s40 offen offset:0
    v_mul_f32 v44, v22, v44
    v_mul_f32 v45, v22, v45
    v_mfma_f32_16x16x32_bf16 v[84:87], v[236:239], v[180:183], v[84:87]
    v_mul_f32 v46, v22, v46
    v_mul_f32 v47, v22, v47
    v_mul_f32 v52, v22, v52
    v_mul_f32 v53, v22, v53
    v_mul_f32 v54, v22, v54
    v_mfma_f32_16x16x32_bf16 v[88:91], v[240:243], v[176:179], v[88:91]
    v_mul_f32 v55, v22, v55
    v_cvt_pk_bf16_f32 v140, v44, v45
    v_cvt_pk_bf16_f32 v141, v46, v47
    v_cvt_pk_bf16_f32 v142, v52, v53
    v_cvt_pk_bf16_f32 v143, v54, v55
    v_mfma_f32_16x16x32_bf16 v[92:95], v[240:243], v[180:183], v[92:95]
    buffer_store_dwordx4 v[140:143], v14, s[20:23], s40 offen offset:1024
    v_mul_f32 v56, v20, v56
    v_mul_f32 v57, v20, v57
    v_mul_f32 v58, v20, v58
    v_mul_f32 v59, v20, v59
    v_mfma_f32_16x16x32_bf16 v[96:99], v[244:247], v[176:179], v[96:99]
    v_mul_f32 v64, v20, v64
    v_mul_f32 v65, v20, v65
    v_mul_f32 v66, v20, v66
    v_mul_f32 v67, v20, v67
    v_cvt_pk_bf16_f32 v144, v56, v57
    v_mfma_f32_16x16x32_bf16 v[100:103], v[244:247], v[180:183], v[100:103]
    v_cvt_pk_bf16_f32 v145, v58, v59
    v_cvt_pk_bf16_f32 v146, v64, v65
    v_cvt_pk_bf16_f32 v147, v66, v67
    buffer_store_dwordx4 v[144:147], v14, s[20:23], s40 offen offset:2048
    v_mul_f32 v60, v22, v60
    v_mul_f32 v61, v22, v61
    v_mul_f32 v62, v22, v62
    v_mul_f32 v63, v22, v63
    v_mul_f32 v68, v22, v68
    v_mul_f32 v69, v22, v69
    v_mul_f32 v70, v22, v70
    v_mul_f32 v71, v22, v71
    v_cvt_pk_bf16_f32 v148, v60, v61
    v_cvt_pk_bf16_f32 v149, v62, v63
    v_cvt_pk_bf16_f32 v150, v68, v69
    v_cvt_pk_bf16_f32 v151, v70, v71
    buffer_store_dwordx4 v[148:151], v14, s[20:23], s40 offen offset:3072
    v_mul_f32 v72, v20, v72
    v_mul_f32 v73, v20, v73
    v_mul_f32 v74, v20, v74
    v_mul_f32 v75, v20, v75
    v_mul_f32 v80, v20, v80
    v_mul_f32 v81, v20, v81
    v_mul_f32 v82, v20, v82
    v_mul_f32 v83, v20, v83
    v_cvt_pk_bf16_f32 v152, v72, v73
    v_cvt_pk_bf16_f32 v153, v74, v75
    v_cvt_pk_bf16_f32 v154, v80, v81
    v_cvt_pk_bf16_f32 v155, v82, v83
    buffer_store_dwordx4 v[152:155], v14, s[20:23], s27 offen offset:0
    v_mul_f32 v76, v22, v76
    v_mul_f32 v77, v22, v77
    v_mul_f32 v78, v22, v78
    v_mul_f32 v79, v22, v79
    v_mul_f32 v84, v22, v84
    v_mul_f32 v85, v22, v85
    v_mul_f32 v86, v22, v86
    v_mul_f32 v87, v22, v87
    v_cvt_pk_bf16_f32 v156, v76, v77
    v_cvt_pk_bf16_f32 v157, v78, v79
    v_cvt_pk_bf16_f32 v158, v84, v85
    v_cvt_pk_bf16_f32 v159, v86, v87
    buffer_store_dwordx4 v[156:159], v14, s[20:23], s27 offen offset:1024
    v_mul_f32 v88, v20, v88
    v_mul_f32 v89, v20, v89
    v_mul_f32 v90, v20, v90
    v_mul_f32 v91, v20, v91
    v_mul_f32 v96, v20, v96
    v_mul_f32 v97, v20, v97
    v_mul_f32 v98, v20, v98
    v_mul_f32 v99, v20, v99
    v_cvt_pk_bf16_f32 v160, v88, v89
    v_cvt_pk_bf16_f32 v161, v90, v91
    v_cvt_pk_bf16_f32 v162, v96, v97
    v_cvt_pk_bf16_f32 v163, v98, v99
    buffer_store_dwordx4 v[160:163], v14, s[20:23], s27 offen offset:2048
    v_mul_f32 v92, v22, v92
    v_mul_f32 v93, v22, v93
    v_mul_f32 v94, v22, v94
    v_mul_f32 v95, v22, v95
    v_mul_f32 v100, v22, v100
    v_mul_f32 v101, v22, v101
    v_mul_f32 v102, v22, v102
    v_mul_f32 v103, v22, v103
    v_cvt_pk_bf16_f32 v164, v92, v93
    v_cvt_pk_bf16_f32 v165, v94, v95
    v_cvt_pk_bf16_f32 v166, v100, v101
    v_cvt_pk_bf16_f32 v167, v102, v103
    buffer_store_dwordx4 v[164:167], v14, s[20:23], s27 offen offset:3072
L_stored:
    s_waitcnt vmcnt(8) lgkmcnt(0)
    s_barrier
    ds_read_b32 v184, v250 offset:0
    ds_read_b32 v185, v250 offset:256
    ds_read_b32 v186, v250 offset:512
    ds_read_b32 v187, v250 offset:768
    ds_read_b32 v188, v250 offset:1024
    ds_read_b32 v189, v250 offset:1280
    ds_read_b32 v190, v250 offset:1536
    ds_read_b32 v191, v250 offset:1792
    ds_read_b64_tr_b16 v[40:41], v2 offset:0
    ds_read_b64_tr_b16 v[42:43], v2 offset:256
    ds_read_b64_tr_b16 v[44:45], v2 offset:32
    ds_read_b64_tr_b16 v[46:47], v2 offset:288
    ds_read_b64_tr_b16 v[48:49], v3 offset:0
    ds_read_b64_tr_b16 v[50:51], v3 offset:256
    ds_read_b64_tr_b16 v[52:53], v3 offset:32
    ds_read_b64_tr_b16 v[54:55], v3 offset:288
    ds_read_b64_tr_b16 v[56:57], v2 offset:512
    ds_read_b64_tr_b16 v[58:59], v2 offset:768
    ds_read_b64_tr_b16 v[60:61], v2 offset:544
    ds_read_b64_tr_b16 v[62:63], v2 offset:800
    ds_read_b64_tr_b16 v[64:65], v3 offset:512
    ds_read_b64_tr_b16 v[66:67], v3 offset:768
    ds_read_b64_tr_b16 v[68:69], v3 offset:544
    ds_read_b64_tr_b16 v[70:71], v3 offset:800
    v_cmp_ne_u64 vcc, s[98:99], v[254:255]
    s_and_b32 s101, vcc_lo, s100
    v_mov_b32 v248, s98
    v_mov_b32 v249, s99
    s_waitcnt lgkmcnt(15)
    v_add_f32 v184, v184, v185
    v_add_f32 v184, v184, v186
    v_add_f32 v184, v184, v187
    v_add_f32 v184, v184, v188
    v_add_f32 v184, v184, v189
    v_add_f32 v184, v184, v190
    v_add_f32 v184, v184, v191
    v_cmp_nge_f32 vcc, 1266679808, v184
    s_cmp_eq_u32 s63, 0
    s_cselect_b64 s[26:27], -1, 0
    s_and_b64 s[26:27], s[26:27], vcc
    s_cbranch_scc1 L_redo
    s_waitcnt vmcnt(0)
    s_cmp_eq_u32 s47, 1
    s_cbranch_scc1 L_flf
    s_xor_b32 exec_lo, s100, 15
    s_mov_b32 exec_hi, 0
    buffer_store_dwordx2 v[248:249], v8, s[20:23], 0 offen sc1
    s_mov_b64 exec, -1
    s_branch L_flx
L_flf:
    s_xor_b32 exec_lo, s100, 15
    s_mov_b32 exec_hi, 0
    buffer_store_dwordx2 v[248:249], v8, s[20:23], 0 offen
    s_mov_b64 exec, -1
L_flx:
    s_cmp_lg_u32 s101, 0
    s_cbranch_scc1 L_late1
    buffer_load_dwordx4 v[168:171], v14, s[20:23], s41 offen offset:0 sc1
    buffer_load_dwordx4 v[172:175], v14, s[20:23], s41 offen offset:1024 sc1
    buffer_load_dwordx4 v[176:179], v14, s[20:23], s41 offen offset:2048 sc1
    buffer_load_dwordx4 v[180:183], v14, s[20:23], s41 offen offset:3072 sc1
    s_add_u32 s28, s41, 4096
    buffer_load_dwordx4 v[184:187], v14, s[20:23], s28 offen offset:0 sc1
    buffer_load_dwordx4 v[188:191], v14, s[20:23], s28 offen offset:1024 sc1
    buffer_load_dwordx4 v[192:195], v14, s[20:23], s28 offen offset:2048 sc1
    buffer_load_dwordx4 v[196:199], v14, s[20:23], s28 offen offset:3072 sc1
L_late1:
    s_waitcnt lgkmcnt(8)
    v_mfma_f32_16x16x32_bf16 v[16:19], v[40:43], v[136:139], 0
    ds_read_b64_tr_b16 v[72:73], v2 offset:8448
    v_mfma_f32_16x16x32_bf16 v[20:23], v[40:43], v[140:143], 0
    ds_read_b64_tr_b16 v[74:75], v2 offset:8704
    v_mfma_f32_16x16x32_bf16 v[24:27], v[44:47], v[136:139], 0
    ds_read_b64_tr_b16 v[76:77], v2 offset:8480
    v_mfma_f32_16x16x32_bf16 v[28:31], v[44:47], v[140:143], 0
    ds_read_b64_tr_b16 v[78:79], v2 offset:8736
    v_mfma_f32_16x16x32_bf16 v[32:35], v[48:51], v[136:139], 0
    ds_read_b64_tr_b16 v[40:41], v3 offset:8448
    s_add_u32 s27, s35, s36
    s_add_u32 m0, s69, 84480
    v_mfma_f32_16x16x32_bf16 v[36:39], v[48:51], v[140:143], 0
    ds_read_b64_tr_b16 v[42:43], v3 offset:8704
    v_mfma_f32_16x16x32_bf16 v[232:235], v[52:55], v[136:139], 0
    ds_read_b64_tr_b16 v[44:45], v3 offset:8480
    buffer_load_dwordx4 v4, s[48:51], s27 offen lds
    s_add_u32 m0, m0, 1056
    v_mfma_f32_16x16x32_bf16 v[236:239], v[52:55], v[140:143], 0
    ds_read_b64_tr_b16 v[46:47], v3 offset:8736
    s_waitcnt lgkmcnt(8)
    v_mfma_f32_16x16x32_bf16 v[16:19], v[56:59], v[144:147], v[16:19]
    ds_read_b64_tr_b16 v[48:49], v2 offset:8960
    buffer_load_dwordx4 v5, s[48:51], s27 offen lds
    v_mfma_f32_16x16x32_bf16 v[20:23], v[56:59], v[148:151], v[20:23]
    ds_read_b64_tr_b16 v[50:51], v2 offset:9216
    v_mfma_f32_16x16x32_bf16 v[24:27], v[60:63], v[144:147], v[24:27]
    ds_read_b64_tr_b16 v[52:53], v2 offset:8992
    s_add_u32 s27, s27, 0x20000
    s_add_u32 m0, s69, 92928
    v_mfma_f32_16x16x32_bf16 v[28:31], v[60:63], v[148:151], v[28:31]
    ds_read_b64_tr_b16 v[54:55], v2 offset:9248
    v_mfma_f32_16x16x32_bf16 v[32:35], v[64:67], v[144:147], v[32:35]
    ds_read_b64_tr_b16 v[56:57], v3 offset:8960
    buffer_load_dwordx4 v4, s[48:51], s27 offen lds
    s_add_u32 m0, m0, 1056
    v_mfma_f32_16x16x32_bf16 v[36:39], v[64:67], v[148:151], v[36:39]
    ds_read_b64_tr_b16 v[58:59], v3 offset:9216
    v_mfma_f32_16x16x32_bf16 v[232:235], v[68:71], v[144:147], v[232:235]
    ds_read_b64_tr_b16 v[60:61], v3 offset:8992
    buffer_load_dwordx4 v5, s[48:51], s27 offen lds
    v_mfma_f32_16x16x32_bf16 v[236:239], v[68:71], v[148:151], v[236:239]
    ds_read_b64_tr_b16 v[62:63], v3 offset:9248
    s_waitcnt lgkmcnt(8)
    v_mfma_f32_16x16x32_bf16 v[16:19], v[72:75], v[152:155], v[16:19]
    ds_read_b64_tr_b16 v[64:65], v2 offset:16896
    s_lshl_b32 s28, s24, 11
    v_mfma_f32_16x16x32_bf16 v[20:23], v[72:75], v[156:159], v[20:23]
    ds_read_b64_tr_b16 v[66:67], v2 offset:17152
    s_add_u32 s28, s28, 137216
    v_mfma_f32_16x16x32_bf16 v[24:27], v[76:79], v[152:155], v[24:27]
    ds_read_b64_tr_b16 v[68:69], v2 offset:16928
    v_lshl_add_u32 v12, v0, 4, s28
    v_mfma_f32_16x16x32_bf16 v[28:31], v[76:79], v[156:159], v[28:31]
    ds_read_b64_tr_b16 v[70:71], v2 offset:17184
    s_xor_b32 s28, s24, 4
    v_mfma_f32_16x16x32_bf16 v[32:35], v[40:43], v[152:155], v[32:35]
    ds_read_b64_tr_b16 v[72:73], v3 offset:16896
    s_lshl_b32 s28, s28, 11
    v_mfma_f32_16x16x32_bf16 v[36:39], v[40:43], v[156:159], v[36:39]
    ds_read_b64_tr_b16 v[74:75], v3 offset:17152
    s_add_u32 s28, s28, 137216
    v_mfma_f32_16x16x32_bf16 v[232:235], v[44:47], v[152:155], v[232:235]
    ds_read_b64_tr_b16 v[76:77], v3 offset:16928
    v_lshl_add_u32 v13, v0, 4, s28
    v_mfma_f32_16x16x32_bf16 v[236:239], v[44:47], v[156:159], v[236:239]
    ds_read_b64_tr_b16 v[78:79], v3 offset:17184
    v_and_b32 v11, 15, v0
    s_waitcnt lgkmcnt(8)
    v_mfma_f32_16x16x32_bf16 v[16:19], v[48:51], v[160:163], v[16:19]
    ds_read_b64_tr_b16 v[40:41], v2 offset:17408
    s_lshl_b32 s28, s31, 5
    v_mfma_f32_16x16x32_bf16 v[20:23], v[48:51], v[164:167], v[20:23]
    ds_read_b64_tr_b16 v[42:43], v2 offset:17664
    v_add_u32 v11, s28, v11
    v_mfma_f32_16x16x32_bf16 v[24:27], v[52:55], v[160:163], v[24:27]
    ds_read_b64_tr_b16 v[44:45], v2 offset:17440
    v_lshlrev_b32 v11, 12, v11
    v_mfma_f32_16x16x32_bf16 v[28:31], v[52:55], v[164:167], v[28:31]
    ds_read_b64_tr_b16 v[46:47], v2 offset:17696
    v_lshrrev_b32 v252, 4, v0
    v_mfma_f32_16x16x32_bf16 v[32:35], v[56:59], v[160:163], v[32:35]
    ds_read_b64_tr_b16 v[48:49], v3 offset:17408
    v_lshl_add_u32 v11, v252, 4, v11
    v_mfma_f32_16x16x32_bf16 v[36:39], v[56:59], v[164:167], v[36:39]
    ds_read_b64_tr_b16 v[50:51], v3 offset:17664
    s_mov_b32 s25, 0x10000
    v_mfma_f32_16x16x32_bf16 v[232:235], v[60:63], v[160:163], v[232:235]
    ds_read_b64_tr_b16 v[52:53], v3 offset:17440
    v_mfma_f32_16x16x32_bf16 v[236:239], v[60:63], v[164:167], v[236:239]
    ds_read_b64_tr_b16 v[54:55], v3 offset:17696
    s_cmp_eq_u32 s101, 0
    s_cbranch_scc1 L_have1
    s_mov_b32 s28, 1048576
L_s1:
    buffer_load_dwordx2 v[248:249], v8, s[20:23], 0 offen sc1
    s_sub_u32 s28, s28, 1
    s_waitcnt vmcnt(0)
    s_cbranch_scc1 L_s1x
    v_cmp_ne_u64 vcc, s[98:99], v[248:249]
    s_and_b32 s27, vcc_lo, s100
    s_cbranch_scc1 L_s1
L_s1x:
    buffer_load_dwordx4 v[168:171], v14, s[20:23], s41 offen offset:0 sc1
    buffer_load_dwordx4 v[172:175], v14, s[20:23], s41 offen offset:1024 sc1
    buffer_load_dwordx4 v[176:179], v14, s[20:23], s41 offen offset:2048 sc1
    buffer_load_dwordx4 v[180:183], v14, s[20:23], s41 offen offset:3072 sc1
    s_add_u32 s28, s41, 4096
    buffer_load_dwordx4 v[184:187], v14, s[20:23], s28 offen offset:0 sc1
    buffer_load_dwordx4 v[188:191], v14, s[20:23], s28 offen offset:1024 sc1
    buffer_load_dwordx4 v[192:195], v14, s[20:23], s28 offen offset:2048 sc1
    buffer_load_dwordx4 v[196:199], v14, s[20:23], s28 offen offset:3072 sc1
L_have1:
    s_waitcnt vmcnt(4)
    s_waitcnt lgkmcnt(8)
    v_mfma_f32_16x16x32_bf16 v[16:19], v[64:67], v[168:171], v[16:19]
    ds_read_b64_tr_b16 v[56:57], v2 offset:25344
    buffer_load_dwordx4 v[200:203], v14, s[20:23], s42 offen offset:0 sc1
    v_mfma_f32_16x16x32_bf16 v[20:23], v[64:67], v[172:175], v[20:23]
    ds_read_b64_tr_b16 v[58:59], v2 offset:25600
    v_mfma_f32_16x16x32_bf16 v[24:27], v[68:71], v[168:171], v[24:27]
    ds_read_b64_tr_b16 v[60:61], v2 offset:25376
    buffer_load_dwordx4 v[204:207], v14, s[20:23], s42 offen offset:1024 sc1
    v_mfma_f32_16x16x32_bf16 v[28:31], v[68:71], v[172:175], v[28:31]
    ds_read_b64_tr_b16 v[62:63], v2 offset:25632
    v_mfma_f32_16x16x32_bf16 v[32:35], v[72:75], v[168:171], v[32:35]
    ds_read_b64_tr_b16 v[64:65], v3 offset:25344
    buffer_load_dwordx4 v[208:211], v14, s[20:23], s42 offen offset:2048 sc1
    v_mfma_f32_16x16x32_bf16 v[36:39], v[72:75], v[172:175], v[36:39]
    ds_read_b64_tr_b16 v[66:67], v3 offset:25600
    v_mfma_f32_16x16x32_bf16 v[232:235], v[76:79], v[168:171], v[232:235]
    ds_read_b64_tr_b16 v[68:69], v3 offset:25376
    buffer_load_dwordx4 v[212:215], v14, s[20:23], s42 offen offset:3072 sc1
    v_mfma_f32_16x16x32_bf16 v[236:239], v[76:79], v[172:175], v[236:239]
    ds_read_b64_tr_b16 v[70:71], v3 offset:25632
    s_waitcnt lgkmcnt(8)
    v_mfma_f32_16x16x32_bf16 v[16:19], v[40:43], v[176:179], v[16:19]
    ds_read_b64_tr_b16 v[72:73], v2 offset:25856
    s_add_u32 s28, s42, 4096
    buffer_load_dwordx4 v[216:219], v14, s[20:23], s28 offen offset:0 sc1
    v_mfma_f32_16x16x32_bf16 v[20:23], v[40:43], v[180:183], v[20:23]
    ds_read_b64_tr_b16 v[74:75], v2 offset:26112
    v_mfma_f32_16x16x32_bf16 v[24:27], v[44:47], v[176:179], v[24:27]
    ds_read_b64_tr_b16 v[76:77], v2 offset:25888
    buffer_load_dwordx4 v[220:223], v14, s[20:23], s28 offen offset:1024 sc1
    v_mfma_f32_16x16x32_bf16 v[28:31], v[44:47], v[180:183], v[28:31]
    ds_read_b64_tr_b16 v[78:79], v2 offset:26144
    v_mfma_f32_16x16x32_bf16 v[32:35], v[48:51], v[176:179], v[32:35]
    ds_read_b64_tr_b16 v[40:41], v3 offset:25856
    buffer_load_dwordx4 v[224:227], v14, s[20:23], s28 offen offset:2048 sc1
    v_mfma_f32_16x16x32_bf16 v[36:39], v[48:51], v[180:183], v[36:39]
    ds_read_b64_tr_b16 v[42:43], v3 offset:26112
    v_mfma_f32_16x16x32_bf16 v[232:235], v[52:55], v[176:179], v[232:235]
    ds_read_b64_tr_b16 v[44:45], v3 offset:25888
    buffer_load_dwordx4 v[228:231], v14, s[20:23], s28 offen offset:3072 sc1
    v_mfma_f32_16x16x32_bf16 v[236:239], v[52:55], v[180:183], v[236:239]
    ds_read_b64_tr_b16 v[46:47], v3 offset:26144
    s_barrier
    s_waitcnt vmcnt(8)
    s_waitcnt lgkmcnt(8)
    v_mfma_f32_16x16x32_bf16 v[16:19], v[56:59], v[184:187], v[16:19]
    ds_read_b64_tr_b16 v[48:49], v6 offset:0
    s_add_u32 s27, s32, s37
    s_add_u32 m0, s69, 0
    v_mfma_f32_16x16x32_bf16 v[20:23], v[56:59], v[188:191], v[20:23]
    ds_read_b64_tr_b16 v[50:51], v6 offset:256
    v_mfma_f32_16x16x32_bf16 v[24:27], v[60:63], v[184:187], v[24:27]
    ds_read_b64_tr_b16 v[52:53], v6 offset:32
    buffer_load_dwordx4 v4, s[48:51], s27 offen lds
    s_add_u32 m0, m0, 1056
    v_mfma_f32_16x16x32_bf16 v[28:31], v[60:63], v[188:191], v[28:31]
    ds_read_b64_tr_b16 v[54:55], v6 offset:288
    v_mfma_f32_16x16x32_bf16 v[32:35], v[64:67], v[184:187], v[32:35]
    ds_read_b64_tr_b16 v[56:57], v7 offset:0
    buffer_load_dwordx4 v5, s[48:51], s27 offen lds
    v_mfma_f32_16x16x32_bf16 v[36:39], v[64:67], v[188:191], v[36:39]
    ds_read_b64_tr_b16 v[58:59], v7 offset:256
    v_mfma_f32_16x16x32_bf16 v[232:235], v[68:71], v[184:187], v[232:235]
    ds_read_b64_tr_b16 v[60:61], v7 offset:32
    s_add_u32 s27, s27, 0x20000
    s_add_u32 m0, s69, 8448
    v_mfma_f32_16x16x32_bf16 v[236:239], v[68:71], v[188:191], v[236:239]
    ds_read_b64_tr_b16 v[62:63], v7 offset:288
    s_waitcnt lgkmcnt(8)
    v_mfma_f32_16x16x32_bf16 v[16:19], v[72:75], v[192:195], v[16:19]
    ds_read_b64_tr_b16 v[64:65], v6 offset:512
    buffer_load_dwordx4 v4, s[48:51], s27 offen lds
    s_add_u32 m0, m0, 1056
    v_mfma_f32_16x16x32_bf16 v[20:23], v[72:75], v[196:199], v[20:23]
    ds_read_b64_tr_b16 v[66:67], v6 offset:768
    v_mfma_f32_16x16x32_bf16 v[24:27], v[76:79], v[192:195], v[24:27]
    ds_read_b64_tr_b16 v[68:69], v6 offset:544
    buffer_load_dwordx4 v5, s[48:51], s27 offen lds
    v_mfma_f32_16x16x32_bf16 v[28:31], v[76:79], v[196:199], v[28:31]
    ds_read_b64_tr_b16 v[70:71], v6 offset:800
    v_mfma_f32_16x16x32_bf16 v[32:35], v[40:43], v[192:195], v[32:35]
    ds_read_b64_tr_b16 v[72:73], v7 offset:512
    v_mfma_f32_16x16x32_bf16 v[36:39], v[40:43], v[196:199], v[36:39]
    ds_read_b64_tr_b16 v[74:75], v7 offset:768
    v_mfma_f32_16x16x32_bf16 v[232:235], v[44:47], v[192:195], v[232:235]
    ds_read_b64_tr_b16 v[76:77], v7 offset:544
    v_mfma_f32_16x16x32_bf16 v[236:239], v[44:47], v[196:199], v[236:239]
    ds_read_b64_tr_b16 v[78:79], v7 offset:800
    s_waitcnt vmcnt(8)
    s_waitcnt lgkmcnt(8)
    v_mfma_f32_16x16x32_bf16 v[16:19], v[48:51], v[200:203], v[16:19]
    ds_read_b64_tr_b16 v[40:41], v6 offset:8448
    buffer_load_dwordx4 v[104:107], v14, s[20:23], s43 offen offset:0 sc1
    v_mfma_f32_16x16x32_bf16 v[20:23], v[48:51], v[204:207], v[20:23]
    ds_read_b64_tr_b16 v[42:43], v6 offset:8704
    v_mfma_f32_16x16x32_bf16 v[24:27], v[52:55], v[200:203], v[24:27]
    ds_read_b64_tr_b16 v[44:45], v6 offset:8480
    buffer_load_dwordx4 v[108:111], v14, s[20:23], s43 offen offset:1024 sc1
    v_mfma_f32_16x16x32_bf16 v[28:31], v[52:55], v[204:207], v[28:31]
    ds_read_b64_tr_b16 v[46:47], v6 offset:8736
    v_mfma_f32_16x16x32_bf16 v[32:35], v[56:59], v[200:203], v[32:35]
    ds_read_b64_tr_b16 v[48:49], v7 offset:8448
    buffer_load_dwordx4 v[112:115], v14, s[20:23], s43 offen offset:2048 sc1
    v_mfma_f32_16x16x32_bf16 v[36:39], v[56:59], v[204:207], v[36:39]
    ds_read_b64_tr_b16 v[50:51], v7 offset:8704
    v_mfma_f32_16x16x32_bf16 v[232:235], v[60:63], v[200:203], v[232:235]
    ds_read_b64_tr_b16 v[52:53], v7 offset:8480
    buffer_load_dwordx4 v[116:119], v14, s[20:23], s43 offen offset:3072 sc1
    v_mfma_f32_16x16x32_bf16 v[236:239], v[60:63], v[204:207], v[236:239]
    ds_read_b64_tr_b16 v[54:55], v7 offset:8736
    s_waitcnt lgkmcnt(8)
    v_mfma_f32_16x16x32_bf16 v[16:19], v[64:67], v[208:211], v[16:19]
    ds_read_b64_tr_b16 v[56:57], v6 offset:8960
    s_add_u32 s28, s43, 4096
    buffer_load_dwordx4 v[120:123], v14, s[20:23], s28 offen offset:0 sc1
    v_mfma_f32_16x16x32_bf16 v[20:23], v[64:67], v[212:215], v[20:23]
    ds_read_b64_tr_b16 v[58:59], v6 offset:9216
    v_mfma_f32_16x16x32_bf16 v[24:27], v[68:71], v[208:211], v[24:27]
    ds_read_b64_tr_b16 v[60:61], v6 offset:8992
    buffer_load_dwordx4 v[124:127], v14, s[20:23], s28 offen offset:1024 sc1
    v_mfma_f32_16x16x32_bf16 v[28:31], v[68:71], v[212:215], v[28:31]
    ds_read_b64_tr_b16 v[62:63], v6 offset:9248
    v_mfma_f32_16x16x32_bf16 v[32:35], v[72:75], v[208:211], v[32:35]
    ds_read_b64_tr_b16 v[64:65], v7 offset:8960
    buffer_load_dwordx4 v[128:131], v14, s[20:23], s28 offen offset:2048 sc1
    v_mfma_f32_16x16x32_bf16 v[36:39], v[72:75], v[212:215], v[36:39]
    ds_read_b64_tr_b16 v[66:67], v7 offset:9216
    v_mfma_f32_16x16x32_bf16 v[232:235], v[76:79], v[208:211], v[232:235]
    ds_read_b64_tr_b16 v[68:69], v7 offset:8992
    buffer_load_dwordx4 v[132:135], v14, s[20:23], s28 offen offset:3072 sc1
    v_mfma_f32_16x16x32_bf16 v[236:239], v[76:79], v[212:215], v[236:239]
    ds_read_b64_tr_b16 v[70:71], v7 offset:9248
    s_barrier
    s_waitcnt vmcnt(12)
    s_waitcnt lgkmcnt(8)
    v_mfma_f32_16x16x32_bf16 v[16:19], v[40:43], v[216:219], v[16:19]
    ds_read_b64_tr_b16 v[72:73], v6 offset:16896
    s_add_u32 s27, s33, s37
    s_add_u32 m0, s69, 16896
    v_mfma_f32_16x16x32_bf16 v[20:23], v[40:43], v[220:223], v[20:23]
    ds_read_b64_tr_b16 v[74:75], v6 offset:17152
    v_mfma_f32_16x16x32_bf16 v[24:27], v[44:47], v[216:219], v[24:27]
    ds_read_b64_tr_b16 v[76:77], v6 offset:16928
    buffer_load_dwordx4 v4, s[48:51], s27 offen lds
    s_add_u32 m0, m0, 1056
    v_mfma_f32_16x16x32_bf16 v[28:31], v[44:47], v[220:223], v[28:31]
    ds_read_b64_tr_b16 v[78:79], v6 offset:17184
    v_mfma_f32_16x16x32_bf16 v[32:35], v[48:51], v[216:219], v[32:35]
    ds_read_b64_tr_b16 v[40:41], v7 offset:16896
    buffer_load_dwordx4 v5, s[48:51], s27 offen lds
    v_mfma_f32_16x16x32_bf16 v[36:39], v[48:51], v[220:223], v[36:39]
    ds_read_b64_tr_b16 v[42:43], v7 offset:17152
    v_mfma_f32_16x16x32_bf16 v[232:235], v[52:55], v[216:219], v[232:235]
    ds_read_b64_tr_b16 v[44:45], v7 offset:16928
    s_add_u32 s27, s27, 0x20000
    s_add_u32 m0, s69, 25344
    v_mfma_f32_16x16x32_bf16 v[236:239], v[52:55], v[220:223], v[236:239]
    ds_read_b64_tr_b16 v[46:47], v7 offset:17184
    s_waitcnt lgkmcnt(8)
    v_mfma_f32_16x16x32_bf16 v[16:19], v[56:59], v[224:227], v[16:19]
    ds_read_b64_tr_b16 v[48:49], v6 offset:17408
    buffer_load_dwordx4 v4, s[48:51], s27 offen lds
    s_add_u32 m0, m0, 1056
    v_mfma_f32_16x16x32_bf16 v[20:23], v[56:59], v[228:231], v[20:23]
    ds_read_b64_tr_b16 v[50:51], v6 offset:17664
    v_mfma_f32_16x16x32_bf16 v[24:27], v[60:63], v[224:227], v[24:27]
    ds_read_b64_tr_b16 v[52:53], v6 offset:17440
    buffer_load_dwordx4 v5, s[48:51], s27 offen lds
    v_mfma_f32_16x16x32_bf16 v[28:31], v[60:63], v[228:231], v[28:31]
    ds_read_b64_tr_b16 v[54:55], v6 offset:17696
    v_mfma_f32_16x16x32_bf16 v[32:35], v[64:67], v[224:227], v[32:35]
    ds_read_b64_tr_b16 v[56:57], v7 offset:17408
    v_mfma_f32_16x16x32_bf16 v[36:39], v[64:67], v[228:231], v[36:39]
    ds_read_b64_tr_b16 v[58:59], v7 offset:17664
    s_cmp_eq_u32 s30, 0
    s_cbranch_scc0 L_wt3
    s_lshl_b32 s26, s31, 5
    v_add_u32 v254, s26, v0
    v_lshlrev_b32 v254, 11, v254
    s_lshl_b32 s26, s67, 18
    s_add_u32 s26, s26, s38
    s_mov_b32 exec_hi, 0
    buffer_load_dword v1, v254, s[48:51], s26 offen
    s_mov_b32 exec_hi, -1
L_wt3:
    v_mfma_f32_16x16x32_bf16 v[232:235], v[68:71], v[224:227], v[232:235]
    ds_read_b64_tr_b16 v[60:61], v7 offset:17440
    v_mfma_f32_16x16x32_bf16 v[236:239], v[68:71], v[228:231], v[236:239]
    ds_read_b64_tr_b16 v[62:63], v7 offset:17696
    s_waitcnt vmcnt(8)
    s_waitcnt lgkmcnt(8)
    v_mfma_f32_16x16x32_bf16 v[16:19], v[72:75], v[104:107], v[16:19]
    ds_read_b64_tr_b16 v[64:65], v7 offset:25344
    v_bfe_u32 v246, v0, 2, 2
    v_mfma_f32_16x16x32_bf16 v[20:23], v[72:75], v[108:111], v[20:23]
    ds_read_b64_tr_b16 v[66:67], v7 offset:25600
    v_lshrrev_b32 v247, 4, v0
    v_mfma_f32_16x16x32_bf16 v[24:27], v[76:79], v[104:107], v[24:27]
    ds_read_b64_tr_b16 v[68:69], v7 offset:25376
    v_cmp_eq_u32 vcc, v247, v246
    v_mfma_f32_16x16x32_bf16 v[28:31], v[76:79], v[108:111], v[28:31]
    ds_read_b64_tr_b16 v[70:71], v7 offset:25632
    v_and_b32 v246, 1, v0
    v_mfma_f32_16x16x32_bf16 v[32:35], v[40:43], v[104:107], v[32:35]
    ds_read_b64_tr_b16 v[72:73], v7 offset:25856
    v_lshlrev_b32 v246, 4, v246
    v_mfma_f32_16x16x32_bf16 v[36:39], v[40:43], v[108:111], v[36:39]
    ds_read_b64_tr_b16 v[74:75], v7 offset:26112
    v_mov_b32 v247, 0x3f80
    v_mfma_f32_16x16x32_bf16 v[232:235], v[44:47], v[104:107], v[232:235]
    ds_read_b64_tr_b16 v[76:77], v7 offset:25888
    v_lshlrev_b32 v246, v246, v247
    v_mfma_f32_16x16x32_bf16 v[236:239], v[44:47], v[108:111], v[236:239]
    ds_read_b64_tr_b16 v[78:79], v7 offset:26144
    v_cndmask_b32 v246, 0, v246, vcc
    s_waitcnt lgkmcnt(8)
    v_mfma_f32_16x16x32_bf16 v[16:19], v[48:51], v[112:115], v[16:19]
    ds_read_b64_tr_b16 v[40:41], v6 offset:25344
    v_and_b32 v247, 2, v0
    v_mfma_f32_16x16x32_bf16 v[20:23], v[48:51], v[116:119], v[20:23]
    ds_read_b64_tr_b16 v[42:43], v6 offset:25600
    v_cmp_eq_u32 vcc, 0, v247
    v_mfma_f32_16x16x32_bf16 v[24:27], v[52:55], v[112:115], v[24:27]
    ds_read_b64_tr_b16 v[44:45], v6 offset:25376
    v_mov_b32 v240, 0
    v_mfma_f32_16x16x32_bf16 v[28:31], v[52:55], v[116:119], v[28:31]
    ds_read_b64_tr_b16 v[46:47], v6 offset:25632
    v_mov_b32 v241, 0
    v_mfma_f32_16x16x32_bf16 v[32:35], v[56:59], v[112:115], v[32:35]
    ds_read_b64_tr_b16 v[48:49], v6 offset:25856
    v_cndmask_b32 v242, 0, v246, vcc
    v_mfma_f32_16x16x32_bf16 v[36:39], v[56:59], v[116:119], v[36:39]
    ds_read_b64_tr_b16 v[50:51], v6 offset:26112
    v_sub_u32 v243, v246, v242
    v_mfma_f32_16x16x32_bf16 v[232:235], v[60:63], v[112:115], v[232:235]
    ds_read_b64_tr_b16 v[52:53], v6 offset:25888
    v_mov_b32 v244, 0
    v_mfma_f32_16x16x32_bf16 v[236:239], v[60:63], v[116:119], v[236:239]
    ds_read_b64_tr_b16 v[54:55], v6 offset:26144
    v_mov_b32 v245, 0
    s_barrier
    s_waitcnt vmcnt(4)
    s_waitcnt lgkmcnt(8)
    v_mfma_f32_16x16x32_bf16 v[32:35], v[64:67], v[120:123], v[32:35]
    ds_read_b64_tr_b16 v[56:57], v2 offset:0
    v_mfma_f32_16x16x32_bf16 v[36:39], v[64:67], v[124:127], v[36:39]
    ds_read_b64_tr_b16 v[58:59], v2 offset:256
    v_mfma_f32_16x16x32_bf16 v[232:235], v[68:71], v[120:123], v[232:235]
    ds_read_b64_tr_b16 v[60:61], v2 offset:32
    v_mfma_f32_16x16x32_bf16 v[236:239], v[68:71], v[124:127], v[236:239]
    ds_read_b64_tr_b16 v[62:63], v2 offset:288
    v_mfma_f32_16x16x32_bf16 v[32:35], v[72:75], v[128:131], v[32:35]
    ds_read_b64_tr_b16 v[64:65], v3 offset:0
    v_mfma_f32_16x16x32_bf16 v[36:39], v[72:75], v[132:135], v[36:39]
    ds_read_b64_tr_b16 v[66:67], v3 offset:256
    v_mfma_f32_16x16x32_bf16 v[232:235], v[76:79], v[128:131], v[232:235]
    ds_read_b64_tr_b16 v[68:69], v3 offset:32
    v_mfma_f32_16x16x32_bf16 v[236:239], v[76:79], v[132:135], v[236:239]
    ds_read_b64_tr_b16 v[70:71], v3 offset:288
    s_waitcnt lgkmcnt(8)
    v_mfma_f32_16x16x32_bf16 v[16:19], v[40:43], v[120:123], v[16:19]
    ds_read_b64_tr_b16 v[72:73], v2 offset:512
    v_mfma_f32_16x16x32_bf16 v[20:23], v[40:43], v[124:127], v[20:23]
    ds_read_b64_tr_b16 v[74:75], v2 offset:768
    v_mfma_f32_16x16x32_bf16 v[24:27], v[44:47], v[120:123], v[24:27]
    ds_read_b64_tr_b16 v[76:77], v2 offset:544
    v_mfma_f32_16x16x32_bf16 v[28:31], v[44:47], v[124:127], v[28:31]
    ds_read_b64_tr_b16 v[78:79], v2 offset:800
    v_mfma_f32_16x16x32_bf16 v[16:19], v[48:51], v[128:131], v[16:19]
    ds_read_b64_tr_b16 v[40:41], v3 offset:512
    v_cvt_pk_bf16_f32 v96, v32, v33
    v_cvt_pk_bf16_f32 v97, v34, v35
    v_mfma_f32_16x16x32_bf16 v[20:23], v[48:51], v[132:135], v[20:23]
    ds_read_b64_tr_b16 v[42:43], v3 offset:768
    v_cvt_pk_bf16_f32 v98, v232, v233
    v_cvt_pk_bf16_f32 v99, v234, v235
    v_mfma_f32_16x16x32_bf16 v[24:27], v[52:55], v[128:131], v[24:27]
    ds_read_b64_tr_b16 v[44:45], v3 offset:544
    v_cvt_pk_bf16_f32 v100, v36, v37
    v_cvt_pk_bf16_f32 v101, v38, v39
    v_mfma_f32_16x16x32_bf16 v[28:31], v[52:55], v[132:135], v[28:31]
    ds_read_b64_tr_b16 v[46:47], v3 offset:800
    v_cvt_pk_bf16_f32 v102, v236, v237
    v_cvt_pk_bf16_f32 v103, v238, v239
    ds_write_b128 v12, v[96:99] offset:0
    ds_write_b128 v12, v[100:103] offset:1024
    s_waitcnt lgkmcnt(10)
    v_mfma_f32_16x16x32_bf16 v[80:83], v[56:59], v[136:139], 0
    ds_read_b64_tr_b16 v[48:49], v2 offset:8448
    v_mfma_f32_16x16x32_bf16 v[84:87], v[56:59], v[140:143], 0
    ds_read_b64_tr_b16 v[50:51], v2 offset:8704
    v_mfma_f32_16x16x32_bf16 v[88:91], v[60:63], v[136:139], 0
    ds_read_b64_tr_b16 v[52:53], v2 offset:8480
    v_mfma_f32_16x16x32_bf16 v[92:95], v[60:63], v[140:143], 0
    ds_read_b64_tr_b16 v[54:55], v2 offset:8736
    v_mfma_f32_16x16x32_bf16 v[32:35], v[64:67], v[136:139], 0
    ds_read_b64_tr_b16 v[56:57], v3 offset:8448
    s_add_u32 s27, s34, s37
    s_add_u32 m0, s69, 67584
    v_mfma_f32_16x16x32_bf16 v[36:39], v[64:67], v[140:143], 0
    ds_read_b64_tr_b16 v[58:59], v3 offset:8704
    v_mfma_f32_16x16x32_bf16 v[232:235], v[68:71], v[136:139], 0
    ds_read_b64_tr_b16 v[60:61], v3 offset:8480
    buffer_load_dwordx4 v4, s[48:51], s27 offen lds
    s_add_u32 m0, m0, 1056
    v_mfma_f32_16x16x32_bf16 v[236:239], v[68:71], v[140:143], 0
    ds_read_b64_tr_b16 v[62:63], v3 offset:8736
    s_waitcnt lgkmcnt(10)
    v_mfma_f32_16x16x32_bf16 v[80:83], v[72:75], v[144:147], v[80:83]
    ds_read_b64_tr_b16 v[64:65], v2 offset:8960
    buffer_load_dwordx4 v5, s[48:51], s27 offen lds
    v_mfma_f32_16x16x32_bf16 v[84:87], v[72:75], v[148:151], v[84:87]
    ds_read_b64_tr_b16 v[66:67], v2 offset:9216
    v_mfma_f32_16x16x32_bf16 v[88:91], v[76:79], v[144:147], v[88:91]
    ds_read_b64_tr_b16 v[68:69], v2 offset:8992
    s_add_u32 s27, s27, 0x20000
    s_add_u32 m0, s69, 76032
    v_mfma_f32_16x16x32_bf16 v[92:95], v[76:79], v[148:151], v[92:95]
    ds_read_b64_tr_b16 v[70:71], v2 offset:9248
    v_mfma_f32_16x16x32_bf16 v[32:35], v[40:43], v[144:147], v[32:35]
    ds_read_b64_tr_b16 v[72:73], v3 offset:8960
    buffer_load_dwordx4 v4, s[48:51], s27 offen lds
    s_add_u32 m0, m0, 1056
    v_mfma_f32_16x16x32_bf16 v[36:39], v[40:43], v[148:151], v[36:39]
    ds_read_b64_tr_b16 v[74:75], v3 offset:9216
    v_mfma_f32_16x16x32_bf16 v[232:235], v[44:47], v[144:147], v[232:235]
    ds_read_b64_tr_b16 v[76:77], v3 offset:8992
    buffer_load_dwordx4 v5, s[48:51], s27 offen lds
    v_mfma_f32_16x16x32_bf16 v[236:239], v[44:47], v[148:151], v[236:239]
    ds_read_b64_tr_b16 v[78:79], v3 offset:9248
    s_waitcnt vmcnt(4)
    s_waitcnt lgkmcnt(15)
    s_barrier
    ds_read_b128 v[96:99], v13 offset:0
    ds_read_b128 v[100:103], v13 offset:1024
    s_waitcnt lgkmcnt(10)
    v_mfma_f32_16x16x32_bf16 v[80:83], v[48:51], v[152:155], v[80:83]
    ds_read_b64_tr_b16 v[40:41], v2 offset:16896
    s_add_u32 s27, s35, s37
    s_add_u32 m0, s69, 84480
    v_mfma_f32_16x16x32_bf16 v[84:87], v[48:51], v[156:159], v[84:87]
    ds_read_b64_tr_b16 v[42:43], v2 offset:17152
    v_mfma_f32_16x16x32_bf16 v[88:91], v[52:55], v[152:155], v[88:91]
    ds_read_b64_tr_b16 v[44:45], v2 offset:16928
    buffer_load_dwordx4 v4, s[48:51], s27 offen lds
    s_add_u32 m0, m0, 1056
    v_mfma_f32_16x16x32_bf16 v[92:95], v[52:55], v[156:159], v[92:95]
    ds_read_b64_tr_b16 v[46:47], v2 offset:17184
    v_mfma_f32_16x16x32_bf16 v[32:35], v[56:59], v[152:155], v[32:35]
    ds_read_b64_tr_b16 v[48:49], v3 offset:16896
    buffer_load_dwordx4 v5, s[48:51], s27 offen lds
    v_mfma_f32_16x16x32_bf16 v[36:39], v[56:59], v[156:159], v[36:39]
    ds_read_b64_tr_b16 v[50:51], v3 offset:17152
    v_mfma_f32_16x16x32_bf16 v[232:235], v[60:63], v[152:155], v[232:235]
    ds_read_b64_tr_b16 v[52:53], v3 offset:16928
    s_add_u32 s27, s27, 0x20000
    s_add_u32 m0, s69, 92928
    v_mfma_f32_16x16x32_bf16 v[236:239], v[60:63], v[156:159], v[236:239]
    ds_read_b64_tr_b16 v[54:55], v3 offset:17184
    s_waitcnt lgkmcnt(10)
    v_mfma_f32_16x16x32_bf16 v[80:83], v[64:67], v[160:163], v[80:83]
    ds_read_b64_tr_b16 v[56:57], v2 offset:17408
    buffer_load_dwordx4 v4, s[48:51], s27 offen lds
    s_add_u32 m0, m0, 1056
    v_mfma_f32_16x16x32_bf16 v[84:87], v[64:67], v[164:167], v[84:87]
    ds_read_b64_tr_b16 v[58:59], v2 offset:17664
    s_waitcnt lgkmcnt(10)
    v_mfma_f32_16x16x32_bf16 v[16:19], v[242:245], v[96:99], v[16:19]
    v_mfma_f32_16x16x32_bf16 v[24:27], v[240:243], v[96:99], v[24:27]
    v_mfma_f32_16x16x32_bf16 v[20:23], v[242:245], v[100:103], v[20:23]
    v_mfma_f32_16x16x32_bf16 v[28:31], v[240:243], v[100:103], v[28:31]
    v_mfma_f32_16x16x32_bf16 v[88:91], v[68:71], v[160:163], v[88:91]
    ds_read_b64_tr_b16 v[60:61], v2 offset:17440
    buffer_load_dwordx4 v5, s[48:51], s27 offen lds
    v_mfma_f32_16x16x32_bf16 v[92:95], v[68:71], v[164:167], v[92:95]
    ds_read_b64_tr_b16 v[62:63], v2 offset:17696
    v_mfma_f32_16x16x32_bf16 v[32:35], v[72:75], v[160:163], v[32:35]
    ds_read_b64_tr_b16 v[64:65], v3 offset:17408
    v_mfma_f32_16x16x32_bf16 v[36:39], v[72:75], v[164:167], v[36:39]
    ds_read_b64_tr_b16 v[66:67], v3 offset:17664
    v_mfma_f32_16x16x32_bf16 v[232:235], v[76:79], v[160:163], v[232:235]
    ds_read_b64_tr_b16 v[68:69], v3 offset:17440
    v_mfma_f32_16x16x32_bf16 v[236:239], v[76:79], v[164:167], v[236:239]
    ds_read_b64_tr_b16 v[70:71], v3 offset:17696
    s_waitcnt lgkmcnt(8)
    v_mfma_f32_16x16x32_bf16 v[80:83], v[40:43], v[168:171], v[80:83]
    ds_read_b64_tr_b16 v[72:73], v2 offset:25344
    v_cvt_pk_bf16_f32 v96, v16, v17
    v_mfma_f32_16x16x32_bf16 v[84:87], v[40:43], v[172:175], v[84:87]
    ds_read_b64_tr_b16 v[74:75], v2 offset:25600
    v_cvt_pk_bf16_f32 v97, v18, v19
    v_mfma_f32_16x16x32_bf16 v[88:91], v[44:47], v[168:171], v[88:91]
    ds_read_b64_tr_b16 v[76:77], v2 offset:25376
    v_cvt_pk_bf16_f32 v98, v24, v25
    v_mfma_f32_16x16x32_bf16 v[92:95], v[44:47], v[172:175], v[92:95]
    ds_read_b64_tr_b16 v[78:79], v2 offset:25632
    v_cvt_pk_bf16_f32 v99, v26, v27
    v_mfma_f32_16x16x32_bf16 v[32:35], v[48:51], v[168:171], v[32:35]
    ds_read_b64_tr_b16 v[40:41], v3 offset:25344
    v_cvt_pk_bf16_f32 v100, v20, v21
    v_mfma_f32_16x16x32_bf16 v[36:39], v[48:51], v[172:175], v[36:39]
    ds_read_b64_tr_b16 v[42:43], v3 offset:25600
    v_cvt_pk_bf16_f32 v101, v22, v23
    buffer_store_dwordx4 v[96:99], v14, s[20:23], s44 offen offset:0 sc1
    v_mfma_f32_16x16x32_bf16 v[232:235], v[52:55], v[168:171], v[232:235]
    ds_read_b64_tr_b16 v[44:45], v3 offset:25376
    v_cvt_pk_bf16_f32 v102, v28, v29
    v_mfma_f32_16x16x32_bf16 v[236:239], v[52:55], v[172:175], v[236:239]
    ds_read_b64_tr_b16 v[46:47], v3 offset:25632
    v_cvt_pk_bf16_f32 v103, v30, v31
    s_waitcnt lgkmcnt(8)
    v_mfma_f32_16x16x32_bf16 v[80:83], v[56:59], v[176:179], v[80:83]
    ds_read_b64_tr_b16 v[48:49], v2 offset:25856
    v_mfma_f32_16x16x32_bf16 v[84:87], v[56:59], v[180:183], v[84:87]
    ds_read_b64_tr_b16 v[50:51], v2 offset:26112
    buffer_store_dwordx4 v[100:103], v14, s[20:23], s44 offen offset:1024 sc1
    v_mfma_f32_16x16x32_bf16 v[88:91], v[60:63], v[176:179], v[88:91]
    ds_read_b64_tr_b16 v[52:53], v2 offset:25888
    v_mfma_f32_16x16x32_bf16 v[92:95], v[60:63], v[180:183], v[92:95]
    ds_read_b64_tr_b16 v[54:55], v2 offset:26144
    v_mfma_f32_16x16x32_bf16 v[32:35], v[64:67], v[176:179], v[32:35]
    ds_read_b64_tr_b16 v[56:57], v3 offset:25856
    v_mfma_f32_16x16x32_bf16 v[36:39], v[64:67], v[180:183], v[36:39]
    ds_read_b64_tr_b16 v[58:59], v3 offset:26112
    v_mfma_f32_16x16x32_bf16 v[232:235], v[68:71], v[176:179], v[232:235]
    ds_read_b64_tr_b16 v[60:61], v3 offset:25888
    v_mfma_f32_16x16x32_bf16 v[236:239], v[68:71], v[180:183], v[236:239]
    ds_read_b64_tr_b16 v[62:63], v3 offset:26144
    s_waitcnt vmcnt(6)
    s_barrier
    s_waitcnt lgkmcnt(8)
    v_mfma_f32_16x16x32_bf16 v[80:83], v[72:75], v[184:187], v[80:83]
    ds_read_b64_tr_b16 v[64:65], v6 offset:0
    s_add_u32 s27, s32, s38
    s_add_u32 m0, s69, 0
    v_mfma_f32_16x16x32_bf16 v[84:87], v[72:75], v[188:191], v[84:87]
    ds_read_b64_tr_b16 v[66:67], v6 offset:256
    s_mul_i32 s28, s2, 384
    v_mfma_f32_16x16x32_bf16 v[88:91], v[76:79], v[184:187], v[88:91]
    ds_read_b64_tr_b16 v[68:69], v6 offset:32
    buffer_load_dwordx4 v4, s[48:51], s27 offen lds
    s_add_u32 m0, m0, 1056
    v_mfma_f32_16x16x32_bf16 v[92:95], v[76:79], v[188:191], v[92:95]
    ds_read_b64_tr_b16 v[70:71], v6 offset:288
    s_add_u32 s28, s28, 50397184
    v_mfma_f32_16x16x32_bf16 v[32:35], v[40:43], v[184:187], v[32:35]
    ds_read_b64_tr_b16 v[72:73], v7 offset:0
    buffer_load_dwordx4 v5, s[48:51], s27 offen lds
    v_mfma_f32_16x16x32_bf16 v[36:39], v[40:43], v[188:191], v[36:39]
    ds_read_b64_tr_b16 v[74:75], v7 offset:256
    v_min_u32 v10, 2, v0
    v_mfma_f32_16x16x32_bf16 v[232:235], v[44:47], v[184:187], v[232:235]
    ds_read_b64_tr_b16 v[76:77], v7 offset:32
    s_add_u32 s27, s27, 0x20000
    s_add_u32 m0, s69, 8448
    v_mfma_f32_16x16x32_bf16 v[236:239], v[44:47], v[188:191], v[236:239]
    ds_read_b64_tr_b16 v[78:79], v7 offset:288
    v_lshl_add_u32 v10, v10, 7, s28
    s_waitcnt lgkmcnt(8)
    v_mfma_f32_16x16x32_bf16 v[80:83], v[48:51], v[192:195], v[80:83]
    ds_read_b64_tr_b16 v[40:41], v6 offset:512
    buffer_load_dwordx4 v4, s[48:51], s27 offen lds
    s_add_u32 m0, m0, 1056
    v_mfma_f32_16x16x32_bf16 v[84:87], v[48:51], v[196:199], v[84:87]
    ds_read_b64_tr_b16 v[42:43], v6 offset:768
    v_lshlrev_b32 v15, 3, v0
    v_mfma_f32_16x16x32_bf16 v[88:91], v[52:55], v[192:195], v[88:91]
    ds_read_b64_tr_b16 v[44:45], v6 offset:544
    buffer_load_dwordx4 v5, s[48:51], s27 offen lds
    v_mfma_f32_16x16x32_bf16 v[92:95], v[52:55], v[196:199], v[92:95]
    ds_read_b64_tr_b16 v[46:47], v6 offset:800
    v_mov_b32 v8, s98
    v_mfma_f32_16x16x32_bf16 v[32:35], v[56:59], v[192:195], v[32:35]
    ds_read_b64_tr_b16 v[48:49], v7 offset:512
    v_mfma_f32_16x16x32_bf16 v[36:39], v[56:59], v[196:199], v[36:39]
    ds_read_b64_tr_b16 v[50:51], v7 offset:768
    v_mov_b32 v9, s99
    v_mfma_f32_16x16x32_bf16 v[232:235], v[60:63], v[192:195], v[232:235]
    ds_read_b64_tr_b16 v[52:53], v7 offset:544
    v_mfma_f32_16x16x32_bf16 v[236:239], v[60:63], v[196:199], v[236:239]
    ds_read_b64_tr_b16 v[54:55], v7 offset:800
    s_waitcnt lgkmcnt(8)
    v_mfma_f32_16x16x32_bf16 v[80:83], v[64:67], v[200:203], v[80:83]
    ds_read_b64_tr_b16 v[56:57], v6 offset:8448
    v_mfma_f32_16x16x32_bf16 v[84:87], v[64:67], v[204:207], v[84:87]
    ds_read_b64_tr_b16 v[58:59], v6 offset:8704
    v_mfma_f32_16x16x32_bf16 v[88:91], v[68:71], v[200:203], v[88:91]
    ds_read_b64_tr_b16 v[60:61], v6 offset:8480
    v_mfma_f32_16x16x32_bf16 v[92:95], v[68:71], v[204:207], v[92:95]
    ds_read_b64_tr_b16 v[62:63], v6 offset:8736
    v_mfma_f32_16x16x32_bf16 v[32:35], v[72:75], v[200:203], v[32:35]
    ds_read_b64_tr_b16 v[64:65], v7 offset:8448
    v_mfma_f32_16x16x32_bf16 v[36:39], v[72:75], v[204:207], v[36:39]
    ds_read_b64_tr_b16 v[66:67], v7 offset:8704
    v_mfma_f32_16x16x32_bf16 v[232:235], v[76:79], v[200:203], v[232:235]
    ds_read_b64_tr_b16 v[68:69], v7 offset:8480
    v_mfma_f32_16x16x32_bf16 v[236:239], v[76:79], v[204:207], v[236:239]
    ds_read_b64_tr_b16 v[70:71], v7 offset:8736
    s_waitcnt lgkmcnt(8)
    v_mfma_f32_16x16x32_bf16 v[80:83], v[40:43], v[208:211], v[80:83]
    ds_read_b64_tr_b16 v[72:73], v6 offset:8960
    v_mfma_f32_16x16x32_bf16 v[84:87], v[40:43], v[212:215], v[84:87]
    ds_read_b64_tr_b16 v[74:75], v6 offset:9216
    v_mfma_f32_16x16x32_bf16 v[88:91], v[44:47], v[208:211], v[88:91]
    ds_read_b64_tr_b16 v[76:77], v6 offset:8992
    v_mfma_f32_16x16x32_bf16 v[92:95], v[44:47], v[212:215], v[92:95]
    ds_read_b64_tr_b16 v[78:79], v6 offset:9248
    v_mfma_f32_16x16x32_bf16 v[32:35], v[48:51], v[208:211], v[32:35]
    ds_read_b64_tr_b16 v[40:41], v7 offset:8960
    v_mfma_f32_16x16x32_bf16 v[36:39], v[48:51], v[212:215], v[36:39]
    ds_read_b64_tr_b16 v[42:43], v7 offset:9216
    v_mfma_f32_16x16x32_bf16 v[232:235], v[52:55], v[208:211], v[232:235]
    ds_read_b64_tr_b16 v[44:45], v7 offset:8992
    v_mfma_f32_16x16x32_bf16 v[236:239], v[52:55], v[212:215], v[236:239]
    ds_read_b64_tr_b16 v[46:47], v7 offset:9248
    s_waitcnt vmcnt(4)
    s_barrier
    s_cmp_lg_u32 s24, 0
    s_cbranch_scc1 L_nf0
    s_mov_b64 exec, 0xffff
    buffer_store_dwordx2 v[8:9], v15, s[20:23], s8 offen sc1
    s_mov_b64 exec, -1
L_nf0:
    s_waitcnt lgkmcnt(8)
    v_mfma_f32_16x16x32_bf16 v[80:83], v[56:59], v[216:219], v[80:83]
    ds_read_b64_tr_b16 v[48:49], v6 offset:16896
    s_add_u32 s27, s33, s38
    s_add_u32 m0, s69, 16896
    v_mfma_f32_16x16x32_bf16 v[84:87], v[56:59], v[220:223], v[84:87]
    ds_read_b64_tr_b16 v[50:51], v6 offset:17152
    v_mfma_f32_16x16x32_bf16 v[88:91], v[60:63], v[216:219], v[88:91]
    ds_read_b64_tr_b16 v[52:53], v6 offset:16928
    buffer_load_dwordx4 v4, s[48:51], s27 offen lds
    s_add_u32 m0, m0, 1056
    v_mfma_f32_16x16x32_bf16 v[92:95], v[60:63], v[220:223], v[92:95]
    ds_read_b64_tr_b16 v[54:55], v6 offset:17184
    v_mfma_f32_16x16x32_bf16 v[32:35], v[64:67], v[216:219], v[32:35]
    ds_read_b64_tr_b16 v[56:57], v7 offset:16896
    buffer_load_dwordx4 v5, s[48:51], s27 offen lds
    v_mfma_f32_16x16x32_bf16 v[36:39], v[64:67], v[220:223], v[36:39]
    ds_read_b64_tr_b16 v[58:59], v7 offset:17152
    v_mfma_f32_16x16x32_bf16 v[232:235], v[68:71], v[216:219], v[232:235]
    ds_read_b64_tr_b16 v[60:61], v7 offset:16928
    s_add_u32 s27, s27, 0x20000
    s_add_u32 m0, s69, 25344
    v_mfma_f32_16x16x32_bf16 v[236:239], v[68:71], v[220:223], v[236:239]
    ds_read_b64_tr_b16 v[62:63], v7 offset:17184
    s_waitcnt lgkmcnt(8)
    v_mfma_f32_16x16x32_bf16 v[80:83], v[72:75], v[224:227], v[80:83]
    ds_read_b64_tr_b16 v[64:65], v6 offset:17408
    buffer_load_dwordx4 v4, s[48:51], s27 offen lds
    s_add_u32 m0, m0, 1056
    v_mfma_f32_16x16x32_bf16 v[84:87], v[72:75], v[228:231], v[84:87]
    ds_read_b64_tr_b16 v[66:67], v6 offset:17664
    v_mfma_f32_16x16x32_bf16 v[88:91], v[76:79], v[224:227], v[88:91]
    ds_read_b64_tr_b16 v[68:69], v6 offset:17440
    buffer_load_dwordx4 v5, s[48:51], s27 offen lds
    v_mfma_f32_16x16x32_bf16 v[92:95], v[76:79], v[228:231], v[92:95]
    ds_read_b64_tr_b16 v[70:71], v6 offset:17696
    v_mfma_f32_16x16x32_bf16 v[32:35], v[40:43], v[224:227], v[32:35]
    ds_read_b64_tr_b16 v[72:73], v7 offset:17408
    v_mfma_f32_16x16x32_bf16 v[36:39], v[40:43], v[228:231], v[36:39]
    ds_read_b64_tr_b16 v[74:75], v7 offset:17664
    s_cmp_eq_u32 s30, 0
    s_cbranch_scc0 L_wt7
    s_lshl_b32 s26, s31, 5
    v_add_u32 v254, s26, v0
    v_lshlrev_b32 v254, 11, v254
    s_lshl_b32 s26, s67, 18
    s_add_u32 s26, s26, s39
    s_mov_b32 exec_hi, 0
    buffer_load_dword v1, v254, s[48:51], s26 offen
    s_mov_b32 exec_hi, -1
L_wt7:
    v_mfma_f32_16x16x32_bf16 v[232:235], v[44:47], v[224:227], v[232:235]
    ds_read_b64_tr_b16 v[76:77], v7 offset:17440
    v_mfma_f32_16x16x32_bf16 v[236:239], v[44:47], v[228:231], v[236:239]
    ds_read_b64_tr_b16 v[78:79], v7 offset:17696
    s_waitcnt lgkmcnt(8)
    v_mfma_f32_16x16x32_bf16 v[80:83], v[48:51], v[104:107], v[80:83]
    ds_read_b64_tr_b16 v[40:41], v7 offset:25344
    v_mfma_f32_16x16x32_bf16 v[84:87], v[48:51], v[108:111], v[84:87]
    ds_read_b64_tr_b16 v[42:43], v7 offset:25600
    v_mfma_f32_16x16x32_bf16 v[88:91], v[52:55], v[104:107], v[88:91]
    ds_read_b64_tr_b16 v[44:45], v7 offset:25376
    v_mfma_f32_16x16x32_bf16 v[92:95], v[52:55], v[108:111], v[92:95]
    ds_read_b64_tr_b16 v[46:47], v7 offset:25632
    v_mfma_f32_16x16x32_bf16 v[32:35], v[56:59], v[104:107], v[32:35]
    ds_read_b64_tr_b16 v[48:49], v7 offset:25856
    v_mfma_f32_16x16x32_bf16 v[36:39], v[56:59], v[108:111], v[36:39]
    ds_read_b64_tr_b16 v[50:51], v7 offset:26112
    v_mfma_f32_16x16x32_bf16 v[232:235], v[60:63], v[104:107], v[232:235]
    ds_read_b64_tr_b16 v[52:53], v7 offset:25888
    v_mfma_f32_16x16x32_bf16 v[236:239], v[60:63], v[108:111], v[236:239]
    ds_read_b64_tr_b16 v[54:55], v7 offset:26144
    s_waitcnt lgkmcnt(8)
    v_mfma_f32_16x16x32_bf16 v[80:83], v[64:67], v[112:115], v[80:83]
    ds_read_b64_tr_b16 v[56:57], v6 offset:25344
    v_mfma_f32_16x16x32_bf16 v[84:87], v[64:67], v[116:119], v[84:87]
    ds_read_b64_tr_b16 v[58:59], v6 offset:25600
    v_mfma_f32_16x16x32_bf16 v[88:91], v[68:71], v[112:115], v[88:91]
    ds_read_b64_tr_b16 v[60:61], v6 offset:25376
    v_mfma_f32_16x16x32_bf16 v[92:95], v[68:71], v[116:119], v[92:95]
    ds_read_b64_tr_b16 v[62:63], v6 offset:25632
    v_mfma_f32_16x16x32_bf16 v[32:35], v[72:75], v[112:115], v[32:35]
    ds_read_b64_tr_b16 v[64:65], v6 offset:25856
    v_mfma_f32_16x16x32_bf16 v[36:39], v[72:75], v[116:119], v[36:39]
    ds_read_b64_tr_b16 v[66:67], v6 offset:26112
    v_mfma_f32_16x16x32_bf16 v[232:235], v[76:79], v[112:115], v[232:235]
    ds_read_b64_tr_b16 v[68:69], v6 offset:25888
    v_mfma_f32_16x16x32_bf16 v[236:239], v[76:79], v[116:119], v[236:239]
    ds_read_b64_tr_b16 v[70:71], v6 offset:26144
    s_waitcnt vmcnt(4)
    s_barrier
    s_waitcnt lgkmcnt(8)
    v_mfma_f32_16x16x32_bf16 v[32:35], v[40:43], v[120:123], v[32:35]
    ds_read_b64_tr_b16 v[72:73], v2 offset:0
    v_mfma_f32_16x16x32_bf16 v[36:39], v[40:43], v[124:127], v[36:39]
    ds_read_b64_tr_b16 v[74:75], v2 offset:256
    v_mfma_f32_16x16x32_bf16 v[232:235], v[44:47], v[120:123], v[232:235]
    ds_read_b64_tr_b16 v[76:77], v2 offset:32
    v_mfma_f32_16x16x32_bf16 v[236:239], v[44:47], v[124:127], v[236:239]
    ds_read_b64_tr_b16 v[78:79], v2 offset:288
    v_mfma_f32_16x16x32_bf16 v[32:35], v[48:51], v[128:131], v[32:35]
    ds_read_b64_tr_b16 v[40:41], v3 offset:0
    v_mfma_f32_16x16x32_bf16 v[36:39], v[48:51], v[132:135], v[36:39]
    ds_read_b64_tr_b16 v[42:43], v3 offset:256
    v_mfma_f32_16x16x32_bf16 v[232:235], v[52:55], v[128:131], v[232:235]
    ds_read_b64_tr_b16 v[44:45], v3 offset:32
    v_mfma_f32_16x16x32_bf16 v[236:239], v[52:55], v[132:135], v[236:239]
    ds_read_b64_tr_b16 v[46:47], v3 offset:288
    s_waitcnt lgkmcnt(8)
    v_mfma_f32_16x16x32_bf16 v[80:83], v[56:59], v[120:123], v[80:83]
    ds_read_b64_tr_b16 v[48:49], v2 offset:512
    v_mfma_f32_16x16x32_bf16 v[84:87], v[56:59], v[124:127], v[84:87]
    ds_read_b64_tr_b16 v[50:51], v2 offset:768
    v_mfma_f32_16x16x32_bf16 v[88:91], v[60:63], v[120:123], v[88:91]
    ds_read_b64_tr_b16 v[52:53], v2 offset:544
    v_mfma_f32_16x16x32_bf16 v[92:95], v[60:63], v[124:127], v[92:95]
    ds_read_b64_tr_b16 v[54:55], v2 offset:800
    v_mfma_f32_16x16x32_bf16 v[80:83], v[64:67], v[128:131], v[80:83]
    ds_read_b64_tr_b16 v[56:57], v3 offset:512
    v_cvt_pk_bf16_f32 v96, v32, v33
    v_cvt_pk_bf16_f32 v97, v34, v35
    v_mfma_f32_16x16x32_bf16 v[84:87], v[64:67], v[132:135], v[84:87]
    ds_read_b64_tr_b16 v[58:59], v3 offset:768
    v_cvt_pk_bf16_f32 v98, v232, v233
    v_cvt_pk_bf16_f32 v99, v234, v235
    v_mfma_f32_16x16x32_bf16 v[88:91], v[68:71], v[128:131], v[88:91]
    ds_read_b64_tr_b16 v[60:61], v3 offset:544
    v_cvt_pk_bf16_f32 v100, v36, v37
    v_cvt_pk_bf16_f32 v101, v38, v39
    v_mfma_f32_16x16x32_bf16 v[92:95], v[68:71], v[132:135], v[92:95]
    ds_read_b64_tr_b16 v[62:63], v3 offset:800
    v_cvt_pk_bf16_f32 v102, v236, v237
    v_cvt_pk_bf16_f32 v103, v238, v239
    ds_write_b128 v12, v[96:99] offset:0
    ds_write_b128 v12, v[100:103] offset:1024
    s_waitcnt lgkmcnt(10)
    v_mfma_f32_16x16x32_bf16 v[16:19], v[72:75], v[136:139], 0
    ds_read_b64_tr_b16 v[64:65], v2 offset:8448
    v_mfma_f32_16x16x32_bf16 v[20:23], v[72:75], v[140:143], 0
    ds_read_b64_tr_b16 v[66:67], v2 offset:8704
    v_mfma_f32_16x16x32_bf16 v[24:27], v[76:79], v[136:139], 0
    ds_read_b64_tr_b16 v[68:69], v2 offset:8480
    v_mfma_f32_16x16x32_bf16 v[28:31], v[76:79], v[140:143], 0
    ds_read_b64_tr_b16 v[70:71], v2 offset:8736
    v_mfma_f32_16x16x32_bf16 v[32:35], v[40:43], v[136:139], 0
    ds_read_b64_tr_b16 v[72:73], v3 offset:8448
    s_add_u32 s27, s34, s38
    s_add_u32 m0, s69, 67584
    v_mfma_f32_16x16x32_bf16 v[36:39], v[40:43], v[140:143], 0
    ds_read_b64_tr_b16 v[74:75], v3 offset:8704
    v_mfma_f32_16x16x32_bf16 v[232:235], v[44:47], v[136:139], 0
    ds_read_b64_tr_b16 v[76:77], v3 offset:8480
    buffer_load_dwordx4 v4, s[48:51], s27 offen lds
    s_add_u32 m0, m0, 1056
    v_mfma_f32_16x16x32_bf16 v[236:239], v[44:47], v[140:143], 0
    ds_read_b64_tr_b16 v[78:79], v3 offset:8736
    s_waitcnt lgkmcnt(10)
    v_mfma_f32_16x16x32_bf16 v[16:19], v[48:51], v[144:147], v[16:19]
    ds_read_b64_tr_b16 v[40:41], v2 offset:8960
    buffer_load_dwordx4 v5, s[48:51], s27 offen lds
    v_mfma_f32_16x16x32_bf16 v[20:23], v[48:51], v[148:151], v[20:23]
    ds_read_b64_tr_b16 v[42:43], v2 offset:9216
    v_mfma_f32_16x16x32_bf16 v[24:27], v[52:55], v[144:147], v[24:27]
    ds_read_b64_tr_b16 v[44:45], v2 offset:8992
    s_add_u32 s27, s27, 0x20000
    s_add_u32 m0, s69, 76032
    v_mfma_f32_16x16x32_bf16 v[28:31], v[52:55], v[148:151], v[28:31]
    ds_read_b64_tr_b16 v[46:47], v2 offset:9248
    v_mfma_f32_16x16x32_bf16 v[32:35], v[56:59], v[144:147], v[32:35]
    ds_read_b64_tr_b16 v[48:49], v3 offset:8960
    buffer_load_dwordx4 v4, s[48:51], s27 offen lds
    s_add_u32 m0, m0, 1056
    v_mfma_f32_16x16x32_bf16 v[36:39], v[56:59], v[148:151], v[36:39]
    ds_read_b64_tr_b16 v[50:51], v3 offset:9216
    v_mfma_f32_16x16x32_bf16 v[232:235], v[60:63], v[144:147], v[232:235]
    ds_read_b64_tr_b16 v[52:53], v3 offset:8992
    buffer_load_dwordx4 v5, s[48:51], s27 offen lds
    v_mfma_f32_16x16x32_bf16 v[236:239], v[60:63], v[148:151], v[236:239]
    ds_read_b64_tr_b16 v[54:55], v3 offset:9248
    s_waitcnt vmcnt(4)
    s_waitcnt lgkmcnt(15)
    s_barrier
    ds_read_b128 v[96:99], v13 offset:0
    ds_read_b128 v[100:103], v13 offset:1024
    s_waitcnt lgkmcnt(10)
    v_mfma_f32_16x16x32_bf16 v[16:19], v[64:67], v[152:155], v[16:19]
    ds_read_b64_tr_b16 v[56:57], v2 offset:16896
    s_add_u32 s27, s35, s38
    s_add_u32 m0, s69, 84480
    v_mfma_f32_16x16x32_bf16 v[20:23], v[64:67], v[156:159], v[20:23]
    ds_read_b64_tr_b16 v[58:59], v2 offset:17152
    v_mfma_f32_16x16x32_bf16 v[24:27], v[68:71], v[152:155], v[24:27]
    ds_read_b64_tr_b16 v[60:61], v2 offset:16928
    buffer_load_dwordx4 v4, s[48:51], s27 offen lds
    s_add_u32 m0, m0, 1056
    v_mfma_f32_16x16x32_bf16 v[28:31], v[68:71], v[156:159], v[28:31]
    ds_read_b64_tr_b16 v[62:63], v2 offset:17184
    v_mfma_f32_16x16x32_bf16 v[32:35], v[72:75], v[152:155], v[32:35]
    ds_read_b64_tr_b16 v[64:65], v3 offset:16896
    buffer_load_dwordx4 v5, s[48:51], s27 offen lds
    v_mfma_f32_16x16x32_bf16 v[36:39], v[72:75], v[156:159], v[36:39]
    ds_read_b64_tr_b16 v[66:67], v3 offset:17152
    v_mfma_f32_16x16x32_bf16 v[232:235], v[76:79], v[152:155], v[232:235]
    ds_read_b64_tr_b16 v[68:69], v3 offset:16928
    s_add_u32 s27, s27, 0x20000
    s_add_u32 m0, s69, 92928
    v_mfma_f32_16x16x32_bf16 v[236:239], v[76:79], v[156:159], v[236:239]
    ds_read_b64_tr_b16 v[70:71], v3 offset:17184
    s_waitcnt lgkmcnt(10)
    v_mfma_f32_16x16x32_bf16 v[16:19], v[40:43], v[160:163], v[16:19]
    ds_read_b64_tr_b16 v[72:73], v2 offset:17408
    buffer_load_dwordx4 v4, s[48:51], s27 offen lds
    s_add_u32 m0, m0, 1056
    v_mfma_f32_16x16x32_bf16 v[20:23], v[40:43], v[164:167], v[20:23]
    ds_read_b64_tr_b16 v[74:75], v2 offset:17664
    s_waitcnt lgkmcnt(10)
    v_mfma_f32_16x16x32_bf16 v[80:83], v[242:245], v[96:99], v[80:83]
    v_mfma_f32_16x16x32_bf16 v[88:91], v[240:243], v[96:99], v[88:91]
    v_mfma_f32_16x16x32_bf16 v[84:87], v[242:245], v[100:103], v[84:87]
    v_mfma_f32_16x16x32_bf16 v[92:95], v[240:243], v[100:103], v[92:95]
    v_mfma_f32_16x16x32_bf16 v[24:27], v[44:47], v[160:163], v[24:27]
    ds_read_b64_tr_b16 v[76:77], v2 offset:17440
    buffer_load_dwordx4 v5, s[48:51], s27 offen lds
    v_mfma_f32_16x16x32_bf16 v[28:31], v[44:47], v[164:167], v[28:31]
    ds_read_b64_tr_b16 v[78:79], v2 offset:17696
    v_mfma_f32_16x16x32_bf16 v[32:35], v[48:51], v[160:163], v[32:35]
    ds_read_b64_tr_b16 v[40:41], v3 offset:17408
    v_mfma_f32_16x16x32_bf16 v[36:39], v[48:51], v[164:167], v[36:39]
    ds_read_b64_tr_b16 v[42:43], v3 offset:17664
    v_mfma_f32_16x16x32_bf16 v[232:235], v[52:55], v[160:163], v[232:235]
    ds_read_b64_tr_b16 v[44:45], v3 offset:17440
    v_mfma_f32_16x16x32_bf16 v[236:239], v[52:55], v[164:167], v[236:239]
    ds_read_b64_tr_b16 v[46:47], v3 offset:17696
    s_waitcnt lgkmcnt(8)
    v_mfma_f32_16x16x32_bf16 v[16:19], v[56:59], v[168:171], v[16:19]
    ds_read_b64_tr_b16 v[48:49], v2 offset:25344
    v_cvt_pk_bf16_f32 v96, v80, v81
    v_mfma_f32_16x16x32_bf16 v[20:23], v[56:59], v[172:175], v[20:23]
    ds_read_b64_tr_b16 v[50:51], v2 offset:25600
    v_cvt_pk_bf16_f32 v97, v82, v83
    v_mfma_f32_16x16x32_bf16 v[24:27], v[60:63], v[168:171], v[24:27]
    ds_read_b64_tr_b16 v[52:53], v2 offset:25376
    v_cvt_pk_bf16_f32 v98, v88, v89
    v_mfma_f32_16x16x32_bf16 v[28:31], v[60:63], v[172:175], v[28:31]
    ds_read_b64_tr_b16 v[54:55], v2 offset:25632
    v_cvt_pk_bf16_f32 v99, v90, v91
    v_mfma_f32_16x16x32_bf16 v[32:35], v[64:67], v[168:171], v[32:35]
    ds_read_b64_tr_b16 v[56:57], v3 offset:25344
    v_cvt_pk_bf16_f32 v100, v84, v85
    v_mfma_f32_16x16x32_bf16 v[36:39], v[64:67], v[172:175], v[36:39]
    ds_read_b64_tr_b16 v[58:59], v3 offset:25600
    v_cvt_pk_bf16_f32 v101, v86, v87
    buffer_store_dwordx4 v[96:99], v14, s[20:23], s45 offen offset:0 sc1
    v_mfma_f32_16x16x32_bf16 v[232:235], v[68:71], v[168:171], v[232:235]
    ds_read_b64_tr_b16 v[60:61], v3 offset:25376
    v_cvt_pk_bf16_f32 v102, v92, v93
    v_mfma_f32_16x16x32_bf16 v[236:239], v[68:71], v[172:175], v[236:239]
    ds_read_b64_tr_b16 v[62:63], v3 offset:25632
    v_cvt_pk_bf16_f32 v103, v94, v95
    s_waitcnt lgkmcnt(8)
    v_mfma_f32_16x16x32_bf16 v[16:19], v[72:75], v[176:179], v[16:19]
    ds_read_b64_tr_b16 v[64:65], v2 offset:25856
    v_mfma_f32_16x16x32_bf16 v[20:23], v[72:75], v[180:183], v[20:23]
    ds_read_b64_tr_b16 v[66:67], v2 offset:26112
    buffer_store_dwordx4 v[100:103], v14, s[20:23], s45 offen offset:1024 sc1
    v_mfma_f32_16x16x32_bf16 v[24:27], v[76:79], v[176:179], v[24:27]
    ds_read_b64_tr_b16 v[68:69], v2 offset:25888
    v_mfma_f32_16x16x32_bf16 v[28:31], v[76:79], v[180:183], v[28:31]
    ds_read_b64_tr_b16 v[70:71], v2 offset:26144
    v_mfma_f32_16x16x32_bf16 v[32:35], v[40:43], v[176:179], v[32:35]
    ds_read_b64_tr_b16 v[72:73], v3 offset:25856
    v_mfma_f32_16x16x32_bf16 v[36:39], v[40:43], v[180:183], v[36:39]
    ds_read_b64_tr_b16 v[74:75], v3 offset:26112
    v_mfma_f32_16x16x32_bf16 v[232:235], v[44:47], v[176:179], v[232:235]
    ds_read_b64_tr_b16 v[76:77], v3 offset:25888
    v_mfma_f32_16x16x32_bf16 v[236:239], v[44:47], v[180:183], v[236:239]
    ds_read_b64_tr_b16 v[78:79], v3 offset:26144
    s_waitcnt vmcnt(6)
    s_barrier
    s_waitcnt lgkmcnt(8)
    v_mfma_f32_16x16x32_bf16 v[16:19], v[48:51], v[184:187], v[16:19]
    ds_read_b64_tr_b16 v[40:41], v6 offset:0
    s_add_u32 s27, s32, s39
    s_add_u32 m0, s69, 0
    v_mfma_f32_16x16x32_bf16 v[20:23], v[48:51], v[188:191], v[20:23]
    ds_read_b64_tr_b16 v[42:43], v6 offset:256
    v_mfma_f32_16x16x32_bf16 v[24:27], v[52:55], v[184:187], v[24:27]
    ds_read_b64_tr_b16 v[44:45], v6 offset:32
    buffer_load_dwordx4 v4, s[48:51], s27 offen lds
    s_add_u32 m0, m0, 1056
    v_mfma_f32_16x16x32_bf16 v[28:31], v[52:55], v[188:191], v[28:31]
    ds_read_b64_tr_b16 v[46:47], v6 offset:288
    v_mfma_f32_16x16x32_bf16 v[32:35], v[56:59], v[184:187], v[32:35]
    ds_read_b64_tr_b16 v[48:49], v7 offset:0
    buffer_load_dwordx4 v5, s[48:51], s27 offen lds
    v_mfma_f32_16x16x32_bf16 v[36:39], v[56:59], v[188:191], v[36:39]
    ds_read_b64_tr_b16 v[50:51], v7 offset:256
    v_mfma_f32_16x16x32_bf16 v[232:235], v[60:63], v[184:187], v[232:235]
    ds_read_b64_tr_b16 v[52:53], v7 offset:32
    s_add_u32 s27, s27, 0x20000
    s_add_u32 m0, s69, 8448
    v_mfma_f32_16x16x32_bf16 v[236:239], v[60:63], v[188:191], v[236:239]
    ds_read_b64_tr_b16 v[54:55], v7 offset:288
    s_waitcnt lgkmcnt(8)
    v_mfma_f32_16x16x32_bf16 v[16:19], v[64:67], v[192:195], v[16:19]
    ds_read_b64_tr_b16 v[56:57], v6 offset:512
    buffer_load_dwordx4 v4, s[48:51], s27 offen lds
    s_add_u32 m0, m0, 1056
    v_mfma_f32_16x16x32_bf16 v[20:23], v[64:67], v[196:199], v[20:23]
    ds_read_b64_tr_b16 v[58:59], v6 offset:768
    v_mfma_f32_16x16x32_bf16 v[24:27], v[68:71], v[192:195], v[24:27]
    ds_read_b64_tr_b16 v[60:61], v6 offset:544
    buffer_load_dwordx4 v5, s[48:51], s27 offen lds
    v_mfma_f32_16x16x32_bf16 v[28:31], v[68:71], v[196:199], v[28:31]
    ds_read_b64_tr_b16 v[62:63], v6 offset:800
    v_mfma_f32_16x16x32_bf16 v[32:35], v[72:75], v[192:195], v[32:35]
    ds_read_b64_tr_b16 v[64:65], v7 offset:512
    v_mfma_f32_16x16x32_bf16 v[36:39], v[72:75], v[196:199], v[36:39]
    ds_read_b64_tr_b16 v[66:67], v7 offset:768
    v_mfma_f32_16x16x32_bf16 v[232:235], v[76:79], v[192:195], v[232:235]
    ds_read_b64_tr_b16 v[68:69], v7 offset:544
    v_mfma_f32_16x16x32_bf16 v[236:239], v[76:79], v[196:199], v[236:239]
    ds_read_b64_tr_b16 v[70:71], v7 offset:800
    s_waitcnt lgkmcnt(8)
    v_mfma_f32_16x16x32_bf16 v[16:19], v[40:43], v[200:203], v[16:19]
    ds_read_b64_tr_b16 v[72:73], v6 offset:8448
    v_mfma_f32_16x16x32_bf16 v[20:23], v[40:43], v[204:207], v[20:23]
    ds_read_b64_tr_b16 v[74:75], v6 offset:8704
    v_mfma_f32_16x16x32_bf16 v[24:27], v[44:47], v[200:203], v[24:27]
    ds_read_b64_tr_b16 v[76:77], v6 offset:8480
    v_mfma_f32_16x16x32_bf16 v[28:31], v[44:47], v[204:207], v[28:31]
    ds_read_b64_tr_b16 v[78:79], v6 offset:8736
    v_mfma_f32_16x16x32_bf16 v[32:35], v[48:51], v[200:203], v[32:35]
    ds_read_b64_tr_b16 v[40:41], v7 offset:8448
    v_mfma_f32_16x16x32_bf16 v[36:39], v[48:51], v[204:207], v[36:39]
    ds_read_b64_tr_b16 v[42:43], v7 offset:8704
    v_mfma_f32_16x16x32_bf16 v[232:235], v[52:55], v[200:203], v[232:235]
    ds_read_b64_tr_b16 v[44:45], v7 offset:8480
    v_mfma_f32_16x16x32_bf16 v[236:239], v[52:55], v[204:207], v[236:239]
    ds_read_b64_tr_b16 v[46:47], v7 offset:8736
    s_waitcnt lgkmcnt(8)
    v_mfma_f32_16x16x32_bf16 v[16:19], v[56:59], v[208:211], v[16:19]
    ds_read_b64_tr_b16 v[48:49], v6 offset:8960
    v_mfma_f32_16x16x32_bf16 v[20:23], v[56:59], v[212:215], v[20:23]
    ds_read_b64_tr_b16 v[50:51], v6 offset:9216
    v_mfma_f32_16x16x32_bf16 v[24:27], v[60:63], v[208:211], v[24:27]
    ds_read_b64_tr_b16 v[52:53], v6 offset:8992
    v_mfma_f32_16x16x32_bf16 v[28:31], v[60:63], v[212:215], v[28:31]
    ds_read_b64_tr_b16 v[54:55], v6 offset:9248
    v_mfma_f32_16x16x32_bf16 v[32:35], v[64:67], v[208:211], v[32:35]
    ds_read_b64_tr_b16 v[56:57], v7 offset:8960
    v_mfma_f32_16x16x32_bf16 v[36:39], v[64:67], v[212:215], v[36:39]
    ds_read_b64_tr_b16 v[58:59], v7 offset:9216
    v_mfma_f32_16x16x32_bf16 v[232:235], v[68:71], v[208:211], v[232:235]
    ds_read_b64_tr_b16 v[60:61], v7 offset:8992
    v_mfma_f32_16x16x32_bf16 v[236:239], v[68:71], v[212:215], v[236:239]
    ds_read_b64_tr_b16 v[62:63], v7 offset:9248
    s_waitcnt vmcnt(4)
    s_barrier
    s_cmp_lg_u32 s24, 0
    s_cbranch_scc1 L_nf1
    s_mov_b64 exec, 0xffff
    buffer_store_dwordx2 v[8:9], v15, s[20:23], s9 offen sc1
    s_mov_b64 exec, -1
L_nf1:
    s_waitcnt lgkmcnt(8)
    v_mfma_f32_16x16x32_bf16 v[16:19], v[72:75], v[216:219], v[16:19]
    ds_read_b64_tr_b16 v[64:65], v6 offset:16896
    s_add_u32 s27, s33, s39
    s_add_u32 m0, s69, 16896
    v_mfma_f32_16x16x32_bf16 v[20:23], v[72:75], v[220:223], v[20:23]
    ds_read_b64_tr_b16 v[66:67], v6 offset:17152
    v_mfma_f32_16x16x32_bf16 v[24:27], v[76:79], v[216:219], v[24:27]
    ds_read_b64_tr_b16 v[68:69], v6 offset:16928
    buffer_load_dwordx4 v4, s[48:51], s27 offen lds
    s_add_u32 m0, m0, 1056
    v_mfma_f32_16x16x32_bf16 v[28:31], v[76:79], v[220:223], v[28:31]
    ds_read_b64_tr_b16 v[70:71], v6 offset:17184
    v_mfma_f32_16x16x32_bf16 v[32:35], v[40:43], v[216:219], v[32:35]
    ds_read_b64_tr_b16 v[72:73], v7 offset:16896
    buffer_load_dwordx4 v5, s[48:51], s27 offen lds
    v_mfma_f32_16x16x32_bf16 v[36:39], v[40:43], v[220:223], v[36:39]
    ds_read_b64_tr_b16 v[74:75], v7 offset:17152
    v_mfma_f32_16x16x32_bf16 v[232:235], v[44:47], v[216:219], v[232:235]
    ds_read_b64_tr_b16 v[76:77], v7 offset:16928
    s_add_u32 s27, s27, 0x20000
    s_add_u32 m0, s69, 25344
    v_mfma_f32_16x16x32_bf16 v[236:239], v[44:47], v[220:223], v[236:239]
    ds_read_b64_tr_b16 v[78:79], v7 offset:17184
    s_waitcnt lgkmcnt(8)
    v_mfma_f32_16x16x32_bf16 v[16:19], v[48:51], v[224:227], v[16:19]
    ds_read_b64_tr_b16 v[40:41], v6 offset:17408
    buffer_load_dwordx4 v4, s[48:51], s27 offen lds
    s_add_u32 m0, m0, 1056
    v_mfma_f32_16x16x32_bf16 v[20:23], v[48:51], v[228:231], v[20:23]
    ds_read_b64_tr_b16 v[42:43], v6 offset:17664
    v_mfma_f32_16x16x32_bf16 v[24:27], v[52:55], v[224:227], v[24:27]
    ds_read_b64_tr_b16 v[44:45], v6 offset:17440
    buffer_load_dwordx4 v5, s[48:51], s27 offen lds
    v_mfma_f32_16x16x32_bf16 v[28:31], v[52:55], v[228:231], v[28:31]
    ds_read_b64_tr_b16 v[46:47], v6 offset:17696
    v_mfma_f32_16x16x32_bf16 v[32:35], v[56:59], v[224:227], v[32:35]
    ds_read_b64_tr_b16 v[48:49], v7 offset:17408
    v_mfma_f32_16x16x32_bf16 v[36:39], v[56:59], v[228:231], v[36:39]
    ds_read_b64_tr_b16 v[50:51], v7 offset:17664
    v_mfma_f32_16x16x32_bf16 v[232:235], v[60:63], v[224:227], v[232:235]
    ds_read_b64_tr_b16 v[52:53], v7 offset:17440
    v_mfma_f32_16x16x32_bf16 v[236:239], v[60:63], v[228:231], v[236:239]
    ds_read_b64_tr_b16 v[54:55], v7 offset:17696
    s_waitcnt lgkmcnt(8)
    v_mfma_f32_16x16x32_bf16 v[16:19], v[64:67], v[104:107], v[16:19]
    ds_read_b64_tr_b16 v[56:57], v7 offset:25344
    v_mfma_f32_16x16x32_bf16 v[20:23], v[64:67], v[108:111], v[20:23]
    ds_read_b64_tr_b16 v[58:59], v7 offset:25600
    v_mfma_f32_16x16x32_bf16 v[24:27], v[68:71], v[104:107], v[24:27]
    ds_read_b64_tr_b16 v[60:61], v7 offset:25376
    v_mfma_f32_16x16x32_bf16 v[28:31], v[68:71], v[108:111], v[28:31]
    ds_read_b64_tr_b16 v[62:63], v7 offset:25632
    v_mfma_f32_16x16x32_bf16 v[32:35], v[72:75], v[104:107], v[32:35]
    ds_read_b64_tr_b16 v[64:65], v7 offset:25856
    v_mfma_f32_16x16x32_bf16 v[36:39], v[72:75], v[108:111], v[36:39]
    ds_read_b64_tr_b16 v[66:67], v7 offset:26112
    v_mfma_f32_16x16x32_bf16 v[232:235], v[76:79], v[104:107], v[232:235]
    ds_read_b64_tr_b16 v[68:69], v7 offset:25888
    v_mfma_f32_16x16x32_bf16 v[236:239], v[76:79], v[108:111], v[236:239]
    ds_read_b64_tr_b16 v[70:71], v7 offset:26144
    s_waitcnt lgkmcnt(8)
    v_mfma_f32_16x16x32_bf16 v[16:19], v[40:43], v[112:115], v[16:19]
    ds_read_b64_tr_b16 v[72:73], v6 offset:25344
    v_mfma_f32_16x16x32_bf16 v[20:23], v[40:43], v[116:119], v[20:23]
    ds_read_b64_tr_b16 v[74:75], v6 offset:25600
    v_mfma_f32_16x16x32_bf16 v[24:27], v[44:47], v[112:115], v[24:27]
    ds_read_b64_tr_b16 v[76:77], v6 offset:25376
    v_mfma_f32_16x16x32_bf16 v[28:31], v[44:47], v[116:119], v[28:31]
    ds_read_b64_tr_b16 v[78:79], v6 offset:25632
    v_mfma_f32_16x16x32_bf16 v[32:35], v[48:51], v[112:115], v[32:35]
    ds_read_b64_tr_b16 v[40:41], v6 offset:25856
    v_mfma_f32_16x16x32_bf16 v[36:39], v[48:51], v[116:119], v[36:39]
    ds_read_b64_tr_b16 v[42:43], v6 offset:26112
    v_mfma_f32_16x16x32_bf16 v[232:235], v[52:55], v[112:115], v[232:235]
    ds_read_b64_tr_b16 v[44:45], v6 offset:25888
    v_mfma_f32_16x16x32_bf16 v[236:239], v[52:55], v[116:119], v[236:239]
    ds_read_b64_tr_b16 v[46:47], v6 offset:26144
    s_waitcnt vmcnt(4)
    s_barrier
    s_waitcnt lgkmcnt(8)
    v_mfma_f32_16x16x32_bf16 v[32:35], v[56:59], v[120:123], v[32:35]
    ds_read_b64_tr_b16 v[48:49], v2 offset:0
    v_mfma_f32_16x16x32_bf16 v[36:39], v[56:59], v[124:127], v[36:39]
    ds_read_b64_tr_b16 v[50:51], v2 offset:256
    v_mfma_f32_16x16x32_bf16 v[232:235], v[60:63], v[120:123], v[232:235]
    ds_read_b64_tr_b16 v[52:53], v2 offset:32
    v_mfma_f32_16x16x32_bf16 v[236:239], v[60:63], v[124:127], v[236:239]
    ds_read_b64_tr_b16 v[54:55], v2 offset:288
    v_mfma_f32_16x16x32_bf16 v[32:35], v[64:67], v[128:131], v[32:35]
    ds_read_b64_tr_b16 v[56:57], v3 offset:0
    v_mfma_f32_16x16x32_bf16 v[36:39], v[64:67], v[132:135], v[36:39]
    ds_read_b64_tr_b16 v[58:59], v3 offset:256
    v_mfma_f32_16x16x32_bf16 v[232:235], v[68:71], v[128:131], v[232:235]
    ds_read_b64_tr_b16 v[60:61], v3 offset:32
    v_mfma_f32_16x16x32_bf16 v[236:239], v[68:71], v[132:135], v[236:239]
    ds_read_b64_tr_b16 v[62:63], v3 offset:288
    s_waitcnt lgkmcnt(8)
    v_mfma_f32_16x16x32_bf16 v[16:19], v[72:75], v[120:123], v[16:19]
    ds_read_b64_tr_b16 v[64:65], v2 offset:512
    v_mfma_f32_16x16x32_bf16 v[20:23], v[72:75], v[124:127], v[20:23]
    ds_read_b64_tr_b16 v[66:67], v2 offset:768
    v_mfma_f32_16x16x32_bf16 v[24:27], v[76:79], v[120:123], v[24:27]
    ds_read_b64_tr_b16 v[68:69], v2 offset:544
    v_mfma_f32_16x16x32_bf16 v[28:31], v[76:79], v[124:127], v[28:31]
    ds_read_b64_tr_b16 v[70:71], v2 offset:800
    v_mfma_f32_16x16x32_bf16 v[16:19], v[40:43], v[128:131], v[16:19]
    ds_read_b64_tr_b16 v[72:73], v3 offset:512
    v_cvt_pk_bf16_f32 v96, v32, v33
    v_cvt_pk_bf16_f32 v97, v34, v35
    v_mfma_f32_16x16x32_bf16 v[20:23], v[40:43], v[132:135], v[20:23]
    ds_read_b64_tr_b16 v[74:75], v3 offset:768
    v_cvt_pk_bf16_f32 v98, v232, v233
    v_cvt_pk_bf16_f32 v99, v234, v235
    v_mfma_f32_16x16x32_bf16 v[24:27], v[44:47], v[128:131], v[24:27]
    ds_read_b64_tr_b16 v[76:77], v3 offset:544
    v_cvt_pk_bf16_f32 v100, v36, v37
    v_cvt_pk_bf16_f32 v101, v38, v39
    v_mfma_f32_16x16x32_bf16 v[28:31], v[44:47], v[132:135], v[28:31]
    ds_read_b64_tr_b16 v[78:79], v3 offset:800
    v_cvt_pk_bf16_f32 v102, v236, v237
    v_cvt_pk_bf16_f32 v103, v238, v239
    ds_write_b128 v12, v[96:99] offset:0
    ds_write_b128 v12, v[100:103] offset:1024
    s_waitcnt lgkmcnt(10)
    v_mfma_f32_16x16x32_bf16 v[80:83], v[48:51], v[136:139], 0
    ds_read_b64_tr_b16 v[40:41], v2 offset:8448
    v_mfma_f32_16x16x32_bf16 v[84:87], v[48:51], v[140:143], 0
    ds_read_b64_tr_b16 v[42:43], v2 offset:8704
    v_mfma_f32_16x16x32_bf16 v[88:91], v[52:55], v[136:139], 0
    ds_read_b64_tr_b16 v[44:45], v2 offset:8480
    v_mfma_f32_16x16x32_bf16 v[92:95], v[52:55], v[140:143], 0
    ds_read_b64_tr_b16 v[46:47], v2 offset:8736
    v_mfma_f32_16x16x32_bf16 v[32:35], v[56:59], v[136:139], 0
    ds_read_b64_tr_b16 v[48:49], v3 offset:8448
    s_add_u32 s27, s34, s39
    s_add_u32 m0, s69, 67584
    v_mfma_f32_16x16x32_bf16 v[36:39], v[56:59], v[140:143], 0
    ds_read_b64_tr_b16 v[50:51], v3 offset:8704
    v_mfma_f32_16x16x32_bf16 v[232:235], v[60:63], v[136:139], 0
    ds_read_b64_tr_b16 v[52:53], v3 offset:8480
    buffer_load_dwordx4 v4, s[48:51], s27 offen lds
    s_add_u32 m0, m0, 1056
    v_mfma_f32_16x16x32_bf16 v[236:239], v[60:63], v[140:143], 0
    ds_read_b64_tr_b16 v[54:55], v3 offset:8736
    s_waitcnt lgkmcnt(10)
    v_mfma_f32_16x16x32_bf16 v[80:83], v[64:67], v[144:147], v[80:83]
    ds_read_b64_tr_b16 v[56:57], v2 offset:8960
    buffer_load_dwordx4 v5, s[48:51], s27 offen lds
    v_mfma_f32_16x16x32_bf16 v[84:87], v[64:67], v[148:151], v[84:87]
    ds_read_b64_tr_b16 v[58:59], v2 offset:9216
    v_mfma_f32_16x16x32_bf16 v[88:91], v[68:71], v[144:147], v[88:91]
    ds_read_b64_tr_b16 v[60:61], v2 offset:8992
    s_add_u32 s27, s27, 0x20000
    s_add_u32 m0, s69, 76032
    v_mfma_f32_16x16x32_bf16 v[92:95], v[68:71], v[148:151], v[92:95]
    ds_read_b64_tr_b16 v[62:63], v2 offset:9248
    v_mfma_f32_16x16x32_bf16 v[32:35], v[72:75], v[144:147], v[32:35]
    ds_read_b64_tr_b16 v[64:65], v3 offset:8960
    buffer_load_dwordx4 v4, s[48:51], s27 offen lds
    s_add_u32 m0, m0, 1056
    v_mfma_f32_16x16x32_bf16 v[36:39], v[72:75], v[148:151], v[36:39]
    ds_read_b64_tr_b16 v[66:67], v3 offset:9216
    v_mfma_f32_16x16x32_bf16 v[232:235], v[76:79], v[144:147], v[232:235]
    ds_read_b64_tr_b16 v[68:69], v3 offset:8992
    buffer_load_dwordx4 v5, s[48:51], s27 offen lds
    v_mfma_f32_16x16x32_bf16 v[236:239], v[76:79], v[148:151], v[236:239]
    ds_read_b64_tr_b16 v[70:71], v3 offset:9248
    s_waitcnt vmcnt(4)
    s_waitcnt lgkmcnt(15)
    s_barrier
    ds_read_b128 v[96:99], v13 offset:0
    ds_read_b128 v[100:103], v13 offset:1024
    s_waitcnt lgkmcnt(10)
    v_mfma_f32_16x16x32_bf16 v[80:83], v[40:43], v[152:155], v[80:83]
    ds_read_b64_tr_b16 v[72:73], v2 offset:16896
    s_add_u32 s27, s35, s39
    s_add_u32 m0, s69, 84480
    v_mfma_f32_16x16x32_bf16 v[84:87], v[40:43], v[156:159], v[84:87]
    ds_read_b64_tr_b16 v[74:75], v2 offset:17152
    buffer_load_dwordx2 v[248:249], v10, s[20:23], 0 offen sc1
    v_mfma_f32_16x16x32_bf16 v[88:91], v[44:47], v[152:155], v[88:91]
    ds_read_b64_tr_b16 v[76:77], v2 offset:16928
    buffer_load_dwordx4 v4, s[48:51], s27 offen lds
    s_add_u32 m0, m0, 1056
    v_mfma_f32_16x16x32_bf16 v[92:95], v[44:47], v[156:159], v[92:95]
    ds_read_b64_tr_b16 v[78:79], v2 offset:17184
    v_mfma_f32_16x16x32_bf16 v[32:35], v[48:51], v[152:155], v[32:35]
    ds_read_b64_tr_b16 v[40:41], v3 offset:16896
    buffer_load_dwordx4 v5, s[48:51], s27 offen lds
    v_mfma_f32_16x16x32_bf16 v[36:39], v[48:51], v[156:159], v[36:39]
    ds_read_b64_tr_b16 v[42:43], v3 offset:17152
    v_mfma_f32_16x16x32_bf16 v[232:235], v[52:55], v[152:155], v[232:235]
    ds_read_b64_tr_b16 v[44:45], v3 offset:16928
    s_add_u32 s27, s27, 0x20000
    s_add_u32 m0, s69, 92928
    v_mfma_f32_16x16x32_bf16 v[236:239], v[52:55], v[156:159], v[236:239]
    ds_read_b64_tr_b16 v[46:47], v3 offset:17184
    s_waitcnt lgkmcnt(10)
    v_mfma_f32_16x16x32_bf16 v[80:83], v[56:59], v[160:163], v[80:83]
    ds_read_b64_tr_b16 v[48:49], v2 offset:17408
    buffer_load_dwordx4 v4, s[48:51], s27 offen lds
    s_add_u32 m0, m0, 1056
    v_mfma_f32_16x16x32_bf16 v[84:87], v[56:59], v[164:167], v[84:87]
    ds_read_b64_tr_b16 v[50:51], v2 offset:17664
    s_waitcnt lgkmcnt(10)
    v_mfma_f32_16x16x32_bf16 v[16:19], v[242:245], v[96:99], v[16:19]
    v_mfma_f32_16x16x32_bf16 v[24:27], v[240:243], v[96:99], v[24:27]
    v_mfma_f32_16x16x32_bf16 v[20:23], v[242:245], v[100:103], v[20:23]
    v_mfma_f32_16x16x32_bf16 v[28:31], v[240:243], v[100:103], v[28:31]
    v_mfma_f32_16x16x32_bf16 v[88:91], v[60:63], v[160:163], v[88:91]
    ds_read_b64_tr_b16 v[52:53], v2 offset:17440
    buffer_load_dwordx4 v5, s[48:51], s27 offen lds
    v_mfma_f32_16x16x32_bf16 v[92:95], v[60:63], v[164:167], v[92:95]
    ds_read_b64_tr_b16 v[54:55], v2 offset:17696
    v_mfma_f32_16x16x32_bf16 v[32:35], v[64:67], v[160:163], v[32:35]
    ds_read_b64_tr_b16 v[56:57], v3 offset:17408
    v_mfma_f32_16x16x32_bf16 v[36:39], v[64:67], v[164:167], v[36:39]
    ds_read_b64_tr_b16 v[58:59], v3 offset:17664
    v_mfma_f32_16x16x32_bf16 v[232:235], v[68:71], v[160:163], v[232:235]
    ds_read_b64_tr_b16 v[60:61], v3 offset:17440
    v_mfma_f32_16x16x32_bf16 v[236:239], v[68:71], v[164:167], v[236:239]
    ds_read_b64_tr_b16 v[62:63], v3 offset:17696
    s_waitcnt lgkmcnt(8)
    v_mfma_f32_16x16x32_bf16 v[80:83], v[72:75], v[168:171], v[80:83]
    ds_read_b64_tr_b16 v[64:65], v2 offset:25344
    v_cvt_pk_bf16_f32 v96, v16, v17
    v_mfma_f32_16x16x32_bf16 v[84:87], v[72:75], v[172:175], v[84:87]
    ds_read_b64_tr_b16 v[66:67], v2 offset:25600
    v_cvt_pk_bf16_f32 v97, v18, v19
    v_mfma_f32_16x16x32_bf16 v[88:91], v[76:79], v[168:171], v[88:91]
    ds_read_b64_tr_b16 v[68:69], v2 offset:25376
    v_cvt_pk_bf16_f32 v98, v24, v25
    v_mfma_f32_16x16x32_bf16 v[92:95], v[76:79], v[172:175], v[92:95]
    ds_read_b64_tr_b16 v[70:71], v2 offset:25632
    v_cvt_pk_bf16_f32 v99, v26, v27
    v_mfma_f32_16x16x32_bf16 v[32:35], v[40:43], v[168:171], v[32:35]
    ds_read_b64_tr_b16 v[72:73], v3 offset:25344
    v_cvt_pk_bf16_f32 v100, v20, v21
    v_mfma_f32_16x16x32_bf16 v[36:39], v[40:43], v[172:175], v[36:39]
    ds_read_b64_tr_b16 v[74:75], v3 offset:25600
    v_cvt_pk_bf16_f32 v101, v22, v23
    buffer_store_dwordx4 v[96:99], v14, s[20:23], s46 offen offset:0 sc1
    v_mfma_f32_16x16x32_bf16 v[232:235], v[44:47], v[168:171], v[232:235]
    ds_read_b64_tr_b16 v[76:77], v3 offset:25376
    v_cvt_pk_bf16_f32 v102, v28, v29
    v_mfma_f32_16x16x32_bf16 v[236:239], v[44:47], v[172:175], v[236:239]
    ds_read_b64_tr_b16 v[78:79], v3 offset:25632
    v_cvt_pk_bf16_f32 v103, v30, v31
    s_waitcnt lgkmcnt(8)
    v_mfma_f32_16x16x32_bf16 v[80:83], v[48:51], v[176:179], v[80:83]
    ds_read_b64_tr_b16 v[40:41], v2 offset:25856
    v_mfma_f32_16x16x32_bf16 v[84:87], v[48:51], v[180:183], v[84:87]
    ds_read_b64_tr_b16 v[42:43], v2 offset:26112
    buffer_store_dwordx4 v[100:103], v14, s[20:23], s46 offen offset:1024 sc1
    v_mfma_f32_16x16x32_bf16 v[88:91], v[52:55], v[176:179], v[88:91]
    ds_read_b64_tr_b16 v[44:45], v2 offset:25888
    v_mfma_f32_16x16x32_bf16 v[92:95], v[52:55], v[180:183], v[92:95]
    ds_read_b64_tr_b16 v[46:47], v2 offset:26144
    v_mfma_f32_16x16x32_bf16 v[32:35], v[56:59], v[176:179], v[32:35]
    ds_read_b64_tr_b16 v[48:49], v3 offset:25856
    v_mfma_f32_16x16x32_bf16 v[36:39], v[56:59], v[180:183], v[36:39]
    ds_read_b64_tr_b16 v[50:51], v3 offset:26112
    v_mfma_f32_16x16x32_bf16 v[232:235], v[60:63], v[176:179], v[232:235]
    ds_read_b64_tr_b16 v[52:53], v3 offset:25888
    v_mfma_f32_16x16x32_bf16 v[236:239], v[60:63], v[180:183], v[236:239]
    ds_read_b64_tr_b16 v[54:55], v3 offset:26144
    s_waitcnt vmcnt(6)
    s_barrier
    v_cmp_ne_u64 vcc, s[98:99], v[248:249]
    s_and_b32 s101, vcc_lo, 3
    s_waitcnt lgkmcnt(8)
    v_mfma_f32_16x16x32_bf16 v[80:83], v[64:67], v[184:187], v[80:83]
    ds_read_b64_tr_b16 v[56:57], v6 offset:0
    v_mfma_f32_16x16x32_bf16 v[84:87], v[64:67], v[188:191], v[84:87]
    ds_read_b64_tr_b16 v[58:59], v6 offset:256
    v_mfma_f32_16x16x32_bf16 v[88:91], v[68:71], v[184:187], v[88:91]
    ds_read_b64_tr_b16 v[60:61], v6 offset:32
    v_mfma_f32_16x16x32_bf16 v[92:95], v[68:71], v[188:191], v[92:95]
    ds_read_b64_tr_b16 v[62:63], v6 offset:288
    s_add_u32 s27, s64, 0
    buffer_load_dwordx4 v[136:139], v14, s[20:23], s27 offen offset:0 sc1
    buffer_load_dwordx4 v[140:143], v14, s[20:23], s27 offen offset:1024 sc1
    v_mfma_f32_16x16x32_bf16 v[32:35], v[72:75], v[184:187], v[32:35]
    ds_read_b64_tr_b16 v[64:65], v7 offset:0
    v_mfma_f32_16x16x32_bf16 v[36:39], v[72:75], v[188:191], v[36:39]
    ds_read_b64_tr_b16 v[66:67], v7 offset:256
    v_mfma_f32_16x16x32_bf16 v[232:235], v[76:79], v[184:187], v[232:235]
    ds_read_b64_tr_b16 v[68:69], v7 offset:32
    v_mfma_f32_16x16x32_bf16 v[236:239], v[76:79], v[188:191], v[236:239]
    ds_read_b64_tr_b16 v[70:71], v7 offset:288
    s_waitcnt lgkmcnt(8)
    v_mfma_f32_16x16x32_bf16 v[80:83], v[40:43], v[192:195], v[80:83]
    ds_read_b64_tr_b16 v[72:73], v6 offset:512
    v_mfma_f32_16x16x32_bf16 v[84:87], v[40:43], v[196:199], v[84:87]
    ds_read_b64_tr_b16 v[74:75], v6 offset:768
    s_add_u32 s27, s64, 16384
    buffer_load_dwordx4 v[144:147], v14, s[20:23], s27 offen offset:0 sc1
    buffer_load_dwordx4 v[148:151], v14, s[20:23], s27 offen offset:1024 sc1
    v_mfma_f32_16x16x32_bf16 v[88:91], v[44:47], v[192:195], v[88:91]
    ds_read_b64_tr_b16 v[76:77], v6 offset:544
    v_mfma_f32_16x16x32_bf16 v[92:95], v[44:47], v[196:199], v[92:95]
    ds_read_b64_tr_b16 v[78:79], v6 offset:800
    v_mfma_f32_16x16x32_bf16 v[32:35], v[48:51], v[192:195], v[32:35]
    ds_read_b64_tr_b16 v[40:41], v7 offset:512
    v_mfma_f32_16x16x32_bf16 v[36:39], v[48:51], v[196:199], v[36:39]
    ds_read_b64_tr_b16 v[42:43], v7 offset:768
    v_mfma_f32_16x16x32_bf16 v[232:235], v[52:55], v[192:195], v[232:235]
    ds_read_b64_tr_b16 v[44:45], v7 offset:544
    v_mfma_f32_16x16x32_bf16 v[236:239], v[52:55], v[196:199], v[236:239]
    ds_read_b64_tr_b16 v[46:47], v7 offset:800
    s_waitcnt lgkmcnt(8)
    v_mfma_f32_16x16x32_bf16 v[80:83], v[56:59], v[200:203], v[80:83]
    ds_read_b64_tr_b16 v[48:49], v6 offset:8448
    v_mfma_f32_16x16x32_bf16 v[84:87], v[56:59], v[204:207], v[84:87]
    ds_read_b64_tr_b16 v[50:51], v6 offset:8704
    v_mfma_f32_16x16x32_bf16 v[88:91], v[60:63], v[200:203], v[88:91]
    ds_read_b64_tr_b16 v[52:53], v6 offset:8480
    v_mfma_f32_16x16x32_bf16 v[92:95], v[60:63], v[204:207], v[92:95]
    ds_read_b64_tr_b16 v[54:55], v6 offset:8736
    v_mfma_f32_16x16x32_bf16 v[32:35], v[64:67], v[200:203], v[32:35]
    ds_read_b64_tr_b16 v[56:57], v7 offset:8448
    v_mfma_f32_16x16x32_bf16 v[36:39], v[64:67], v[204:207], v[36:39]
    ds_read_b64_tr_b16 v[58:59], v7 offset:8704
    v_mfma_f32_16x16x32_bf16 v[232:235], v[68:71], v[200:203], v[232:235]
    ds_read_b64_tr_b16 v[60:61], v7 offset:8480
    v_mfma_f32_16x16x32_bf16 v[236:239], v[68:71], v[204:207], v[236:239]
    ds_read_b64_tr_b16 v[62:63], v7 offset:8736
    s_waitcnt lgkmcnt(8)
    v_mfma_f32_16x16x32_bf16 v[80:83], v[72:75], v[208:211], v[80:83]
    ds_read_b64_tr_b16 v[64:65], v6 offset:8960
    v_mfma_f32_16x16x32_bf16 v[84:87], v[72:75], v[212:215], v[84:87]
    ds_read_b64_tr_b16 v[66:67], v6 offset:9216
    v_mfma_f32_16x16x32_bf16 v[88:91], v[76:79], v[208:211], v[88:91]
    ds_read_b64_tr_b16 v[68:69], v6 offset:8992
    v_mfma_f32_16x16x32_bf16 v[92:95], v[76:79], v[212:215], v[92:95]
    ds_read_b64_tr_b16 v[70:71], v6 offset:9248
    v_mfma_f32_16x16x32_bf16 v[32:35], v[40:43], v[208:211], v[32:35]
    ds_read_b64_tr_b16 v[72:73], v7 offset:8960
    v_mfma_f32_16x16x32_bf16 v[36:39], v[40:43], v[212:215], v[36:39]
    ds_read_b64_tr_b16 v[74:75], v7 offset:9216
    v_mfma_f32_16x16x32_bf16 v[232:235], v[44:47], v[208:211], v[232:235]
    ds_read_b64_tr_b16 v[76:77], v7 offset:8992
    v_mfma_f32_16x16x32_bf16 v[236:239], v[44:47], v[212:215], v[236:239]
    ds_read_b64_tr_b16 v[78:79], v7 offset:9248
    s_waitcnt vmcnt(4)
    s_barrier
    s_cmp_lg_u32 s24, 0
    s_cbranch_scc1 L_nf2
    s_mov_b64 exec, 0xffff
    buffer_store_dwordx2 v[8:9], v15, s[20:23], s10 offen sc1
    s_mov_b64 exec, -1
L_nf2:
    s_waitcnt lgkmcnt(8)
    v_mfma_f32_16x16x32_bf16 v[80:83], v[48:51], v[216:219], v[80:83]
    ds_read_b64_tr_b16 v[40:41], v6 offset:16896
    v_mfma_f32_16x16x32_bf16 v[84:87], v[48:51], v[220:223], v[84:87]
    ds_read_b64_tr_b16 v[42:43], v6 offset:17152
    buffer_load_dwordx2 v[248:249], v10, s[20:23], 0 offen sc1
    v_mfma_f32_16x16x32_bf16 v[88:91], v[52:55], v[216:219], v[88:91]
    ds_read_b64_tr_b16 v[44:45], v6 offset:16928
    v_mfma_f32_16x16x32_bf16 v[92:95], v[52:55], v[220:223], v[92:95]
    ds_read_b64_tr_b16 v[46:47], v6 offset:17184
    v_mfma_f32_16x16x32_bf16 v[32:35], v[56:59], v[216:219], v[32:35]
    ds_read_b64_tr_b16 v[48:49], v7 offset:16896
    v_mfma_f32_16x16x32_bf16 v[36:39], v[56:59], v[220:223], v[36:39]
    ds_read_b64_tr_b16 v[50:51], v7 offset:17152
    v_mfma_f32_16x16x32_bf16 v[232:235], v[60:63], v[216:219], v[232:235]
    ds_read_b64_tr_b16 v[52:53], v7 offset:16928
    v_mfma_f32_16x16x32_bf16 v[236:239], v[60:63], v[220:223], v[236:239]
    ds_read_b64_tr_b16 v[54:55], v7 offset:17184
    s_waitcnt lgkmcnt(8)
    v_mfma_f32_16x16x32_bf16 v[80:83], v[64:67], v[224:227], v[80:83]
    ds_read_b64_tr_b16 v[56:57], v6 offset:17408
    v_mfma_f32_16x16x32_bf16 v[84:87], v[64:67], v[228:231], v[84:87]
    ds_read_b64_tr_b16 v[58:59], v6 offset:17664
    v_mfma_f32_16x16x32_bf16 v[88:91], v[68:71], v[224:227], v[88:91]
    ds_read_b64_tr_b16 v[60:61], v6 offset:17440
    v_mfma_f32_16x16x32_bf16 v[92:95], v[68:71], v[228:231], v[92:95]
    ds_read_b64_tr_b16 v[62:63], v6 offset:17696
    v_mfma_f32_16x16x32_bf16 v[32:35], v[72:75], v[224:227], v[32:35]
    ds_read_b64_tr_b16 v[64:65], v7 offset:17408
    v_mfma_f32_16x16x32_bf16 v[36:39], v[72:75], v[228:231], v[36:39]
    ds_read_b64_tr_b16 v[66:67], v7 offset:17664
    v_mfma_f32_16x16x32_bf16 v[232:235], v[76:79], v[224:227], v[232:235]
    ds_read_b64_tr_b16 v[68:69], v7 offset:17440
    v_mfma_f32_16x16x32_bf16 v[236:239], v[76:79], v[228:231], v[236:239]
    ds_read_b64_tr_b16 v[70:71], v7 offset:17696
    s_waitcnt vmcnt(0)
    v_cmp_ne_u64 vcc, s[98:99], v[248:249]
    s_and_b32 s47, vcc_lo, 4
    s_waitcnt lgkmcnt(8)
    v_mfma_f32_16x16x32_bf16 v[80:83], v[40:43], v[104:107], v[80:83]
    ds_read_b64_tr_b16 v[72:73], v7 offset:25344
    v_mfma_f32_16x16x32_bf16 v[84:87], v[40:43], v[108:111], v[84:87]
    ds_read_b64_tr_b16 v[74:75], v7 offset:25600
    v_mfma_f32_16x16x32_bf16 v[88:91], v[44:47], v[104:107], v[88:91]
    ds_read_b64_tr_b16 v[76:77], v7 offset:25376
    s_add_u32 s27, s64, 32768
    buffer_load_dwordx4 v[152:155], v14, s[20:23], s27 offen offset:0 sc1
    buffer_load_dwordx4 v[156:159], v14, s[20:23], s27 offen offset:1024 sc1
    v_mfma_f32_16x16x32_bf16 v[92:95], v[44:47], v[108:111], v[92:95]
    ds_read_b64_tr_b16 v[78:79], v7 offset:25632
    v_mfma_f32_16x16x32_bf16 v[32:35], v[48:51], v[104:107], v[32:35]
    ds_read_b64_tr_b16 v[40:41], v7 offset:25856
    v_mfma_f32_16x16x32_bf16 v[36:39], v[48:51], v[108:111], v[36:39]
    ds_read_b64_tr_b16 v[42:43], v7 offset:26112
    v_mfma_f32_16x16x32_bf16 v[232:235], v[52:55], v[104:107], v[232:235]
    ds_read_b64_tr_b16 v[44:45], v7 offset:25888
    v_mfma_f32_16x16x32_bf16 v[236:239], v[52:55], v[108:111], v[236:239]
    ds_read_b64_tr_b16 v[46:47], v7 offset:26144
    s_waitcnt lgkmcnt(8)
    v_mfma_f32_16x16x32_bf16 v[80:83], v[56:59], v[112:115], v[80:83]
    ds_read_b64_tr_b16 v[48:49], v6 offset:25344
    v_mfma_f32_16x16x32_bf16 v[84:87], v[56:59], v[116:119], v[84:87]
    ds_read_b64_tr_b16 v[50:51], v6 offset:25600
    v_mfma_f32_16x16x32_bf16 v[88:91], v[60:63], v[112:115], v[88:91]
    ds_read_b64_tr_b16 v[52:53], v6 offset:25376
    v_mfma_f32_16x16x32_bf16 v[92:95], v[60:63], v[116:119], v[92:95]
    ds_read_b64_tr_b16 v[54:55], v6 offset:25632
    v_mfma_f32_16x16x32_bf16 v[32:35], v[64:67], v[112:115], v[32:35]
    ds_read_b64_tr_b16 v[56:57], v6 offset:25856
    v_mfma_f32_16x16x32_bf16 v[36:39], v[64:67], v[116:119], v[36:39]
    ds_read_b64_tr_b16 v[58:59], v6 offset:26112
    v_mfma_f32_16x16x32_bf16 v[232:235], v[68:71], v[112:115], v[232:235]
    ds_read_b64_tr_b16 v[60:61], v6 offset:25888
    v_mfma_f32_16x16x32_bf16 v[236:239], v[68:71], v[116:119], v[236:239]
    ds_read_b64_tr_b16 v[62:63], v6 offset:26144
    s_waitcnt lgkmcnt(8)
    v_mfma_f32_16x16x32_bf16 v[32:35], v[72:75], v[120:123], v[32:35]
    v_mfma_f32_16x16x32_bf16 v[36:39], v[72:75], v[124:127], v[36:39]
    v_mfma_f32_16x16x32_bf16 v[232:235], v[76:79], v[120:123], v[232:235]
    v_mfma_f32_16x16x32_bf16 v[236:239], v[76:79], v[124:127], v[236:239]
    v_mfma_f32_16x16x32_bf16 v[32:35], v[40:43], v[128:131], v[32:35]
    v_mfma_f32_16x16x32_bf16 v[36:39], v[40:43], v[132:135], v[36:39]
    v_mfma_f32_16x16x32_bf16 v[232:235], v[44:47], v[128:131], v[232:235]
    v_mfma_f32_16x16x32_bf16 v[236:239], v[44:47], v[132:135], v[236:239]
    s_waitcnt lgkmcnt(0)
    v_mfma_f32_16x16x32_bf16 v[80:83], v[48:51], v[120:123], v[80:83]
    v_mfma_f32_16x16x32_bf16 v[84:87], v[48:51], v[124:127], v[84:87]
    v_mfma_f32_16x16x32_bf16 v[88:91], v[52:55], v[120:123], v[88:91]
    v_mfma_f32_16x16x32_bf16 v[92:95], v[52:55], v[124:127], v[92:95]
    s_nop 3
    v_mfma_f32_16x16x32_bf16 v[80:83], v[56:59], v[128:131], v[80:83]
    v_cvt_pk_bf16_f32 v96, v32, v33
    v_cvt_pk_bf16_f32 v97, v34, v35
    v_mfma_f32_16x16x32_bf16 v[84:87], v[56:59], v[132:135], v[84:87]
    v_cvt_pk_bf16_f32 v98, v232, v233
    v_cvt_pk_bf16_f32 v99, v234, v235
    v_mfma_f32_16x16x32_bf16 v[88:91], v[60:63], v[128:131], v[88:91]
    v_cvt_pk_bf16_f32 v100, v36, v37
    v_cvt_pk_bf16_f32 v101, v38, v39
    v_mfma_f32_16x16x32_bf16 v[92:95], v[60:63], v[132:135], v[92:95]
    v_cvt_pk_bf16_f32 v102, v236, v237
    v_cvt_pk_bf16_f32 v103, v238, v239
    ds_write_b128 v12, v[96:99] offset:0
    ds_write_b128 v12, v[100:103] offset:1024
    s_or_b32 s27, s101, s47
    s_cbranch_scc0 L_have3
    s_mov_b32 s28, 1048576
L_s2:
    buffer_load_dwordx2 v[248:249], v10, s[20:23], 0 offen sc1
    s_sub_u32 s28, s28, 1
    s_waitcnt vmcnt(0)
    s_cbranch_scc1 L_s2x
    v_cmp_ne_u64 vcc, s[98:99], v[248:249]
    s_and_b32 s27, vcc_lo, 7
    s_cbranch_scc1 L_s2
L_s2x:
    s_cmp_eq_u32 s101, 0
    s_cbranch_scc1 L_have2
    s_add_u32 s27, s64, 0
    buffer_load_dwordx4 v[136:139], v14, s[20:23], s27 offen offset:0 sc1
    buffer_load_dwordx4 v[140:143], v14, s[20:23], s27 offen offset:1024 sc1
    s_add_u32 s27, s64, 16384
    buffer_load_dwordx4 v[144:147], v14, s[20:23], s27 offen offset:0 sc1
    buffer_load_dwordx4 v[148:151], v14, s[20:23], s27 offen offset:1024 sc1
L_have2:
    s_add_u32 s27, s64, 32768
    buffer_load_dwordx4 v[152:155], v14, s[20:23], s27 offen offset:0 sc1
    buffer_load_dwordx4 v[156:159], v14, s[20:23], s27 offen offset:1024 sc1
L_have3:
    s_waitcnt lgkmcnt(0)
    s_barrier
    ds_read_b128 v[96:99], v13 offset:0
    ds_read_b128 v[100:103], v13 offset:1024
    s_waitcnt vmcnt(4)
    v_mfma_f32_16x16x32_bf16 v[80:83], v[242:245], v[136:139], v[80:83]
    v_mfma_f32_16x16x32_bf16 v[88:91], v[240:243], v[136:139], v[88:91]
    v_mfma_f32_16x16x32_bf16 v[84:87], v[242:245], v[140:143], v[84:87]
    v_mfma_f32_16x16x32_bf16 v[92:95], v[240:243], v[140:143], v[92:95]
    s_waitcnt vmcnt(2)
    v_mfma_f32_16x16x32_bf16 v[80:83], v[242:245], v[144:147], v[80:83]
    v_mfma_f32_16x16x32_bf16 v[88:91], v[240:243], v[144:147], v[88:91]
    v_mfma_f32_16x16x32_bf16 v[84:87], v[242:245], v[148:151], v[84:87]
    v_mfma_f32_16x16x32_bf16 v[92:95], v[240:243], v[148:151], v[92:95]
    s_waitcnt vmcnt(0)
    v_mfma_f32_16x16x32_bf16 v[80:83], v[242:245], v[152:155], v[80:83]
    v_mfma_f32_16x16x32_bf16 v[88:91], v[240:243], v[152:155], v[88:91]
    v_mfma_f32_16x16x32_bf16 v[84:87], v[242:245], v[156:159], v[84:87]
    v_mfma_f32_16x16x32_bf16 v[92:95], v[240:243], v[156:159], v[92:95]
    s_waitcnt lgkmcnt(0)
    v_mfma_f32_16x16x32_bf16 v[80:83], v[242:245], v[96:99], v[80:83]
    v_mfma_f32_16x16x32_bf16 v[88:91], v[240:243], v[96:99], v[88:91]
    v_mfma_f32_16x16x32_bf16 v[84:87], v[242:245], v[100:103], v[84:87]
    v_mfma_f32_16x16x32_bf16 v[92:95], v[240:243], v[100:103], v[92:95]
    s_nop 7
    v_cvt_pk_bf16_f32 v96, v80, v81
    v_cvt_pk_bf16_f32 v97, v82, v83
    v_cvt_pk_bf16_f32 v98, v88, v89
    v_cvt_pk_bf16_f32 v99, v90, v91
    v_cvt_pk_bf16_f32 v100, v84, v85
    v_cvt_pk_bf16_f32 v101, v86, v87
    v_cvt_pk_bf16_f32 v102, v92, v93
    v_cvt_pk_bf16_f32 v103, v94, v95
    s_nop 1
    v_permlane32_swap_b32 v96, v98
    v_permlane32_swap_b32 v97, v99
    v_permlane32_swap_b32 v100, v102
    v_permlane32_swap_b32 v101, v103
    v_permlane16_swap_b32 v96, v98
    v_permlane16_swap_b32 v97, v99
    v_permlane16_swap_b32 v100, v102
    v_permlane16_swap_b32 v101, v103
    buffer_store_dwordx4 v[96:99], v11, s[4:7], 0 offen sc1
    buffer_store_dwordx4 v[100:103], v11, s[4:7], s25 offen sc1
L_end:
    s_endpgm
L_redo:
    s_mov_b32 s63, 1
    s_mov_b32 s58, 0
    s_mov_b32 s59, 0
    s_mov_b32 s29, 16
    v_xor_b32 v10, v10, v11
    s_waitcnt vmcnt(0) lgkmcnt(0)
.p2align 3
L_mx:
    s_barrier
    s_add_u32 m0, s69, 0
    s_nop 0
    buffer_load_dwordx4 v9, s[12:15], s58 offen offset:0 nt lds
    s_add_u32 m0, s69, 32
    s_nop 0
    buffer_load_dwordx4 v9, s[12:15], s58 offen offset:1024 nt lds
    s_add_u32 s58, s58, 8192
    s_waitcnt vmcnt(0)
    s_barrier
    ds_read_b128 v[184:187], v10 offset:0
    ds_read_b128 v[188:191], v10 offset:64
    ds_read_b128 v[192:195], v10 offset:128
    ds_read_b128 v[196:199], v10 offset:192
    ds_read_b128 v[200:203], v10 offset:512
    ds_read_b128 v[204:207], v10 offset:576
    ds_read_b128 v[208:211], v10 offset:640
    ds_read_b128 v[212:215], v10 offset:704
    s_waitcnt lgkmcnt(0)
    v_mfma_f32_16x16x32_bf16 v[136:139], v[184:187], v[104:107], 0
    v_mfma_f32_16x16x32_bf16 v[136:139], v[188:191], v[108:111], v[136:139]
    v_mfma_f32_16x16x32_bf16 v[136:139], v[192:195], v[112:115], v[136:139]
    v_mfma_f32_16x16x32_bf16 v[136:139], v[196:199], v[116:119], v[136:139]
    v_mfma_f32_16x16x32_bf16 v[140:143], v[184:187], v[120:123], 0
    v_mfma_f32_16x16x32_bf16 v[140:143], v[188:191], v[124:127], v[140:143]
    v_mfma_f32_16x16x32_bf16 v[140:143], v[192:195], v[128:131], v[140:143]
    v_mfma_f32_16x16x32_bf16 v[140:143], v[196:199], v[132:135], v[140:143]
    v_mfma_f32_16x16x32_bf16 v[144:147], v[200:203], v[104:107], 0
    v_mfma_f32_16x16x32_bf16 v[144:147], v[204:207], v[108:111], v[144:147]
    v_mfma_f32_16x16x32_bf16 v[144:147], v[208:211], v[112:115], v[144:147]
    v_mfma_f32_16x16x32_bf16 v[144:147], v[212:215], v[116:119], v[144:147]
    v_mfma_f32_16x16x32_bf16 v[148:151], v[200:203], v[120:123], 0
    v_mfma_f32_16x16x32_bf16 v[148:151], v[204:207], v[124:127], v[148:151]
    v_mfma_f32_16x16x32_bf16 v[148:151], v[208:211], v[128:131], v[148:151]
    v_mfma_f32_16x16x32_bf16 v[148:151], v[212:215], v[132:135], v[148:151]
    s_nop 7
    v_max3_f32 v248, v136, v137, v138
    v_max3_f32 v249, v139, v144, v145
    v_max3_f32 v250, v146, v147, v36
    v_max3_f32 v36, v248, v249, v250
    v_max3_f32 v252, v140, v141, v142
    v_max3_f32 v253, v143, v148, v149
    v_max3_f32 v254, v150, v151, v37
    v_max3_f32 v37, v252, v253, v254
    s_sub_u32 s29, s29, 1
    s_cmp_lg_u32 s29, 0
    s_cbranch_scc1 L_mx
    s_mov_b32 s58, 0
    s_barrier
    s_add_u32 m0, s69, 0
    s_nop 0
    buffer_load_dwordx4 v9, s[12:15], s58 offen offset:0 nt lds
    s_add_u32 m0, s69, 32
    s_nop 0
    buffer_load_dwordx4 v9, s[12:15], s58 offen offset:1024 nt lds
    s_add_u32 s58, s58, 8192
    s_add_u32 m0, s69, 8448
    s_nop 0
    buffer_load_dwordx4 v9, s[16:19], s59 offen offset:0 nt lds
    s_add_u32 m0, s69, 8480
    s_nop 0
    buffer_load_dwordx4 v9, s[16:19], s59 offen offset:1024 nt lds
    s_add_u32 s59, s59, 8192
    s_add_u32 m0, s69, 16896
    s_nop 0
    buffer_load_dwordx4 v9, s[12:15], s58 offen offset:0 nt lds
    s_add_u32 m0, s69, 16928
    s_nop 0
    buffer_load_dwordx4 v9, s[12:15], s58 offen offset:1024 nt lds
    s_add_u32 s58, s58, 8192
    s_add_u32 m0, s69, 25344
    s_nop 0
    buffer_load_dwordx4 v9, s[16:19], s59 offen offset:0 nt lds
    s_add_u32 m0, s69, 25376
    s_nop 0
    buffer_load_dwordx4 v9, s[16:19], s59 offen offset:1024 nt lds
    s_add_u32 s59, s59, 8192
    s_add_u32 m0, s69, 67584
    s_nop 0
    buffer_load_dwordx4 v9, s[12:15], s58 offen offset:0 nt lds
    s_add_u32 m0, s69, 67616
    s_nop 0
    buffer_load_dwordx4 v9, s[12:15], s58 offen offset:1024 nt lds
    s_add_u32 s58, s58, 8192
    s_add_u32 m0, s69, 76032
    s_nop 0
    buffer_load_dwordx4 v9, s[16:19], s59 offen offset:0 nt lds
    s_add_u32 m0, s69, 76064
    s_nop 0
    buffer_load_dwordx4 v9, s[16:19], s59 offen offset:1024 nt lds
    s_add_u32 s59, s59, 8192
    s_add_u32 m0, s69, 84480
    s_nop 0
    buffer_load_dwordx4 v9, s[12:15], s58 offen offset:0 nt lds
    s_waitcnt vmcnt(0)
    s_barrier
    ds_read_b128 v[184:187], v10 offset:0
    ds_read_b128 v[188:191], v10 offset:64
    ds_read_b128 v[192:195], v10 offset:128
    ds_read_b128 v[196:199], v10 offset:192
    ds_read_b128 v[200:203], v10 offset:512
    ds_read_b128 v[204:207], v10 offset:576
    ds_read_b128 v[208:211], v10 offset:640
    ds_read_b128 v[212:215], v10 offset:704
    s_branch L_attn

.p2align 8
.fill 4096, 4, 0xbf800000
.section .rodata,"a"
.p2align 6
.amdhsa_kernel concat_heads__mha_block_cached__gqa_block_cached__near_ridge_kernel
  .amdhsa_next_free_vgpr 256
  .amdhsa_next_free_sgpr 102
  .amdhsa_accum_offset 256
  .amdhsa_group_segment_fixed_size 0
  .amdhsa_kernarg_size 104
  .amdhsa_user_sgpr_count 2
  .amdhsa_user_sgpr_kernarg_segment_ptr 1
  .amdhsa_system_sgpr_workgroup_id_x 1
.end_amdhsa_kernel
```
